```python
import torch

def _softmax(x, axis=-1):
    return torch.softmax(x, dim=axis)
def _gelu(x):
    return torch.nn.functional.gelu(x, approximate="tanh")
def _silu(x):
    return torch.nn.functional.silu(x)
def _sigmoid(x):
    return torch.sigmoid(x)
def _layernorm(x, axis=-1, eps=1e-5):
    m = x.mean(dim=axis, keepdim=True)
    v = x.var(dim=axis, keepdim=True, unbiased=False)
    return (x - m) / torch.sqrt(v + eps)
def _scatter_add(tgt, idx, src, axis=0):
    return tgt.clone().index_add_(axis, idx, src)
def _segment_sum(src, seg, n):
    out = torch.zeros((n,) + src.shape[1:], dtype=src.dtype)
    return out.index_add_(0, seg, src)
def _pad(x, pw):
    flat = tuple(v for pair in reversed(pw) for v in pair)
    return torch.nn.functional.pad(x, flat)

kernel_name = 'standalone__mha_softmax__near_ridge'

def setup_inputs():

    _w = (lambda a: (lambda t: t.to(torch.bfloat16) if t.is_floating_point() else t)(torch.as_tensor(a)))
    B, H, Sq, Sk, D = 8, 32, 496, 1024, 128
    return {
        "q": _w((lambda *s: torch.randn(*s, dtype=torch.bfloat16) * 0.8)(B, H, Sq, D)),
        "k": _w((lambda *s: torch.randn(*s, dtype=torch.bfloat16) * 0.8)(B, H, Sk, D)),
        "v": _w((lambda *s: torch.randn(*s, dtype=torch.bfloat16) * 0.05)(B, H, Sk, D)),
    }

def reference(q, k, v):
    scale = q.shape[-1] ** -0.5
    scores = torch.einsum("bhqd,bhkd->bhqk", q, k) * scale
    p = _softmax(scores, axis=-1)
    return torch.einsum("bhqk,bhkd->bhqd", p, v)
```

```asm
; @launch grid=(256,1,1) block=(256,1,1) lds=163840
.amdgcn_target "amdgcn-amd-amdhsa--gfx950"
.text
.globl standalone__mha_softmax__near_ridge_kernel
.p2align 8
.type standalone__mha_softmax__near_ridge_kernel,@function
standalone__mha_softmax__near_ridge_kernel:
    s_cmp_ge_u32 s2, 256
    s_cbranch_scc1 L_done
    s_load_dwordx4 s[4:7], s[0:1], 0
    s_load_dwordx4 s[56:59], s[0:1], 16
    v_lshrrev_b32 v8, 6, v0
    v_and_b32 v0, 63, v0
    v_readfirstlane_b32 s24, v8
    v_and_b32 v9, 15, v0
    v_lshrrev_b32 v10, 4, v0
    v_lshrrev_b32 v13, 5, v0
    v_bfe_u32 v11, v0, 2, 3
    v_lshrrev_b32 v12, 2, v11
    v_lshlrev_b32 v12, 1, v12
    v_and_b32 v14, 3, v0
    v_xor_b32 v12, v12, v14
    v_lshlrev_b32 v12, 4, v12
    v_lshl_add_u32 v12, v13, 6, v12
    v_lshl_add_u32 v3, v11, 8, v12
    s_lshl_b32 s28, s24, 15
    v_lshlrev_b32 v15, 8, v9
    v_add_u32 v15, s28, v15
    v_add_u32 v5, s28, v3
    v_bfe_u32 v11, v0, 1, 3
    v_and_b32 v12, 1, v0
    v_lshlrev_b32 v12, 4, v12
    v_lshl_add_u32 v12, v10, 5, v12
    v_lshl_add_u32 v4, v11, 8, v12
    s_lshl_b32 s26, s24, 11
    s_mov_b32 s25, s26
    s_mov_b32 s33, s26
    s_and_b32 s3, s2, 7
    s_lshl_b32 s3, s3, 5
    s_lshr_b32 s29, s2, 3
    s_add_u32 s3, s3, s29
    s_mul_i32 s28, s3, 126976
    s_lshl_b32 s29, s3, 18
    s_mov_b32 s14, 262144
    s_mov_b32 s15, 0x20000
    s_mov_b32 s10, 126976
    s_mov_b32 s11, 0x20000
    s_mov_b32 s18, 262144
    s_mov_b32 s19, 0x20000
    s_mov_b32 s22, 126976
    s_mov_b32 s23, 0x20000
    s_waitcnt lgkmcnt(0)
    s_add_u32 s12, s6, s29
    s_addc_u32 s13, s7, 0
    s_add_u32 s8, s4, s28
    s_addc_u32 s9, s5, 0
    s_add_u32 s16, s56, s29
    s_addc_u32 s17, s57, 0
    s_add_u32 s20, s58, s28
    s_addc_u32 s21, s59, 0
    s_add_u32 m0, s26, 32768
    s_nop 0
    buffer_load_dwordx4 v5, s[8:11], 0 offen nt lds
    s_add_u32 m0, s26, 33664
    s_nop 0
    buffer_load_dwordx4 v5, s[8:11], 0 offen offset:128 nt lds
    s_add_u32 m0, s26, 96256
    s_nop 0
    buffer_load_dwordx4 v5, s[8:11], 0 offen offset:2048 nt lds
    s_add_u32 m0, s26, 97152
    s_nop 0
    buffer_load_dwordx4 v5, s[8:11], 0 offen offset:2176 nt lds
    s_add_u32 m0, s26, 0
    s_nop 0
    buffer_load_dwordx4 v3, s[12:15], s25 offen nt lds
    s_add_u32 m0, s26, 896
    s_nop 0
    buffer_load_dwordx4 v3, s[12:15], s25 offen offset:128 nt lds
    s_add_u32 m0, s26, 65536
    s_nop 0
    buffer_load_dwordx4 v4, s[16:19], s25 offen nt lds
    s_add_u32 m0, s26, 66432
    s_nop 0
    buffer_load_dwordx4 v4, s[16:19], s25 offen offset:128 nt lds
    s_add_u32 s25, s25, 8192
    s_getpc_b64 s[64:65]
L_pc:
    s_mov_b32 s66, L_done - L_pc
    s_mov_b32 s67, 0x20000
    s_bfe_u32 s69, s2, 0x50003
    s_lshl_b32 s69, s69, 2
    s_add_u32 s69, s69, s24
    s_lshl_b32 s69, s69, 9
    v_lshlrev_b32 v11, 3, v0
    v_add_u32 v11, s69, v11
    buffer_load_dwordx2 v[120:121], v11, s[64:67], 0 offen
    v_add_u32 v5, 0x1000, v5
    s_add_u32 m0, s26, 40960
    s_nop 0
    buffer_load_dwordx4 v5, s[8:11], 0 offen nt lds
    s_add_u32 m0, s26, 41856
    s_nop 0
    buffer_load_dwordx4 v5, s[8:11], 0 offen offset:128 nt lds
    s_add_u32 m0, s26, 104448
    s_nop 0
    buffer_load_dwordx4 v5, s[8:11], 0 offen offset:2048 nt lds
    s_add_u32 m0, s26, 105344
    s_nop 0
    buffer_load_dwordx4 v5, s[8:11], 0 offen offset:2176 nt lds
    s_add_u32 m0, s26, 8192
    s_nop 0
    buffer_load_dwordx4 v3, s[12:15], s25 offen nt lds
    s_add_u32 m0, s26, 9088
    s_nop 0
    buffer_load_dwordx4 v3, s[12:15], s25 offen offset:128 nt lds
    s_add_u32 m0, s26, 73728
    s_nop 0
    buffer_load_dwordx4 v4, s[16:19], s25 offen nt lds
    s_add_u32 m0, s26, 74624
    s_nop 0
    buffer_load_dwordx4 v4, s[16:19], s25 offen offset:128 nt lds
    s_add_u32 s25, s25, 8192
    v_and_b32 v11, 7, v9
    v_lshrrev_b32 v12, 2, v11
    v_lshlrev_b32 v12, 1, v12
    v_xor_b32 v12, v12, v10
    v_lshl_add_u32 v12, v11, 2, v12
    v_lshlrev_b32 v12, 4, v12
    v_lshrrev_b32 v14, 3, v9
    v_lshl_add_u32 v1, v14, 11, v12
    v_mul_u32_u24 v14, 65536, v14
    v_add3_u32 v122, v14, v12, s26
    v_and_b32 v12, 31, v0
    v_lshlrev_b32 v12, 3, v12
    v_lshl_add_u32 v2, v13, 11, v12
    v_add_u32 v2, 65536, v2
    v_and_b32 v14, 1, v10
    v_lshl_add_u32 v15, v14, 5, v15
    v_lshl_add_u32 v6, v13, 4, v15
    s_add_u32 s32, s26, 253952
    s_mov_b32 s30, 0x3e0293ee
    s_mov_b32 s31, 0x3e0293ee
    v_mov_b32 v112, 0
    v_mov_b32 v113, 0
    v_mov_b32 v114, 0
    v_mov_b32 v115, 0
    v_mov_b32 v116, 0
    v_mov_b32 v117, 0
    v_mov_b32 v118, 0
    v_mov_b32 v119, 0
    s_cmp_eq_u32 s24, 3
    s_cselect_b32 s28, 0xc4800000, 0
    s_cselect_b32 s29, 1.0, 0
    v_mov_b32 v124, s28
    v_mov_b32 v125, s28
    v_mov_b32 v126, s28
    v_mov_b32 v127, s28
    v_mov_b32 v119, s29
    s_waitcnt vmcnt(13)
    ds_read_b128 v[128:131], v122 offset:32768
    ds_read_b128 v[132:135], v122 offset:33280
    ds_read_b128 v[136:139], v122 offset:33792
    ds_read_b128 v[140:143], v122 offset:34304
    s_waitcnt lgkmcnt(3)
    v_lshlrev_b32 v8, 16, v128
    v_lshlrev_b32 v10, 16, v129
    v_lshlrev_b32 v12, 16, v130
    v_lshlrev_b32 v14, 16, v131
    v_and_b32 v9, 0xffff0000, v128
    v_and_b32 v11, 0xffff0000, v129
    v_and_b32 v13, 0xffff0000, v130
    v_and_b32 v15, 0xffff0000, v131
    v_pk_mul_f32 v[8:9], v[8:9], s[30:31]
    v_pk_mul_f32 v[10:11], v[10:11], s[30:31]
    v_pk_mul_f32 v[12:13], v[12:13], s[30:31]
    v_pk_mul_f32 v[14:15], v[14:15], s[30:31]
    v_cvt_pk_bf16_f32 v128, v8, v9
    v_cvt_pk_bf16_f32 v129, v10, v11
    v_cvt_pk_bf16_f32 v130, v12, v13
    v_cvt_pk_bf16_f32 v131, v14, v15
    s_waitcnt lgkmcnt(2)
    v_lshlrev_b32 v8, 16, v132
    v_lshlrev_b32 v10, 16, v133
    v_lshlrev_b32 v12, 16, v134
    v_lshlrev_b32 v14, 16, v135
    v_and_b32 v9, 0xffff0000, v132
    v_and_b32 v11, 0xffff0000, v133
    v_and_b32 v13, 0xffff0000, v134
    v_and_b32 v15, 0xffff0000, v135
    v_pk_mul_f32 v[8:9], v[8:9], s[30:31]
    v_pk_mul_f32 v[10:11], v[10:11], s[30:31]
    v_pk_mul_f32 v[12:13], v[12:13], s[30:31]
    v_pk_mul_f32 v[14:15], v[14:15], s[30:31]
    v_cvt_pk_bf16_f32 v132, v8, v9
    v_cvt_pk_bf16_f32 v133, v10, v11
    v_cvt_pk_bf16_f32 v134, v12, v13
    v_cvt_pk_bf16_f32 v135, v14, v15
    s_waitcnt lgkmcnt(1)
    v_lshlrev_b32 v8, 16, v136
    v_lshlrev_b32 v10, 16, v137
    v_lshlrev_b32 v12, 16, v138
    v_lshlrev_b32 v14, 16, v139
    v_and_b32 v9, 0xffff0000, v136
    v_and_b32 v11, 0xffff0000, v137
    v_and_b32 v13, 0xffff0000, v138
    v_and_b32 v15, 0xffff0000, v139
    v_pk_mul_f32 v[8:9], v[8:9], s[30:31]
    v_pk_mul_f32 v[10:11], v[10:11], s[30:31]
    v_pk_mul_f32 v[12:13], v[12:13], s[30:31]
    v_pk_mul_f32 v[14:15], v[14:15], s[30:31]
    v_cvt_pk_bf16_f32 v136, v8, v9
    v_cvt_pk_bf16_f32 v137, v10, v11
    v_cvt_pk_bf16_f32 v138, v12, v13
    v_cvt_pk_bf16_f32 v139, v14, v15
    s_waitcnt lgkmcnt(0)
    v_lshlrev_b32 v8, 16, v140
    v_lshlrev_b32 v10, 16, v141
    v_lshlrev_b32 v12, 16, v142
    v_lshlrev_b32 v14, 16, v143
    v_and_b32 v9, 0xffff0000, v140
    v_and_b32 v11, 0xffff0000, v141
    v_and_b32 v13, 0xffff0000, v142
    v_and_b32 v15, 0xffff0000, v143
    v_pk_mul_f32 v[8:9], v[8:9], s[30:31]
    v_pk_mul_f32 v[10:11], v[10:11], s[30:31]
    v_pk_mul_f32 v[12:13], v[12:13], s[30:31]
    v_pk_mul_f32 v[14:15], v[14:15], s[30:31]
    v_cvt_pk_bf16_f32 v140, v8, v9
    v_cvt_pk_bf16_f32 v141, v10, v11
    v_cvt_pk_bf16_f32 v142, v12, v13
    v_cvt_pk_bf16_f32 v143, v14, v15
    s_waitcnt vmcnt(11)
    s_barrier
    ds_read_b128 a[192:195], v1 offset:0
    ds_read_b128 a[196:199], v1 offset:512
    ds_read_b128 a[200:203], v1 offset:1024
    ds_read_b128 a[204:207], v1 offset:1536
    ds_read_b128 a[208:211], v1 offset:4096
    ds_read_b128 a[212:215], v1 offset:4608
    ds_read_b128 a[216:219], v1 offset:5120
    ds_read_b128 a[220:223], v1 offset:5632
    s_waitcnt lgkmcnt(7)
    v_mfma_f32_16x16x32_bf16 v[16:19], a[192:195], v[128:131], 0
    s_waitcnt lgkmcnt(6)
    v_mfma_f32_16x16x32_bf16 v[16:19], a[196:199], v[132:135], v[16:19]
    s_waitcnt lgkmcnt(5)
    v_mfma_f32_16x16x32_bf16 v[16:19], a[200:203], v[136:139], v[16:19]
    s_waitcnt lgkmcnt(4)
    v_mfma_f32_16x16x32_bf16 v[16:19], a[204:207], v[140:143], v[16:19]
    s_waitcnt lgkmcnt(0)
    v_mfma_f32_16x16x32_bf16 v[20:23], a[220:223], v[140:143], 0
    v_mfma_f32_16x16x32_bf16 v[20:23], a[216:219], v[136:139], v[20:23]
    v_mfma_f32_16x16x32_bf16 v[20:23], a[212:215], v[132:135], v[20:23]
    v_mfma_f32_16x16x32_bf16 v[20:23], a[208:211], v[128:131], v[20:23]
    s_waitcnt vmcnt(4)
    ds_read_b128 v[144:147], v122 offset:40960
    ds_read_b128 v[148:151], v122 offset:41472
    ds_read_b128 v[152:155], v122 offset:41984
    ds_read_b128 v[156:159], v122 offset:42496
    v_add_u32 v5, 0x1000, v5
    s_add_u32 m0, s26, 49152
    s_nop 0
    buffer_load_dwordx4 v5, s[8:11], 0 offen nt lds
    s_add_u32 m0, s26, 50048
    s_nop 0
    buffer_load_dwordx4 v5, s[8:11], 0 offen offset:128 nt lds
    s_add_u32 m0, s26, 112640
    s_nop 0
    buffer_load_dwordx4 v5, s[8:11], 0 offen offset:2048 nt lds
    s_add_u32 m0, s26, 113536
    s_nop 0
    buffer_load_dwordx4 v5, s[8:11], 0 offen offset:2176 nt lds
    v_add_u32 v5, 0x1000, v5
    s_add_u32 m0, s26, 57344
    s_nop 0
    buffer_load_dwordx4 v5, s[8:11], 0 offen nt lds
    s_add_u32 m0, s26, 58240
    s_nop 0
    buffer_load_dwordx4 v5, s[8:11], 0 offen offset:128 nt lds
    s_add_u32 m0, s26, 120832
    s_nop 0
    buffer_load_dwordx4 v5, s[8:11], 0 offen offset:2048 nt lds
    s_add_u32 m0, s26, 121728
    s_nop 0
    buffer_load_dwordx4 v5, s[8:11], 0 offen offset:2176 nt lds
    s_waitcnt lgkmcnt(3)
    v_lshlrev_b32 v8, 16, v144
    v_lshlrev_b32 v10, 16, v145
    v_lshlrev_b32 v12, 16, v146
    v_lshlrev_b32 v14, 16, v147
    v_and_b32 v9, 0xffff0000, v144
    v_and_b32 v11, 0xffff0000, v145
    v_and_b32 v13, 0xffff0000, v146
    v_and_b32 v15, 0xffff0000, v147
    v_pk_mul_f32 v[8:9], v[8:9], s[30:31]
    v_pk_mul_f32 v[10:11], v[10:11], s[30:31]
    v_pk_mul_f32 v[12:13], v[12:13], s[30:31]
    v_pk_mul_f32 v[14:15], v[14:15], s[30:31]
    v_cvt_pk_bf16_f32 v144, v8, v9
    v_cvt_pk_bf16_f32 v145, v10, v11
    v_cvt_pk_bf16_f32 v146, v12, v13
    v_cvt_pk_bf16_f32 v147, v14, v15
    s_waitcnt lgkmcnt(2)
    v_lshlrev_b32 v8, 16, v148
    v_lshlrev_b32 v10, 16, v149
    v_lshlrev_b32 v12, 16, v150
    v_lshlrev_b32 v14, 16, v151
    v_and_b32 v9, 0xffff0000, v148
    v_and_b32 v11, 0xffff0000, v149
    v_and_b32 v13, 0xffff0000, v150
    v_and_b32 v15, 0xffff0000, v151
    v_pk_mul_f32 v[8:9], v[8:9], s[30:31]
    v_pk_mul_f32 v[10:11], v[10:11], s[30:31]
    v_pk_mul_f32 v[12:13], v[12:13], s[30:31]
    v_pk_mul_f32 v[14:15], v[14:15], s[30:31]
    v_cvt_pk_bf16_f32 v148, v8, v9
    v_cvt_pk_bf16_f32 v149, v10, v11
    v_cvt_pk_bf16_f32 v150, v12, v13
    v_cvt_pk_bf16_f32 v151, v14, v15
    s_waitcnt lgkmcnt(1)
    v_lshlrev_b32 v8, 16, v152
    v_lshlrev_b32 v10, 16, v153
    v_lshlrev_b32 v12, 16, v154
    v_lshlrev_b32 v14, 16, v155
    v_and_b32 v9, 0xffff0000, v152
    v_and_b32 v11, 0xffff0000, v153
    v_and_b32 v13, 0xffff0000, v154
    v_and_b32 v15, 0xffff0000, v155
    v_pk_mul_f32 v[8:9], v[8:9], s[30:31]
    v_pk_mul_f32 v[10:11], v[10:11], s[30:31]
    v_pk_mul_f32 v[12:13], v[12:13], s[30:31]
    v_pk_mul_f32 v[14:15], v[14:15], s[30:31]
    v_cvt_pk_bf16_f32 v152, v8, v9
    v_cvt_pk_bf16_f32 v153, v10, v11
    v_cvt_pk_bf16_f32 v154, v12, v13
    v_cvt_pk_bf16_f32 v155, v14, v15
    s_waitcnt lgkmcnt(0)
    v_lshlrev_b32 v8, 16, v156
    v_lshlrev_b32 v10, 16, v157
    v_lshlrev_b32 v12, 16, v158
    v_lshlrev_b32 v14, 16, v159
    v_and_b32 v9, 0xffff0000, v156
    v_and_b32 v11, 0xffff0000, v157
    v_and_b32 v13, 0xffff0000, v158
    v_and_b32 v15, 0xffff0000, v159
    v_pk_mul_f32 v[8:9], v[8:9], s[30:31]
    v_pk_mul_f32 v[10:11], v[10:11], s[30:31]
    v_pk_mul_f32 v[12:13], v[12:13], s[30:31]
    v_pk_mul_f32 v[14:15], v[14:15], s[30:31]
    v_cvt_pk_bf16_f32 v156, v8, v9
    v_cvt_pk_bf16_f32 v157, v10, v11
    v_cvt_pk_bf16_f32 v158, v12, v13
    v_cvt_pk_bf16_f32 v159, v14, v15
    v_mfma_f32_16x16x32_bf16 v[24:27], a[192:195], v[144:147], 0
    v_exp_f32 v16, v16
    v_mfma_f32_16x16x32_bf16 v[24:27], a[196:199], v[148:151], v[24:27]
    v_exp_f32 v17, v17
    v_mfma_f32_16x16x32_bf16 v[24:27], a[200:203], v[152:155], v[24:27]
    v_add_f32 v112, v112, v16
    v_add_f32 v112, v112, v17
    v_mfma_f32_16x16x32_bf16 v[24:27], a[204:207], v[156:159], v[24:27]
    v_exp_f32 v18, v18
    v_mfma_f32_16x16x32_bf16 v[28:31], a[220:223], v[156:159], 0
    v_exp_f32 v19, v19
    v_mfma_f32_16x16x32_bf16 v[28:31], a[216:219], v[152:155], v[28:31]
    v_cvt_pk_bf16_f32 v16, v16, v17
    v_add_f32 v112, v112, v18
    v_mfma_f32_16x16x32_bf16 v[28:31], a[212:215], v[148:151], v[28:31]
    v_exp_f32 v20, v20
    v_mfma_f32_16x16x32_bf16 v[28:31], a[208:211], v[144:147], v[28:31]
    v_add_f32 v112, v112, v19
    v_cvt_pk_bf16_f32 v17, v18, v19
    s_waitcnt vmcnt(8)
    s_add_u32 m0, s26, 16384
    s_nop 0
    buffer_load_dwordx4 v3, s[12:15], s25 offen nt lds
    s_add_u32 m0, s26, 17280
    s_nop 0
    buffer_load_dwordx4 v3, s[12:15], s25 offen offset:128 nt lds
    s_add_u32 m0, s26, 81920
    s_nop 0
    buffer_load_dwordx4 v4, s[16:19], s25 offen nt lds
    s_add_u32 m0, s26, 82816
    s_nop 0
    buffer_load_dwordx4 v4, s[16:19], s25 offen offset:128 nt lds
    s_add_u32 s25, s25, 8192
    s_barrier
    ds_read_b128 a[192:195], v1 offset:8192
    ds_read_b128 a[196:199], v1 offset:8704
    ds_read_b128 a[200:203], v1 offset:9216
    ds_read_b128 a[204:207], v1 offset:9728
    ds_read_b128 a[208:211], v1 offset:12288
    ds_read_b128 a[212:215], v1 offset:12800
    ds_read_b128 a[216:219], v1 offset:13312
    ds_read_b128 a[220:223], v1 offset:13824
    s_waitcnt lgkmcnt(0)
    ds_read_b64_tr_b16 a[224:225], v2 offset:0
    ds_read_b64_tr_b16 a[226:227], v2 offset:4096
    ds_read_b64_tr_b16 a[228:229], v2 offset:256
    ds_read_b64_tr_b16 a[230:231], v2 offset:4352
    ds_read_b64_tr_b16 a[232:233], v2 offset:512
    ds_read_b64_tr_b16 a[234:235], v2 offset:4608
    ds_read_b64_tr_b16 a[236:237], v2 offset:768
    ds_read_b64_tr_b16 a[238:239], v2 offset:4864
    ds_read_b64_tr_b16 a[240:241], v2 offset:1024
    ds_read_b64_tr_b16 a[242:243], v2 offset:5120
    ds_read_b64_tr_b16 a[244:245], v2 offset:1280
    ds_read_b64_tr_b16 a[246:247], v2 offset:5376
    ds_read_b64_tr_b16 a[248:249], v2 offset:1536
    ds_read_b64_tr_b16 a[250:251], v2 offset:5632
    ds_read_b64_tr_b16 a[252:253], v2 offset:1792
    ds_read_b64_tr_b16 a[254:255], v2 offset:5888
    v_mfma_f32_16x16x32_bf16 v[32:35], a[192:195], v[128:131], 0
    v_exp_f32 v21, v21
    v_mfma_f32_16x16x32_bf16 v[32:35], a[196:199], v[132:135], v[32:35]
    v_add_f32 v112, v112, v20
    v_add_f32 v112, v112, v21
    v_mfma_f32_16x16x32_bf16 v[32:35], a[200:203], v[136:139], v[32:35]
    v_exp_f32 v22, v22
    v_mfma_f32_16x16x32_bf16 v[32:35], a[204:207], v[140:143], v[32:35]
    v_exp_f32 v23, v23
    v_mfma_f32_16x16x32_bf16 v[36:39], a[220:223], v[140:143], 0
    v_cvt_pk_bf16_f32 v18, v20, v21
    v_add_f32 v112, v112, v22
    v_mfma_f32_16x16x32_bf16 v[36:39], a[216:219], v[136:139], v[36:39]
    v_add_f32 v112, v112, v23
    v_cvt_pk_bf16_f32 v19, v22, v23
    v_mfma_f32_16x16x32_bf16 v[36:39], a[212:215], v[132:135], v[36:39]
    v_exp_f32 v24, v24
    v_mfma_f32_16x16x32_bf16 v[36:39], a[208:211], v[128:131], v[36:39]
    s_waitcnt lgkmcnt(14)
    v_exp_f32 v25, v25
    v_mfma_f32_16x16x32_bf16 a[0:3], a[224:227], v[16:19], 0
    s_waitcnt lgkmcnt(12)
    v_add_f32 v113, v113, v24
    v_add_f32 v113, v113, v25
    v_mfma_f32_16x16x32_bf16 a[4:7], a[228:231], v[16:19], 0
    s_waitcnt lgkmcnt(10)
    v_exp_f32 v26, v26
    v_mfma_f32_16x16x32_bf16 a[8:11], a[232:235], v[16:19], 0
    s_waitcnt lgkmcnt(8)
    v_exp_f32 v27, v27
    v_mfma_f32_16x16x32_bf16 a[12:15], a[236:239], v[16:19], 0
    s_waitcnt lgkmcnt(6)
    v_cvt_pk_bf16_f32 v24, v24, v25
    v_add_f32 v113, v113, v26
    v_mfma_f32_16x16x32_bf16 a[16:19], a[240:243], v[16:19], 0
    s_waitcnt lgkmcnt(4)
    v_exp_f32 v28, v28
    v_mfma_f32_16x16x32_bf16 a[20:23], a[244:247], v[16:19], 0
    s_waitcnt lgkmcnt(2)
    v_add_f32 v113, v113, v27
    v_cvt_pk_bf16_f32 v25, v26, v27
    v_mfma_f32_16x16x32_bf16 a[24:27], a[248:251], v[16:19], 0
    s_waitcnt lgkmcnt(0)
    v_exp_f32 v29, v29
    v_mfma_f32_16x16x32_bf16 a[28:31], a[252:255], v[16:19], 0
    v_add_f32 v113, v113, v28
    v_add_f32 v113, v113, v29
    v_mfma_f32_16x16x32_bf16 v[40:43], a[192:195], v[144:147], 0
    v_exp_f32 v30, v30
    v_mfma_f32_16x16x32_bf16 v[40:43], a[196:199], v[148:151], v[40:43]
    v_exp_f32 v31, v31
    v_mfma_f32_16x16x32_bf16 v[40:43], a[200:203], v[152:155], v[40:43]
    v_cvt_pk_bf16_f32 v26, v28, v29
    v_add_f32 v113, v113, v30
    v_mfma_f32_16x16x32_bf16 v[40:43], a[204:207], v[156:159], v[40:43]
    v_add_f32 v113, v113, v31
    v_cvt_pk_bf16_f32 v27, v30, v31
    v_mfma_f32_16x16x32_bf16 v[44:47], a[220:223], v[156:159], 0
    v_exp_f32 v32, v32
    v_exp_f32 v33, v33
    v_mfma_f32_16x16x32_bf16 v[44:47], a[216:219], v[152:155], v[44:47]
    v_add_f32 v112, v112, v32
    v_add_f32 v112, v112, v33
    v_exp_f32 v34, v34
    v_mfma_f32_16x16x32_bf16 v[44:47], a[212:215], v[148:151], v[44:47]
    v_exp_f32 v35, v35
    v_cvt_pk_bf16_f32 v32, v32, v33
    v_add_f32 v112, v112, v34
    v_mfma_f32_16x16x32_bf16 v[44:47], a[208:211], v[144:147], v[44:47]
    v_exp_f32 v36, v36
    v_mfma_f32_16x16x32_bf16 a[32:35], a[224:227], v[24:27], 0
    ds_read_b64_tr_b16 a[224:225], v2 offset:8192
    ds_read_b64_tr_b16 a[226:227], v2 offset:12288
    v_mfma_f32_16x16x32_bf16 a[36:39], a[228:231], v[24:27], 0
    v_add_f32 v112, v112, v35
    v_cvt_pk_bf16_f32 v33, v34, v35
    v_mfma_f32_16x16x32_bf16 a[40:43], a[232:235], v[24:27], 0
    ds_read_b64_tr_b16 a[228:229], v2 offset:8448
    ds_read_b64_tr_b16 a[230:231], v2 offset:12544
    v_mfma_f32_16x16x32_bf16 a[44:47], a[236:239], v[24:27], 0
    v_exp_f32 v37, v37
    v_mfma_f32_16x16x32_bf16 a[48:51], a[240:243], v[24:27], 0
    ds_read_b64_tr_b16 a[232:233], v2 offset:8704
    ds_read_b64_tr_b16 a[234:235], v2 offset:12800
    v_mfma_f32_16x16x32_bf16 a[52:55], a[244:247], v[24:27], 0
    v_add_f32 v112, v112, v36
    v_add_f32 v112, v112, v37
    v_mfma_f32_16x16x32_bf16 a[56:59], a[248:251], v[24:27], 0
    ds_read_b64_tr_b16 a[236:237], v2 offset:8960
    ds_read_b64_tr_b16 a[238:239], v2 offset:13056
    v_mfma_f32_16x16x32_bf16 a[60:63], a[252:255], v[24:27], 0
    ds_read_b64_tr_b16 a[240:241], v2 offset:9216
    ds_read_b64_tr_b16 a[242:243], v2 offset:13312
    s_waitcnt vmcnt(8)
    ds_read_b128 v[160:163], v122 offset:49152
    ds_read_b128 v[164:167], v122 offset:49664
    ds_read_b128 v[168:171], v122 offset:50176
    ds_read_b128 v[172:175], v122 offset:50688
    v_add_u32 v5, 0x1000, v5
    s_add_u32 m0, s26, 32768
    s_nop 0
    buffer_load_dwordx4 v5, s[8:11], 0 offen nt lds
    s_add_u32 m0, s26, 33664
    s_nop 0
    buffer_load_dwordx4 v5, s[8:11], 0 offen offset:128 nt lds
    s_add_u32 m0, s26, 96256
    s_nop 0
    buffer_load_dwordx4 v5, s[8:11], 0 offen offset:2048 nt lds
    s_add_u32 m0, s26, 97152
    s_nop 0
    buffer_load_dwordx4 v5, s[8:11], 0 offen offset:2176 nt lds
    s_waitcnt lgkmcnt(3)
    v_lshlrev_b32 v8, 16, v160
    v_lshlrev_b32 v10, 16, v161
    v_lshlrev_b32 v12, 16, v162
    v_lshlrev_b32 v14, 16, v163
    v_and_b32 v9, 0xffff0000, v160
    v_and_b32 v11, 0xffff0000, v161
    v_and_b32 v13, 0xffff0000, v162
    v_and_b32 v15, 0xffff0000, v163
    v_pk_mul_f32 v[8:9], v[8:9], s[30:31]
    v_pk_mul_f32 v[10:11], v[10:11], s[30:31]
    v_pk_mul_f32 v[12:13], v[12:13], s[30:31]
    v_pk_mul_f32 v[14:15], v[14:15], s[30:31]
    v_cvt_pk_bf16_f32 v160, v8, v9
    v_cvt_pk_bf16_f32 v161, v10, v11
    v_cvt_pk_bf16_f32 v162, v12, v13
    v_cvt_pk_bf16_f32 v163, v14, v15
    s_waitcnt lgkmcnt(2)
    v_lshlrev_b32 v8, 16, v164
    v_lshlrev_b32 v10, 16, v165
    v_lshlrev_b32 v12, 16, v166
    v_lshlrev_b32 v14, 16, v167
    v_and_b32 v9, 0xffff0000, v164
    v_and_b32 v11, 0xffff0000, v165
    v_and_b32 v13, 0xffff0000, v166
    v_and_b32 v15, 0xffff0000, v167
    v_pk_mul_f32 v[8:9], v[8:9], s[30:31]
    v_pk_mul_f32 v[10:11], v[10:11], s[30:31]
    v_pk_mul_f32 v[12:13], v[12:13], s[30:31]
    v_pk_mul_f32 v[14:15], v[14:15], s[30:31]
    v_cvt_pk_bf16_f32 v164, v8, v9
    v_cvt_pk_bf16_f32 v165, v10, v11
    v_cvt_pk_bf16_f32 v166, v12, v13
    v_cvt_pk_bf16_f32 v167, v14, v15
    s_waitcnt lgkmcnt(1)
    v_lshlrev_b32 v8, 16, v168
    v_lshlrev_b32 v10, 16, v169
    v_lshlrev_b32 v12, 16, v170
    v_lshlrev_b32 v14, 16, v171
    v_and_b32 v9, 0xffff0000, v168
    v_and_b32 v11, 0xffff0000, v169
    v_and_b32 v13, 0xffff0000, v170
    v_and_b32 v15, 0xffff0000, v171
    v_pk_mul_f32 v[8:9], v[8:9], s[30:31]
    v_pk_mul_f32 v[10:11], v[10:11], s[30:31]
    v_pk_mul_f32 v[12:13], v[12:13], s[30:31]
    v_pk_mul_f32 v[14:15], v[14:15], s[30:31]
    v_cvt_pk_bf16_f32 v168, v8, v9
    v_cvt_pk_bf16_f32 v169, v10, v11
    v_cvt_pk_bf16_f32 v170, v12, v13
    v_cvt_pk_bf16_f32 v171, v14, v15
    s_waitcnt lgkmcnt(0)
    v_lshlrev_b32 v8, 16, v172
    v_lshlrev_b32 v10, 16, v173
    v_lshlrev_b32 v12, 16, v174
    v_lshlrev_b32 v14, 16, v175
    v_and_b32 v9, 0xffff0000, v172
    v_and_b32 v11, 0xffff0000, v173
    v_and_b32 v13, 0xffff0000, v174
    v_and_b32 v15, 0xffff0000, v175
    v_pk_mul_f32 v[8:9], v[8:9], s[30:31]
    v_pk_mul_f32 v[10:11], v[10:11], s[30:31]
    v_pk_mul_f32 v[12:13], v[12:13], s[30:31]
    v_pk_mul_f32 v[14:15], v[14:15], s[30:31]
    v_cvt_pk_bf16_f32 v172, v8, v9
    v_cvt_pk_bf16_f32 v173, v10, v11
    v_cvt_pk_bf16_f32 v174, v12, v13
    v_cvt_pk_bf16_f32 v175, v14, v15
    v_mfma_f32_16x16x32_bf16 v[16:19], a[192:195], v[160:163], 0
    ds_read_b64_tr_b16 a[244:245], v2 offset:9472
    ds_read_b64_tr_b16 a[246:247], v2 offset:13568
    v_mfma_f32_16x16x32_bf16 v[16:19], a[196:199], v[164:167], v[16:19]
    ds_read_b64_tr_b16 a[248:249], v2 offset:9728
    ds_read_b64_tr_b16 a[250:251], v2 offset:13824
    v_mfma_f32_16x16x32_bf16 v[16:19], a[200:203], v[168:171], v[16:19]
    ds_read_b64_tr_b16 a[252:253], v2 offset:9984
    ds_read_b64_tr_b16 a[254:255], v2 offset:14080
    v_mfma_f32_16x16x32_bf16 v[16:19], a[204:207], v[172:175], v[16:19]
    v_exp_f32 v38, v38
    v_mfma_f32_16x16x32_bf16 v[20:23], a[220:223], v[172:175], 0
    v_exp_f32 v39, v39
    v_mfma_f32_16x16x32_bf16 v[20:23], a[216:219], v[168:171], v[20:23]
    v_cvt_pk_bf16_f32 v34, v36, v37
    v_add_f32 v112, v112, v38
    v_mfma_f32_16x16x32_bf16 v[20:23], a[212:215], v[164:167], v[20:23]
    v_add_f32 v112, v112, v39
    v_cvt_pk_bf16_f32 v35, v38, v39
    v_mfma_f32_16x16x32_bf16 v[20:23], a[208:211], v[160:163], v[20:23]
    v_exp_f32 v40, v40
    v_mfma_f32_16x16x32_bf16 a[0:3], a[224:227], v[32:35], a[0:3]
    v_exp_f32 v41, v41
    v_mfma_f32_16x16x32_bf16 a[4:7], a[228:231], v[32:35], a[4:7]
    v_add_f32 v113, v113, v40
    v_add_f32 v113, v113, v41
    v_mfma_f32_16x16x32_bf16 a[8:11], a[232:235], v[32:35], a[8:11]
    v_exp_f32 v42, v42
    v_mfma_f32_16x16x32_bf16 a[12:15], a[236:239], v[32:35], a[12:15]
    v_exp_f32 v43, v43
    v_mfma_f32_16x16x32_bf16 a[16:19], a[240:243], v[32:35], a[16:19]
    s_waitcnt lgkmcnt(4)
    v_cvt_pk_bf16_f32 v40, v40, v41
    v_add_f32 v113, v113, v42
    v_mfma_f32_16x16x32_bf16 a[20:23], a[244:247], v[32:35], a[20:23]
    s_waitcnt lgkmcnt(2)
    v_exp_f32 v44, v44
    v_mfma_f32_16x16x32_bf16 a[24:27], a[248:251], v[32:35], a[24:27]
    s_waitcnt lgkmcnt(0)
    v_add_f32 v113, v113, v43
    v_cvt_pk_bf16_f32 v41, v42, v43
    v_mfma_f32_16x16x32_bf16 a[28:31], a[252:255], v[32:35], a[28:31]
    v_exp_f32 v45, v45
    s_waitcnt vmcnt(8)
    ds_read_b128 v[176:179], v122 offset:57344
    ds_read_b128 v[180:183], v122 offset:57856
    ds_read_b128 v[184:187], v122 offset:58368
    ds_read_b128 v[188:191], v122 offset:58880
    v_add_u32 v5, 0x1000, v5
    s_add_u32 m0, s26, 40960
    s_nop 0
    buffer_load_dwordx4 v5, s[8:11], 0 offen nt lds
    s_add_u32 m0, s26, 41856
    s_nop 0
    buffer_load_dwordx4 v5, s[8:11], 0 offen offset:128 nt lds
    s_add_u32 m0, s26, 104448
    s_nop 0
    buffer_load_dwordx4 v5, s[8:11], 0 offen offset:2048 nt lds
    s_add_u32 m0, s26, 105344
    s_nop 0
    buffer_load_dwordx4 v5, s[8:11], 0 offen offset:2176 nt lds
    s_waitcnt lgkmcnt(3)
    v_lshlrev_b32 v8, 16, v176
    v_lshlrev_b32 v10, 16, v177
    v_lshlrev_b32 v12, 16, v178
    v_lshlrev_b32 v14, 16, v179
    v_and_b32 v9, 0xffff0000, v176
    v_and_b32 v11, 0xffff0000, v177
    v_and_b32 v13, 0xffff0000, v178
    v_and_b32 v15, 0xffff0000, v179
    v_pk_mul_f32 v[8:9], v[8:9], s[30:31]
    v_pk_mul_f32 v[10:11], v[10:11], s[30:31]
    v_pk_mul_f32 v[12:13], v[12:13], s[30:31]
    v_pk_mul_f32 v[14:15], v[14:15], s[30:31]
    v_cvt_pk_bf16_f32 v176, v8, v9
    v_cvt_pk_bf16_f32 v177, v10, v11
    v_cvt_pk_bf16_f32 v178, v12, v13
    v_cvt_pk_bf16_f32 v179, v14, v15
    s_waitcnt lgkmcnt(2)
    v_lshlrev_b32 v8, 16, v180
    v_lshlrev_b32 v10, 16, v181
    v_lshlrev_b32 v12, 16, v182
    v_lshlrev_b32 v14, 16, v183
    v_and_b32 v9, 0xffff0000, v180
    v_and_b32 v11, 0xffff0000, v181
    v_and_b32 v13, 0xffff0000, v182
    v_and_b32 v15, 0xffff0000, v183
    v_pk_mul_f32 v[8:9], v[8:9], s[30:31]
    v_pk_mul_f32 v[10:11], v[10:11], s[30:31]
    v_pk_mul_f32 v[12:13], v[12:13], s[30:31]
    v_pk_mul_f32 v[14:15], v[14:15], s[30:31]
    v_cvt_pk_bf16_f32 v180, v8, v9
    v_cvt_pk_bf16_f32 v181, v10, v11
    v_cvt_pk_bf16_f32 v182, v12, v13
    v_cvt_pk_bf16_f32 v183, v14, v15
    s_waitcnt lgkmcnt(1)
    v_lshlrev_b32 v8, 16, v184
    v_lshlrev_b32 v10, 16, v185
    v_lshlrev_b32 v12, 16, v186
    v_lshlrev_b32 v14, 16, v187
    v_and_b32 v9, 0xffff0000, v184
    v_and_b32 v11, 0xffff0000, v185
    v_and_b32 v13, 0xffff0000, v186
    v_and_b32 v15, 0xffff0000, v187
    v_pk_mul_f32 v[8:9], v[8:9], s[30:31]
    v_pk_mul_f32 v[10:11], v[10:11], s[30:31]
    v_pk_mul_f32 v[12:13], v[12:13], s[30:31]
    v_pk_mul_f32 v[14:15], v[14:15], s[30:31]
    v_cvt_pk_bf16_f32 v184, v8, v9
    v_cvt_pk_bf16_f32 v185, v10, v11
    v_cvt_pk_bf16_f32 v186, v12, v13
    v_cvt_pk_bf16_f32 v187, v14, v15
    s_waitcnt lgkmcnt(0)
    v_lshlrev_b32 v8, 16, v188
    v_lshlrev_b32 v10, 16, v189
    v_lshlrev_b32 v12, 16, v190
    v_lshlrev_b32 v14, 16, v191
    v_and_b32 v9, 0xffff0000, v188
    v_and_b32 v11, 0xffff0000, v189
    v_and_b32 v13, 0xffff0000, v190
    v_and_b32 v15, 0xffff0000, v191
    v_pk_mul_f32 v[8:9], v[8:9], s[30:31]
    v_pk_mul_f32 v[10:11], v[10:11], s[30:31]
    v_pk_mul_f32 v[12:13], v[12:13], s[30:31]
    v_pk_mul_f32 v[14:15], v[14:15], s[30:31]
    v_cvt_pk_bf16_f32 v188, v8, v9
    v_cvt_pk_bf16_f32 v189, v10, v11
    v_cvt_pk_bf16_f32 v190, v12, v13
    v_cvt_pk_bf16_f32 v191, v14, v15
    v_mfma_f32_16x16x32_bf16 v[24:27], a[192:195], v[176:179], 0
    v_add_f32 v113, v113, v44
    v_add_f32 v113, v113, v45
    v_mfma_f32_16x16x32_bf16 v[24:27], a[196:199], v[180:183], v[24:27]
    ds_read_b128 a[192:195], v1 offset:0
    ds_read_b128 a[196:199], v1 offset:512
    v_mfma_f32_16x16x32_bf16 v[24:27], a[200:203], v[184:187], v[24:27]
    v_exp_f32 v46, v46
    v_mfma_f32_16x16x32_bf16 v[24:27], a[204:207], v[188:191], v[24:27]
    v_exp_f32 v47, v47
    v_mfma_f32_16x16x32_bf16 v[28:31], a[220:223], v[188:191], 0
    v_cvt_pk_bf16_f32 v42, v44, v45
    v_add_f32 v113, v113, v46
    v_mfma_f32_16x16x32_bf16 v[28:31], a[216:219], v[184:187], v[28:31]
    ds_read_b128 a[200:203], v1 offset:1024
    ds_read_b128 a[204:207], v1 offset:1536
    v_mfma_f32_16x16x32_bf16 v[28:31], a[212:215], v[180:183], v[28:31]
    v_add_f32 v113, v113, v47
    v_cvt_pk_bf16_f32 v43, v46, v47
    v_mfma_f32_16x16x32_bf16 v[28:31], a[208:211], v[176:179], v[28:31]
    v_exp_f32 v16, v16
    v_mfma_f32_16x16x32_bf16 a[32:35], a[224:227], v[40:43], a[32:35]
    v_exp_f32 v17, v17
    v_mfma_f32_16x16x32_bf16 a[36:39], a[228:231], v[40:43], a[36:39]
    ds_read_b128 a[220:223], v1 offset:5632
    ds_read_b128 a[216:219], v1 offset:5120
    v_mfma_f32_16x16x32_bf16 a[40:43], a[232:235], v[40:43], a[40:43]
    v_add_f32 v114, v114, v16
    v_add_f32 v114, v114, v17
    v_mfma_f32_16x16x32_bf16 a[44:47], a[236:239], v[40:43], a[44:47]
    v_exp_f32 v18, v18
    v_mfma_f32_16x16x32_bf16 a[48:51], a[240:243], v[40:43], a[48:51]
    v_exp_f32 v19, v19
    v_mfma_f32_16x16x32_bf16 a[52:55], a[244:247], v[40:43], a[52:55]
    ds_read_b128 a[212:215], v1 offset:4608
    ds_read_b128 a[208:211], v1 offset:4096
    v_mfma_f32_16x16x32_bf16 a[56:59], a[248:251], v[40:43], a[56:59]
    v_cvt_pk_bf16_f32 v16, v16, v17
    v_add_f32 v114, v114, v18
    v_mfma_f32_16x16x32_bf16 a[60:63], a[252:255], v[40:43], a[60:63]
    s_waitcnt lgkmcnt(7)
    v_exp_f32 v20, v20
    v_mfma_f32_16x16x32_bf16 v[32:35], a[192:195], v[160:163], 0
    s_waitcnt lgkmcnt(6)
    v_add_f32 v114, v114, v19
    v_cvt_pk_bf16_f32 v17, v18, v19
    v_mfma_f32_16x16x32_bf16 v[32:35], a[196:199], v[164:167], v[32:35]
    s_waitcnt lgkmcnt(5)
    v_exp_f32 v21, v21
    v_mfma_f32_16x16x32_bf16 v[32:35], a[200:203], v[168:171], v[32:35]
    s_waitcnt lgkmcnt(4)
    v_add_f32 v114, v114, v20
    v_add_f32 v114, v114, v21
    v_mfma_f32_16x16x32_bf16 v[32:35], a[204:207], v[172:175], v[32:35]
    s_waitcnt lgkmcnt(3)
    v_exp_f32 v22, v22
    v_mfma_f32_16x16x32_bf16 v[36:39], a[220:223], v[172:175], 0
    s_waitcnt lgkmcnt(2)
    v_exp_f32 v23, v23
    v_mfma_f32_16x16x32_bf16 v[36:39], a[216:219], v[168:171], v[36:39]
    s_waitcnt lgkmcnt(1)
    v_cvt_pk_bf16_f32 v18, v20, v21
    v_add_f32 v114, v114, v22
    v_mfma_f32_16x16x32_bf16 v[36:39], a[212:215], v[164:167], v[36:39]
    s_waitcnt lgkmcnt(0)
    v_add_f32 v114, v114, v23
    v_cvt_pk_bf16_f32 v19, v22, v23
    v_mfma_f32_16x16x32_bf16 v[36:39], a[208:211], v[160:163], v[36:39]
    v_exp_f32 v24, v24
    v_mfma_f32_16x16x32_bf16 a[64:67], a[224:227], v[16:19], 0
    v_exp_f32 v25, v25
    v_mfma_f32_16x16x32_bf16 a[68:71], a[228:231], v[16:19], 0
    v_add_f32 v115, v115, v24
    v_add_f32 v115, v115, v25
    v_mfma_f32_16x16x32_bf16 a[72:75], a[232:235], v[16:19], 0
    v_exp_f32 v26, v26
    v_mfma_f32_16x16x32_bf16 a[76:79], a[236:239], v[16:19], 0
    v_exp_f32 v27, v27
    v_mfma_f32_16x16x32_bf16 a[80:83], a[240:243], v[16:19], 0
    v_cvt_pk_bf16_f32 v24, v24, v25
    v_add_f32 v115, v115, v26
    v_mfma_f32_16x16x32_bf16 a[84:87], a[244:247], v[16:19], 0
    v_exp_f32 v28, v28
    v_mfma_f32_16x16x32_bf16 a[88:91], a[248:251], v[16:19], 0
    v_add_f32 v115, v115, v27
    v_cvt_pk_bf16_f32 v25, v26, v27
    v_mfma_f32_16x16x32_bf16 a[92:95], a[252:255], v[16:19], 0
    v_exp_f32 v29, v29
    v_mfma_f32_16x16x32_bf16 v[40:43], a[192:195], v[176:179], 0
    v_add_f32 v115, v115, v28
    v_add_f32 v115, v115, v29
    v_mfma_f32_16x16x32_bf16 v[40:43], a[196:199], v[180:183], v[40:43]
    v_exp_f32 v30, v30
    v_mfma_f32_16x16x32_bf16 v[40:43], a[200:203], v[184:187], v[40:43]
    v_exp_f32 v31, v31
    v_mfma_f32_16x16x32_bf16 v[40:43], a[204:207], v[188:191], v[40:43]
    v_cvt_pk_bf16_f32 v26, v28, v29
    v_add_f32 v115, v115, v30
    v_mfma_f32_16x16x32_bf16 v[44:47], a[220:223], v[188:191], 0
    v_add_f32 v115, v115, v31
    v_cvt_pk_bf16_f32 v27, v30, v31
    v_mfma_f32_16x16x32_bf16 v[44:47], a[216:219], v[184:187], v[44:47]
    v_exp_f32 v32, v32
    v_exp_f32 v33, v33
    v_mfma_f32_16x16x32_bf16 v[44:47], a[212:215], v[180:183], v[44:47]
    v_add_f32 v114, v114, v32
    v_add_f32 v114, v114, v33
    v_exp_f32 v34, v34
    v_mfma_f32_16x16x32_bf16 v[44:47], a[208:211], v[176:179], v[44:47]
    v_exp_f32 v35, v35
    v_cvt_pk_bf16_f32 v32, v32, v33
    v_add_f32 v114, v114, v34
    v_mfma_f32_16x16x32_bf16 a[96:99], a[224:227], v[24:27], 0
    ds_read_b64_tr_b16 a[224:225], v2 offset:0
    ds_read_b64_tr_b16 a[226:227], v2 offset:4096
    v_mfma_f32_16x16x32_bf16 a[100:103], a[228:231], v[24:27], 0
    v_exp_f32 v36, v36
    v_add_f32 v114, v114, v35
    v_cvt_pk_bf16_f32 v33, v34, v35
    v_mfma_f32_16x16x32_bf16 a[104:107], a[232:235], v[24:27], 0
    ds_read_b64_tr_b16 a[228:229], v2 offset:256
    ds_read_b64_tr_b16 a[230:231], v2 offset:4352
    v_mfma_f32_16x16x32_bf16 a[108:111], a[236:239], v[24:27], 0
    v_exp_f32 v37, v37
    v_mfma_f32_16x16x32_bf16 a[112:115], a[240:243], v[24:27], 0
    ds_read_b64_tr_b16 a[232:233], v2 offset:512
    ds_read_b64_tr_b16 a[234:235], v2 offset:4608
    v_mfma_f32_16x16x32_bf16 a[116:119], a[244:247], v[24:27], 0
    v_add_f32 v114, v114, v36
    v_add_f32 v114, v114, v37
    v_mfma_f32_16x16x32_bf16 a[120:123], a[248:251], v[24:27], 0
    ds_read_b64_tr_b16 a[236:237], v2 offset:768
    ds_read_b64_tr_b16 a[238:239], v2 offset:4864
    v_mfma_f32_16x16x32_bf16 a[124:127], a[252:255], v[24:27], 0
    ds_read_b64_tr_b16 a[240:241], v2 offset:1024
    ds_read_b64_tr_b16 a[242:243], v2 offset:5120
    s_waitcnt vmcnt(8)
    s_barrier
    ds_read_b128 a[192:195], v1 offset:16384
    ds_read_b128 a[196:199], v1 offset:16896
    ds_read_b128 a[200:203], v1 offset:17408
    ds_read_b128 a[204:207], v1 offset:17920
    ds_read_b128 a[208:211], v1 offset:20480
    ds_read_b128 a[212:215], v1 offset:20992
    ds_read_b128 a[216:219], v1 offset:21504
    ds_read_b128 a[220:223], v1 offset:22016
    s_waitcnt lgkmcnt(7)
    v_mfma_f32_16x16x32_bf16 v[16:19], a[192:195], v[128:131], 0
    s_waitcnt lgkmcnt(6)
    ds_read_b64_tr_b16 a[244:245], v2 offset:1280
    ds_read_b64_tr_b16 a[246:247], v2 offset:5376
    v_mfma_f32_16x16x32_bf16 v[16:19], a[196:199], v[132:135], v[16:19]
    s_waitcnt lgkmcnt(7)
    ds_read_b64_tr_b16 a[248:249], v2 offset:1536
    ds_read_b64_tr_b16 a[250:251], v2 offset:5632
    v_mfma_f32_16x16x32_bf16 v[16:19], a[200:203], v[136:139], v[16:19]
    s_waitcnt lgkmcnt(8)
    ds_read_b64_tr_b16 a[252:253], v2 offset:1792
    ds_read_b64_tr_b16 a[254:255], v2 offset:5888
    v_mfma_f32_16x16x32_bf16 v[16:19], a[204:207], v[140:143], v[16:19]
    s_waitcnt lgkmcnt(6)
    v_exp_f32 v38, v38
    v_mfma_f32_16x16x32_bf16 v[20:23], a[220:223], v[140:143], 0
    v_exp_f32 v39, v39
    v_mfma_f32_16x16x32_bf16 v[20:23], a[216:219], v[136:139], v[20:23]
    v_cvt_pk_bf16_f32 v34, v36, v37
    v_add_f32 v114, v114, v38
    v_mfma_f32_16x16x32_bf16 v[20:23], a[212:215], v[132:135], v[20:23]
    v_add_f32 v114, v114, v39
    v_cvt_pk_bf16_f32 v35, v38, v39
    v_mfma_f32_16x16x32_bf16 v[20:23], a[208:211], v[128:131], v[20:23]
    v_exp_f32 v40, v40
    v_exp_f32 v41, v41
    v_mfma_f32_16x16x32_bf16 a[64:67], a[224:227], v[32:35], a[64:67]
    v_add_f32 v115, v115, v40
    v_add_f32 v115, v115, v41
    v_exp_f32 v42, v42
    v_mfma_f32_16x16x32_bf16 a[68:71], a[228:231], v[32:35], a[68:71]
    v_exp_f32 v43, v43
    v_mfma_f32_16x16x32_bf16 a[72:75], a[232:235], v[32:35], a[72:75]
    v_cvt_pk_bf16_f32 v40, v40, v41
    v_add_f32 v115, v115, v42
    v_mfma_f32_16x16x32_bf16 a[76:79], a[236:239], v[32:35], a[76:79]
    v_exp_f32 v44, v44
    v_mfma_f32_16x16x32_bf16 a[80:83], a[240:243], v[32:35], a[80:83]
    s_waitcnt lgkmcnt(4)
    v_add_f32 v115, v115, v43
    v_cvt_pk_bf16_f32 v41, v42, v43
    v_mfma_f32_16x16x32_bf16 a[84:87], a[244:247], v[32:35], a[84:87]
    s_waitcnt lgkmcnt(2)
    v_exp_f32 v45, v45
    v_mfma_f32_16x16x32_bf16 a[88:91], a[248:251], v[32:35], a[88:91]
    s_waitcnt lgkmcnt(0)
    v_add_f32 v115, v115, v44
    v_add_f32 v115, v115, v45
    v_mfma_f32_16x16x32_bf16 a[92:95], a[252:255], v[32:35], a[92:95]
    v_add_u32 v5, 0x1000, v5
    s_add_u32 m0, s26, 49152
    v_exp_f32 v46, v46
    v_cvt_pk_bf16_f32 v42, v44, v45
    v_mfma_f32_16x16x32_bf16 v[24:27], a[192:195], v[144:147], 0
    buffer_load_dwordx4 v5, s[8:11], 0 offen nt lds
    v_mfma_f32_16x16x32_bf16 v[24:27], a[196:199], v[148:151], v[24:27]
    s_add_u32 m0, s26, 50048
    v_exp_f32 v47, v47
    v_mfma_f32_16x16x32_bf16 v[24:27], a[200:203], v[152:155], v[24:27]
    buffer_load_dwordx4 v5, s[8:11], 0 offen offset:128 nt lds
    v_mfma_f32_16x16x32_bf16 v[24:27], a[204:207], v[156:159], v[24:27]
    s_add_u32 m0, s26, 112640
    v_add_f32 v115, v115, v46
    v_add_f32 v115, v115, v47
    v_mfma_f32_16x16x32_bf16 v[28:31], a[220:223], v[156:159], 0
    buffer_load_dwordx4 v5, s[8:11], 0 offen offset:2048 nt lds
    v_mfma_f32_16x16x32_bf16 v[28:31], a[216:219], v[152:155], v[28:31]
    s_add_u32 m0, s26, 113536
    v_exp_f32 v16, v16
    v_mfma_f32_16x16x32_bf16 v[28:31], a[212:215], v[148:151], v[28:31]
    buffer_load_dwordx4 v5, s[8:11], 0 offen offset:2176 nt lds
    v_mfma_f32_16x16x32_bf16 v[28:31], a[208:211], v[144:147], v[28:31]
    v_cvt_pk_bf16_f32 v43, v46, v47
    v_add_f32 v112, v112, v16
    s_nop 0
    v_mfma_f32_16x16x32_bf16 a[96:99], a[224:227], v[40:43], a[96:99]
    ds_read_b64_tr_b16 a[224:225], v2 offset:16384
    ds_read_b64_tr_b16 a[226:227], v2 offset:20480
    v_mfma_f32_16x16x32_bf16 a[100:103], a[228:231], v[40:43], a[100:103]
    v_exp_f32 v17, v17
    v_exp_f32 v18, v18
    v_mfma_f32_16x16x32_bf16 a[104:107], a[232:235], v[40:43], a[104:107]
    ds_read_b64_tr_b16 a[228:229], v2 offset:16640
    ds_read_b64_tr_b16 a[230:231], v2 offset:20736
    v_mfma_f32_16x16x32_bf16 a[108:111], a[236:239], v[40:43], a[108:111]
    v_add_f32 v112, v112, v17
    v_exp_f32 v19, v19
    v_cvt_pk_bf16_f32 v16, v16, v17
    v_mfma_f32_16x16x32_bf16 a[112:115], a[240:243], v[40:43], a[112:115]
    ds_read_b64_tr_b16 a[232:233], v2 offset:16896
    ds_read_b64_tr_b16 a[234:235], v2 offset:20992
    v_mfma_f32_16x16x32_bf16 a[116:119], a[244:247], v[40:43], a[116:119]
    v_add_f32 v112, v112, v18
    v_exp_f32 v20, v20
    v_add_f32 v112, v112, v19
    v_mfma_f32_16x16x32_bf16 a[120:123], a[248:251], v[40:43], a[120:123]
    ds_read_b64_tr_b16 a[236:237], v2 offset:17152
    ds_read_b64_tr_b16 a[238:239], v2 offset:21248
    v_mfma_f32_16x16x32_bf16 a[124:127], a[252:255], v[40:43], a[124:127]
    v_cvt_pk_bf16_f32 v17, v18, v19
    v_exp_f32 v21, v21
    v_add_f32 v112, v112, v20
    v_mfma_f32_16x16x32_bf16 v[32:35], a[192:195], v[160:163], 0
    ds_read_b64_tr_b16 a[240:241], v2 offset:17408
    ds_read_b64_tr_b16 a[242:243], v2 offset:21504
    v_mfma_f32_16x16x32_bf16 v[32:35], a[196:199], v[164:167], v[32:35]
    v_add_f32 v112, v112, v21
    v_exp_f32 v22, v22
    v_cvt_pk_bf16_f32 v18, v20, v21
    v_mfma_f32_16x16x32_bf16 v[32:35], a[200:203], v[168:171], v[32:35]
    ds_read_b64_tr_b16 a[244:245], v2 offset:17664
    ds_read_b64_tr_b16 a[246:247], v2 offset:21760
    v_mfma_f32_16x16x32_bf16 v[32:35], a[204:207], v[172:175], v[32:35]
    v_exp_f32 v23, v23
    v_add_f32 v112, v112, v22
    v_add_f32 v112, v112, v23
    v_mfma_f32_16x16x32_bf16 v[36:39], a[220:223], v[172:175], 0
    ds_read_b64_tr_b16 a[248:249], v2 offset:17920
    ds_read_b64_tr_b16 a[250:251], v2 offset:22016
    v_mfma_f32_16x16x32_bf16 v[36:39], a[216:219], v[168:171], v[36:39]
    v_exp_f32 v24, v24
    v_mfma_f32_16x16x32_bf16 v[36:39], a[212:215], v[164:167], v[36:39]
    ds_read_b64_tr_b16 a[252:253], v2 offset:18176
    ds_read_b64_tr_b16 a[254:255], v2 offset:22272
    v_mfma_f32_16x16x32_bf16 v[36:39], a[208:211], v[160:163], v[36:39]
    s_waitcnt lgkmcnt(14)
    v_cvt_pk_bf16_f32 v19, v22, v23
    v_add_f32 v113, v113, v24
    s_nop 0
    v_mfma_f32_16x16x32_bf16 a[0:3], a[224:227], v[16:19], a[0:3]
    s_waitcnt lgkmcnt(12)
    v_exp_f32 v25, v25
    v_exp_f32 v26, v26
    v_mfma_f32_16x16x32_bf16 a[4:7], a[228:231], v[16:19], a[4:7]
    s_waitcnt lgkmcnt(10)
    v_add_f32 v113, v113, v25
    v_cvt_pk_bf16_f32 v24, v24, v25
    v_mfma_f32_16x16x32_bf16 a[8:11], a[232:235], v[16:19], a[8:11]
    s_waitcnt lgkmcnt(8)
    v_exp_f32 v27, v27
    v_mfma_f32_16x16x32_bf16 a[12:15], a[236:239], v[16:19], a[12:15]
    s_waitcnt lgkmcnt(6)
    v_add_f32 v113, v113, v26
    v_add_f32 v113, v113, v27
    v_mfma_f32_16x16x32_bf16 a[16:19], a[240:243], v[16:19], a[16:19]
    s_waitcnt lgkmcnt(4)
    v_exp_f32 v28, v28
    v_mfma_f32_16x16x32_bf16 a[20:23], a[244:247], v[16:19], a[20:23]
    s_waitcnt lgkmcnt(2)
    v_cvt_pk_bf16_f32 v25, v26, v27
    v_add_f32 v113, v113, v28
    v_mfma_f32_16x16x32_bf16 a[24:27], a[248:251], v[16:19], a[24:27]
    s_waitcnt lgkmcnt(0)
    v_exp_f32 v29, v29
    v_mfma_f32_16x16x32_bf16 a[28:31], a[252:255], v[16:19], a[28:31]
    v_add_f32 v113, v113, v29
    v_cvt_pk_bf16_f32 v26, v28, v29
    v_mfma_f32_16x16x32_bf16 v[40:43], a[192:195], v[176:179], 0
    s_waitcnt vmcnt(8)
    v_exp_f32 v30, v30
    v_mfma_f32_16x16x32_bf16 v[40:43], a[196:199], v[180:183], v[40:43]
    ds_read_b128 v[192:195], v122 offset:32768
    ds_read_b128 v[196:199], v122 offset:33280
    v_mfma_f32_16x16x32_bf16 v[40:43], a[200:203], v[184:187], v[40:43]
    v_exp_f32 v31, v31
    v_mfma_f32_16x16x32_bf16 v[40:43], a[204:207], v[188:191], v[40:43]
    ds_read_b128 v[200:203], v122 offset:33792
    ds_read_b128 v[204:207], v122 offset:34304
    v_mfma_f32_16x16x32_bf16 v[44:47], a[220:223], v[188:191], 0
    v_add_u32 v5, 0x1000, v5
    s_add_u32 m0, s26, 57344
    v_add_f32 v113, v113, v30
    v_mfma_f32_16x16x32_bf16 v[44:47], a[216:219], v[184:187], v[44:47]
    buffer_load_dwordx4 v5, s[8:11], 0 offen nt lds
    v_mfma_f32_16x16x32_bf16 v[44:47], a[212:215], v[180:183], v[44:47]
    s_add_u32 m0, s26, 58240
    v_add_f32 v113, v113, v31
    v_cvt_pk_bf16_f32 v27, v30, v31
    v_mfma_f32_16x16x32_bf16 v[44:47], a[208:211], v[176:179], v[44:47]
    buffer_load_dwordx4 v5, s[8:11], 0 offen offset:128 nt lds
    v_mfma_f32_16x16x32_bf16 a[32:35], a[224:227], v[24:27], a[32:35]
    s_add_u32 m0, s26, 120832
    v_exp_f32 v32, v32
    v_exp_f32 v33, v33
    v_mfma_f32_16x16x32_bf16 a[36:39], a[228:231], v[24:27], a[36:39]
    buffer_load_dwordx4 v5, s[8:11], 0 offen offset:2048 nt lds
    v_mfma_f32_16x16x32_bf16 a[40:43], a[232:235], v[24:27], a[40:43]
    s_add_u32 m0, s26, 121728
    v_add_f32 v114, v114, v32
    v_add_f32 v114, v114, v33
    v_exp_f32 v34, v34
    v_mfma_f32_16x16x32_bf16 a[44:47], a[236:239], v[24:27], a[44:47]
    buffer_load_dwordx4 v5, s[8:11], 0 offen offset:2176 nt lds
    v_mfma_f32_16x16x32_bf16 a[48:51], a[240:243], v[24:27], a[48:51]
    s_add_u32 m0, s26, 24576
    v_exp_f32 v35, v35
    v_cvt_pk_bf16_f32 v32, v32, v33
    v_add_f32 v114, v114, v34
    v_mfma_f32_16x16x32_bf16 a[52:55], a[244:247], v[24:27], a[52:55]
    buffer_load_dwordx4 v3, s[12:15], s25 offen nt lds
    v_mfma_f32_16x16x32_bf16 a[56:59], a[248:251], v[24:27], a[56:59]
    v_exp_f32 v36, v36
    v_add_f32 v114, v114, v35
    v_cvt_pk_bf16_f32 v33, v34, v35
    v_mfma_f32_16x16x32_bf16 a[60:63], a[252:255], v[24:27], a[60:63]
    v_exp_f32 v37, v37
    v_add_f32 v114, v114, v36
    v_add_f32 v114, v114, v37
    s_waitcnt lgkmcnt(3)
    v_lshlrev_b32 v8, 16, v192
    v_lshlrev_b32 v10, 16, v193
    v_lshlrev_b32 v12, 16, v194
    v_lshlrev_b32 v14, 16, v195
    v_and_b32 v9, 0xffff0000, v192
    v_and_b32 v11, 0xffff0000, v193
    v_and_b32 v13, 0xffff0000, v194
    v_and_b32 v15, 0xffff0000, v195
    v_pk_mul_f32 v[8:9], v[8:9], s[30:31]
    v_pk_mul_f32 v[10:11], v[10:11], s[30:31]
    v_pk_mul_f32 v[12:13], v[12:13], s[30:31]
    v_pk_mul_f32 v[14:15], v[14:15], s[30:31]
    v_cvt_pk_bf16_f32 v192, v8, v9
    v_cvt_pk_bf16_f32 v193, v10, v11
    v_cvt_pk_bf16_f32 v194, v12, v13
    v_cvt_pk_bf16_f32 v195, v14, v15
    s_waitcnt lgkmcnt(2)
    v_lshlrev_b32 v8, 16, v196
    v_lshlrev_b32 v10, 16, v197
    v_lshlrev_b32 v12, 16, v198
    v_lshlrev_b32 v14, 16, v199
    v_and_b32 v9, 0xffff0000, v196
    v_and_b32 v11, 0xffff0000, v197
    v_and_b32 v13, 0xffff0000, v198
    v_and_b32 v15, 0xffff0000, v199
    v_pk_mul_f32 v[8:9], v[8:9], s[30:31]
    v_pk_mul_f32 v[10:11], v[10:11], s[30:31]
    v_pk_mul_f32 v[12:13], v[12:13], s[30:31]
    v_pk_mul_f32 v[14:15], v[14:15], s[30:31]
    v_cvt_pk_bf16_f32 v196, v8, v9
    v_cvt_pk_bf16_f32 v197, v10, v11
    v_cvt_pk_bf16_f32 v198, v12, v13
    v_cvt_pk_bf16_f32 v199, v14, v15
    s_waitcnt lgkmcnt(1)
    v_lshlrev_b32 v8, 16, v200
    v_lshlrev_b32 v10, 16, v201
    v_lshlrev_b32 v12, 16, v202
    v_lshlrev_b32 v14, 16, v203
    v_and_b32 v9, 0xffff0000, v200
    v_and_b32 v11, 0xffff0000, v201
    v_and_b32 v13, 0xffff0000, v202
    v_and_b32 v15, 0xffff0000, v203
    v_pk_mul_f32 v[8:9], v[8:9], s[30:31]
    v_pk_mul_f32 v[10:11], v[10:11], s[30:31]
    v_pk_mul_f32 v[12:13], v[12:13], s[30:31]
    v_pk_mul_f32 v[14:15], v[14:15], s[30:31]
    v_cvt_pk_bf16_f32 v200, v8, v9
    v_cvt_pk_bf16_f32 v201, v10, v11
    v_cvt_pk_bf16_f32 v202, v12, v13
    v_cvt_pk_bf16_f32 v203, v14, v15
    s_waitcnt lgkmcnt(0)
    v_lshlrev_b32 v8, 16, v204
    v_lshlrev_b32 v10, 16, v205
    v_lshlrev_b32 v12, 16, v206
    v_lshlrev_b32 v14, 16, v207
    v_and_b32 v9, 0xffff0000, v204
    v_and_b32 v11, 0xffff0000, v205
    v_and_b32 v13, 0xffff0000, v206
    v_and_b32 v15, 0xffff0000, v207
    v_pk_mul_f32 v[8:9], v[8:9], s[30:31]
    v_pk_mul_f32 v[10:11], v[10:11], s[30:31]
    v_pk_mul_f32 v[12:13], v[12:13], s[30:31]
    v_pk_mul_f32 v[14:15], v[14:15], s[30:31]
    v_cvt_pk_bf16_f32 v204, v8, v9
    v_cvt_pk_bf16_f32 v205, v10, v11
    v_cvt_pk_bf16_f32 v206, v12, v13
    v_cvt_pk_bf16_f32 v207, v14, v15
    v_mfma_f32_16x16x32_bf16 v[16:19], a[192:195], v[192:195], 0
    s_waitcnt vmcnt(9)
    v_exp_f32 v38, v38
    v_mfma_f32_16x16x32_bf16 v[16:19], a[196:199], v[196:199], v[16:19]
    ds_read_b128 v[208:211], v122 offset:40960
    ds_read_b128 v[212:215], v122 offset:41472
    v_mfma_f32_16x16x32_bf16 v[16:19], a[200:203], v[200:203], v[16:19]
    v_exp_f32 v39, v39
    v_mfma_f32_16x16x32_bf16 v[16:19], a[204:207], v[204:207], v[16:19]
    ds_read_b128 v[216:219], v122 offset:41984
    ds_read_b128 v[220:223], v122 offset:42496
    v_mfma_f32_16x16x32_bf16 v[20:23], a[220:223], v[204:207], 0
    s_add_u32 m0, s26, 25472
    v_cvt_pk_bf16_f32 v34, v36, v37
    v_add_f32 v114, v114, v38
    v_mfma_f32_16x16x32_bf16 v[20:23], a[216:219], v[200:203], v[20:23]
    buffer_load_dwordx4 v3, s[12:15], s25 offen offset:128 nt lds
    v_mfma_f32_16x16x32_bf16 v[20:23], a[212:215], v[196:199], v[20:23]
    s_add_u32 m0, s26, 90112
    v_add_f32 v114, v114, v39
    v_cvt_pk_bf16_f32 v35, v38, v39
    v_mfma_f32_16x16x32_bf16 v[20:23], a[208:211], v[192:195], v[20:23]
    buffer_load_dwordx4 v4, s[16:19], s25 offen nt lds
    v_mfma_f32_16x16x32_bf16 a[64:67], a[224:227], v[32:35], a[64:67]
    s_add_u32 m0, s26, 91008
    v_exp_f32 v40, v40
    v_exp_f32 v41, v41
    v_mfma_f32_16x16x32_bf16 a[68:71], a[228:231], v[32:35], a[68:71]
    buffer_load_dwordx4 v4, s[16:19], s25 offen offset:128 nt lds
    s_add_u32 s25, s25, 8192
    v_mfma_f32_16x16x32_bf16 a[72:75], a[232:235], v[32:35], a[72:75]
    v_add_f32 v115, v115, v40
    v_add_f32 v115, v115, v41
    v_exp_f32 v42, v42
    v_mfma_f32_16x16x32_bf16 a[76:79], a[236:239], v[32:35], a[76:79]
    v_exp_f32 v43, v43
    v_mfma_f32_16x16x32_bf16 a[80:83], a[240:243], v[32:35], a[80:83]
    v_cvt_pk_bf16_f32 v40, v40, v41
    v_add_f32 v115, v115, v42
    v_mfma_f32_16x16x32_bf16 a[84:87], a[244:247], v[32:35], a[84:87]
    v_exp_f32 v44, v44
    v_mfma_f32_16x16x32_bf16 a[88:91], a[248:251], v[32:35], a[88:91]
    v_add_f32 v115, v115, v43
    v_cvt_pk_bf16_f32 v41, v42, v43
    v_mfma_f32_16x16x32_bf16 a[92:95], a[252:255], v[32:35], a[92:95]
    v_exp_f32 v45, v45
    s_waitcnt lgkmcnt(3)
    v_lshlrev_b32 v8, 16, v208
    v_lshlrev_b32 v10, 16, v209
    v_lshlrev_b32 v12, 16, v210
    v_lshlrev_b32 v14, 16, v211
    v_and_b32 v9, 0xffff0000, v208
    v_and_b32 v11, 0xffff0000, v209
    v_and_b32 v13, 0xffff0000, v210
    v_and_b32 v15, 0xffff0000, v211
    v_pk_mul_f32 v[8:9], v[8:9], s[30:31]
    v_pk_mul_f32 v[10:11], v[10:11], s[30:31]
    v_pk_mul_f32 v[12:13], v[12:13], s[30:31]
    v_pk_mul_f32 v[14:15], v[14:15], s[30:31]
    v_cvt_pk_bf16_f32 v208, v8, v9
    v_cvt_pk_bf16_f32 v209, v10, v11
    v_cvt_pk_bf16_f32 v210, v12, v13
    v_cvt_pk_bf16_f32 v211, v14, v15
    s_waitcnt lgkmcnt(2)
    v_lshlrev_b32 v8, 16, v212
    v_lshlrev_b32 v10, 16, v213
    v_lshlrev_b32 v12, 16, v214
    v_lshlrev_b32 v14, 16, v215
    v_and_b32 v9, 0xffff0000, v212
    v_and_b32 v11, 0xffff0000, v213
    v_and_b32 v13, 0xffff0000, v214
    v_and_b32 v15, 0xffff0000, v215
    v_pk_mul_f32 v[8:9], v[8:9], s[30:31]
    v_pk_mul_f32 v[10:11], v[10:11], s[30:31]
    v_pk_mul_f32 v[12:13], v[12:13], s[30:31]
    v_pk_mul_f32 v[14:15], v[14:15], s[30:31]
    v_cvt_pk_bf16_f32 v212, v8, v9
    v_cvt_pk_bf16_f32 v213, v10, v11
    v_cvt_pk_bf16_f32 v214, v12, v13
    v_cvt_pk_bf16_f32 v215, v14, v15
    s_waitcnt lgkmcnt(1)
    v_lshlrev_b32 v8, 16, v216
    v_lshlrev_b32 v10, 16, v217
    v_lshlrev_b32 v12, 16, v218
    v_lshlrev_b32 v14, 16, v219
    v_and_b32 v9, 0xffff0000, v216
    v_and_b32 v11, 0xffff0000, v217
    v_and_b32 v13, 0xffff0000, v218
    v_and_b32 v15, 0xffff0000, v219
    v_pk_mul_f32 v[8:9], v[8:9], s[30:31]
    v_pk_mul_f32 v[10:11], v[10:11], s[30:31]
    v_pk_mul_f32 v[12:13], v[12:13], s[30:31]
    v_pk_mul_f32 v[14:15], v[14:15], s[30:31]
    v_cvt_pk_bf16_f32 v216, v8, v9
    v_cvt_pk_bf16_f32 v217, v10, v11
    v_cvt_pk_bf16_f32 v218, v12, v13
    v_cvt_pk_bf16_f32 v219, v14, v15
    s_waitcnt lgkmcnt(0)
    v_lshlrev_b32 v8, 16, v220
    v_lshlrev_b32 v10, 16, v221
    v_lshlrev_b32 v12, 16, v222
    v_lshlrev_b32 v14, 16, v223
    v_and_b32 v9, 0xffff0000, v220
    v_and_b32 v11, 0xffff0000, v221
    v_and_b32 v13, 0xffff0000, v222
    v_and_b32 v15, 0xffff0000, v223
    v_pk_mul_f32 v[8:9], v[8:9], s[30:31]
    v_pk_mul_f32 v[10:11], v[10:11], s[30:31]
    v_pk_mul_f32 v[12:13], v[12:13], s[30:31]
    v_pk_mul_f32 v[14:15], v[14:15], s[30:31]
    v_cvt_pk_bf16_f32 v220, v8, v9
    v_cvt_pk_bf16_f32 v221, v10, v11
    v_cvt_pk_bf16_f32 v222, v12, v13
    v_cvt_pk_bf16_f32 v223, v14, v15
    v_mfma_f32_16x16x32_bf16 v[24:27], a[192:195], v[208:211], 0
    s_waitcnt vmcnt(8)
    v_add_f32 v115, v115, v44
    v_add_f32 v115, v115, v45
    v_mfma_f32_16x16x32_bf16 v[24:27], a[196:199], v[212:215], v[24:27]
    ds_read_b128 v[224:227], v122 offset:49152
    ds_read_b128 v[228:231], v122 offset:49664
    v_mfma_f32_16x16x32_bf16 v[24:27], a[200:203], v[216:219], v[24:27]
    v_exp_f32 v46, v46
    v_mfma_f32_16x16x32_bf16 v[24:27], a[204:207], v[220:223], v[24:27]
    ds_read_b128 v[232:235], v122 offset:50176
    ds_read_b128 v[236:239], v122 offset:50688
    v_mfma_f32_16x16x32_bf16 v[28:31], a[220:223], v[220:223], 0
    v_exp_f32 v47, v47
    v_mfma_f32_16x16x32_bf16 v[28:31], a[216:219], v[216:219], v[28:31]
    v_cvt_pk_bf16_f32 v42, v44, v45
    v_add_f32 v115, v115, v46
    v_mfma_f32_16x16x32_bf16 v[28:31], a[212:215], v[212:215], v[28:31]
    v_add_f32 v115, v115, v47
    v_cvt_pk_bf16_f32 v43, v46, v47
    v_mfma_f32_16x16x32_bf16 v[28:31], a[208:211], v[208:211], v[28:31]
    v_exp_f32 v16, v16
    v_mfma_f32_16x16x32_bf16 a[96:99], a[224:227], v[40:43], a[96:99]
    v_exp_f32 v17, v17
    v_mfma_f32_16x16x32_bf16 a[100:103], a[228:231], v[40:43], a[100:103]
    v_add_f32 v116, v116, v16
    v_add_f32 v116, v116, v17
    v_mfma_f32_16x16x32_bf16 a[104:107], a[232:235], v[40:43], a[104:107]
    v_exp_f32 v18, v18
    v_mfma_f32_16x16x32_bf16 a[108:111], a[236:239], v[40:43], a[108:111]
    v_exp_f32 v19, v19
    v_mfma_f32_16x16x32_bf16 a[112:115], a[240:243], v[40:43], a[112:115]
    v_cvt_pk_bf16_f32 v16, v16, v17
    v_add_f32 v116, v116, v18
    v_mfma_f32_16x16x32_bf16 a[116:119], a[244:247], v[40:43], a[116:119]
    v_exp_f32 v20, v20
    v_mfma_f32_16x16x32_bf16 a[120:123], a[248:251], v[40:43], a[120:123]
    v_add_f32 v116, v116, v19
    v_cvt_pk_bf16_f32 v17, v18, v19
    v_mfma_f32_16x16x32_bf16 a[124:127], a[252:255], v[40:43], a[124:127]
    v_exp_f32 v21, v21
    s_waitcnt lgkmcnt(3)
    v_lshlrev_b32 v8, 16, v224
    v_lshlrev_b32 v10, 16, v225
    v_lshlrev_b32 v12, 16, v226
    v_lshlrev_b32 v14, 16, v227
    v_and_b32 v9, 0xffff0000, v224
    v_and_b32 v11, 0xffff0000, v225
    v_and_b32 v13, 0xffff0000, v226
    v_and_b32 v15, 0xffff0000, v227
    v_pk_mul_f32 v[8:9], v[8:9], s[30:31]
    v_pk_mul_f32 v[10:11], v[10:11], s[30:31]
    v_pk_mul_f32 v[12:13], v[12:13], s[30:31]
    v_pk_mul_f32 v[14:15], v[14:15], s[30:31]
    v_cvt_pk_bf16_f32 v224, v8, v9
    v_cvt_pk_bf16_f32 v225, v10, v11
    v_cvt_pk_bf16_f32 v226, v12, v13
    v_cvt_pk_bf16_f32 v227, v14, v15
    s_waitcnt lgkmcnt(2)
    v_lshlrev_b32 v8, 16, v228
    v_lshlrev_b32 v10, 16, v229
    v_lshlrev_b32 v12, 16, v230
    v_lshlrev_b32 v14, 16, v231
    v_and_b32 v9, 0xffff0000, v228
    v_and_b32 v11, 0xffff0000, v229
    v_and_b32 v13, 0xffff0000, v230
    v_and_b32 v15, 0xffff0000, v231
    v_pk_mul_f32 v[8:9], v[8:9], s[30:31]
    v_pk_mul_f32 v[10:11], v[10:11], s[30:31]
    v_pk_mul_f32 v[12:13], v[12:13], s[30:31]
    v_pk_mul_f32 v[14:15], v[14:15], s[30:31]
    v_cvt_pk_bf16_f32 v228, v8, v9
    v_cvt_pk_bf16_f32 v229, v10, v11
    v_cvt_pk_bf16_f32 v230, v12, v13
    v_cvt_pk_bf16_f32 v231, v14, v15
    s_waitcnt lgkmcnt(1)
    v_lshlrev_b32 v8, 16, v232
    v_lshlrev_b32 v10, 16, v233
    v_lshlrev_b32 v12, 16, v234
    v_lshlrev_b32 v14, 16, v235
    v_and_b32 v9, 0xffff0000, v232
    v_and_b32 v11, 0xffff0000, v233
    v_and_b32 v13, 0xffff0000, v234
    v_and_b32 v15, 0xffff0000, v235
    v_pk_mul_f32 v[8:9], v[8:9], s[30:31]
    v_pk_mul_f32 v[10:11], v[10:11], s[30:31]
    v_pk_mul_f32 v[12:13], v[12:13], s[30:31]
    v_pk_mul_f32 v[14:15], v[14:15], s[30:31]
    v_cvt_pk_bf16_f32 v232, v8, v9
    v_cvt_pk_bf16_f32 v233, v10, v11
    v_cvt_pk_bf16_f32 v234, v12, v13
    v_cvt_pk_bf16_f32 v235, v14, v15
    s_waitcnt lgkmcnt(0)
    v_lshlrev_b32 v8, 16, v236
    v_lshlrev_b32 v10, 16, v237
    v_lshlrev_b32 v12, 16, v238
    v_lshlrev_b32 v14, 16, v239
    v_and_b32 v9, 0xffff0000, v236
    v_and_b32 v11, 0xffff0000, v237
    v_and_b32 v13, 0xffff0000, v238
    v_and_b32 v15, 0xffff0000, v239
    v_pk_mul_f32 v[8:9], v[8:9], s[30:31]
    v_pk_mul_f32 v[10:11], v[10:11], s[30:31]
    v_pk_mul_f32 v[12:13], v[12:13], s[30:31]
    v_pk_mul_f32 v[14:15], v[14:15], s[30:31]
    v_cvt_pk_bf16_f32 v236, v8, v9
    v_cvt_pk_bf16_f32 v237, v10, v11
    v_cvt_pk_bf16_f32 v238, v12, v13
    v_cvt_pk_bf16_f32 v239, v14, v15
    v_mfma_f32_16x16x32_bf16 v[32:35], a[192:195], v[224:227], 0
    s_waitcnt vmcnt(4)
    v_add_f32 v116, v116, v20
    v_add_f32 v116, v116, v21
    v_mfma_f32_16x16x32_bf16 v[32:35], a[196:199], v[228:231], v[32:35]
    ds_read_b128 v[240:243], v122 offset:57344
    ds_read_b128 v[244:247], v122 offset:57856
    v_mfma_f32_16x16x32_bf16 v[32:35], a[200:203], v[232:235], v[32:35]
    v_exp_f32 v22, v22
    v_mfma_f32_16x16x32_bf16 v[32:35], a[204:207], v[236:239], v[32:35]
    ds_read_b128 v[248:251], v122 offset:58368
    ds_read_b128 v[252:255], v122 offset:58880
    v_mfma_f32_16x16x32_bf16 v[36:39], a[220:223], v[236:239], 0
    v_exp_f32 v23, v23
    v_mfma_f32_16x16x32_bf16 v[36:39], a[216:219], v[232:235], v[36:39]
    v_cvt_pk_bf16_f32 v18, v20, v21
    v_add_f32 v116, v116, v22
    v_mfma_f32_16x16x32_bf16 v[36:39], a[212:215], v[228:231], v[36:39]
    v_add_f32 v116, v116, v23
    v_cvt_pk_bf16_f32 v19, v22, v23
    v_mfma_f32_16x16x32_bf16 v[36:39], a[208:211], v[224:227], v[36:39]
    v_exp_f32 v24, v24
    v_mfma_f32_16x16x32_bf16 a[128:131], a[224:227], v[16:19], 0
    v_exp_f32 v25, v25
    v_mfma_f32_16x16x32_bf16 a[132:135], a[228:231], v[16:19], 0
    v_add_f32 v117, v117, v24
    v_add_f32 v117, v117, v25
    v_mfma_f32_16x16x32_bf16 a[136:139], a[232:235], v[16:19], 0
    v_exp_f32 v26, v26
    v_mfma_f32_16x16x32_bf16 a[140:143], a[236:239], v[16:19], 0
    v_exp_f32 v27, v27
    v_mfma_f32_16x16x32_bf16 a[144:147], a[240:243], v[16:19], 0
    v_cvt_pk_bf16_f32 v24, v24, v25
    v_add_f32 v117, v117, v26
    v_mfma_f32_16x16x32_bf16 a[148:151], a[244:247], v[16:19], 0
    v_exp_f32 v28, v28
    v_mfma_f32_16x16x32_bf16 a[152:155], a[248:251], v[16:19], 0
    v_add_f32 v117, v117, v27
    v_cvt_pk_bf16_f32 v25, v26, v27
    v_mfma_f32_16x16x32_bf16 a[156:159], a[252:255], v[16:19], 0
    v_exp_f32 v29, v29
    s_waitcnt lgkmcnt(3)
    v_lshlrev_b32 v8, 16, v240
    v_lshlrev_b32 v10, 16, v241
    v_lshlrev_b32 v12, 16, v242
    v_lshlrev_b32 v14, 16, v243
    v_and_b32 v9, 0xffff0000, v240
    v_and_b32 v11, 0xffff0000, v241
    v_and_b32 v13, 0xffff0000, v242
    v_and_b32 v15, 0xffff0000, v243
    v_pk_mul_f32 v[8:9], v[8:9], s[30:31]
    v_pk_mul_f32 v[10:11], v[10:11], s[30:31]
    v_pk_mul_f32 v[12:13], v[12:13], s[30:31]
    v_pk_mul_f32 v[14:15], v[14:15], s[30:31]
    v_cvt_pk_bf16_f32 v240, v8, v9
    v_cvt_pk_bf16_f32 v241, v10, v11
    v_cvt_pk_bf16_f32 v242, v12, v13
    v_cvt_pk_bf16_f32 v243, v14, v15
    s_waitcnt lgkmcnt(2)
    v_lshlrev_b32 v8, 16, v244
    v_lshlrev_b32 v10, 16, v245
    v_lshlrev_b32 v12, 16, v246
    v_lshlrev_b32 v14, 16, v247
    v_and_b32 v9, 0xffff0000, v244
    v_and_b32 v11, 0xffff0000, v245
    v_and_b32 v13, 0xffff0000, v246
    v_and_b32 v15, 0xffff0000, v247
    v_pk_mul_f32 v[8:9], v[8:9], s[30:31]
    v_pk_mul_f32 v[10:11], v[10:11], s[30:31]
    v_pk_mul_f32 v[12:13], v[12:13], s[30:31]
    v_pk_mul_f32 v[14:15], v[14:15], s[30:31]
    v_cvt_pk_bf16_f32 v244, v8, v9
    v_cvt_pk_bf16_f32 v245, v10, v11
    v_cvt_pk_bf16_f32 v246, v12, v13
    v_cvt_pk_bf16_f32 v247, v14, v15
    s_waitcnt lgkmcnt(1)
    v_lshlrev_b32 v8, 16, v248
    v_lshlrev_b32 v10, 16, v249
    v_lshlrev_b32 v12, 16, v250
    v_lshlrev_b32 v14, 16, v251
    v_and_b32 v9, 0xffff0000, v248
    v_and_b32 v11, 0xffff0000, v249
    v_and_b32 v13, 0xffff0000, v250
    v_and_b32 v15, 0xffff0000, v251
    v_pk_mul_f32 v[8:9], v[8:9], s[30:31]
    v_pk_mul_f32 v[10:11], v[10:11], s[30:31]
    v_pk_mul_f32 v[12:13], v[12:13], s[30:31]
    v_pk_mul_f32 v[14:15], v[14:15], s[30:31]
    v_cvt_pk_bf16_f32 v248, v8, v9
    v_cvt_pk_bf16_f32 v249, v10, v11
    v_cvt_pk_bf16_f32 v250, v12, v13
    v_cvt_pk_bf16_f32 v251, v14, v15
    s_waitcnt lgkmcnt(0)
    v_lshlrev_b32 v8, 16, v252
    v_lshlrev_b32 v10, 16, v253
    v_lshlrev_b32 v12, 16, v254
    v_lshlrev_b32 v14, 16, v255
    v_and_b32 v9, 0xffff0000, v252
    v_and_b32 v11, 0xffff0000, v253
    v_and_b32 v13, 0xffff0000, v254
    v_and_b32 v15, 0xffff0000, v255
    v_pk_mul_f32 v[8:9], v[8:9], s[30:31]
    v_pk_mul_f32 v[10:11], v[10:11], s[30:31]
    v_pk_mul_f32 v[12:13], v[12:13], s[30:31]
    v_pk_mul_f32 v[14:15], v[14:15], s[30:31]
    v_cvt_pk_bf16_f32 v252, v8, v9
    v_cvt_pk_bf16_f32 v253, v10, v11
    v_cvt_pk_bf16_f32 v254, v12, v13
    v_cvt_pk_bf16_f32 v255, v14, v15
    v_mfma_f32_16x16x32_bf16 v[40:43], a[192:195], v[240:243], v[124:127]
    v_add_f32 v117, v117, v28
    v_add_f32 v117, v117, v29
    v_mfma_f32_16x16x32_bf16 v[40:43], a[196:199], v[244:247], v[40:43]
    ds_read_b128 a[192:195], v1 offset:0
    ds_read_b128 a[196:199], v1 offset:512
    v_mfma_f32_16x16x32_bf16 v[40:43], a[200:203], v[248:251], v[40:43]
    v_exp_f32 v30, v30
    v_mfma_f32_16x16x32_bf16 v[40:43], a[204:207], v[252:255], v[40:43]
    v_exp_f32 v31, v31
    v_mfma_f32_16x16x32_bf16 v[44:47], a[220:223], v[252:255], v[124:127]
    v_cvt_pk_bf16_f32 v26, v28, v29
    v_add_f32 v117, v117, v30
    v_mfma_f32_16x16x32_bf16 v[44:47], a[216:219], v[248:251], v[44:47]
    ds_read_b128 a[200:203], v1 offset:1024
    ds_read_b128 a[204:207], v1 offset:1536
    v_mfma_f32_16x16x32_bf16 v[44:47], a[212:215], v[244:247], v[44:47]
    v_add_f32 v117, v117, v31
    v_cvt_pk_bf16_f32 v27, v30, v31
    v_mfma_f32_16x16x32_bf16 v[44:47], a[208:211], v[240:243], v[44:47]
    v_exp_f32 v32, v32
    v_mfma_f32_16x16x32_bf16 a[160:163], a[224:227], v[24:27], 0
    v_exp_f32 v33, v33
    v_mfma_f32_16x16x32_bf16 a[164:167], a[228:231], v[24:27], 0
    ds_read_b128 a[220:223], v1 offset:5632
    ds_read_b128 a[216:219], v1 offset:5120
    v_mfma_f32_16x16x32_bf16 a[168:171], a[232:235], v[24:27], 0
    v_add_f32 v118, v118, v32
    v_add_f32 v118, v118, v33
    v_mfma_f32_16x16x32_bf16 a[172:175], a[236:239], v[24:27], 0
    v_exp_f32 v34, v34
    v_mfma_f32_16x16x32_bf16 a[176:179], a[240:243], v[24:27], 0
    v_exp_f32 v35, v35
    v_mfma_f32_16x16x32_bf16 a[180:183], a[244:247], v[24:27], 0
    ds_read_b128 a[212:215], v1 offset:4608
    ds_read_b128 a[208:211], v1 offset:4096
    v_mfma_f32_16x16x32_bf16 a[184:187], a[248:251], v[24:27], 0
    v_cvt_pk_bf16_f32 v32, v32, v33
    v_add_f32 v118, v118, v34
    v_mfma_f32_16x16x32_bf16 a[188:191], a[252:255], v[24:27], 0
    s_waitcnt lgkmcnt(7)
    v_exp_f32 v36, v36
    v_mfma_f32_16x16x32_bf16 v[16:19], a[192:195], v[192:195], 0
    s_waitcnt lgkmcnt(6)
    v_add_f32 v118, v118, v35
    v_cvt_pk_bf16_f32 v33, v34, v35
    v_mfma_f32_16x16x32_bf16 v[16:19], a[196:199], v[196:199], v[16:19]
    s_waitcnt lgkmcnt(5)
    v_exp_f32 v37, v37
    v_mfma_f32_16x16x32_bf16 v[16:19], a[200:203], v[200:203], v[16:19]
    s_waitcnt lgkmcnt(4)
    v_add_f32 v118, v118, v36
    v_add_f32 v118, v118, v37
    v_mfma_f32_16x16x32_bf16 v[16:19], a[204:207], v[204:207], v[16:19]
    s_waitcnt lgkmcnt(3)
    v_exp_f32 v38, v38
    v_mfma_f32_16x16x32_bf16 v[20:23], a[220:223], v[204:207], 0
    s_waitcnt lgkmcnt(2)
    v_exp_f32 v39, v39
    v_mfma_f32_16x16x32_bf16 v[20:23], a[216:219], v[200:203], v[20:23]
    s_waitcnt lgkmcnt(1)
    v_cvt_pk_bf16_f32 v34, v36, v37
    v_add_f32 v118, v118, v38
    v_mfma_f32_16x16x32_bf16 v[20:23], a[212:215], v[196:199], v[20:23]
    s_waitcnt lgkmcnt(0)
    v_add_f32 v118, v118, v39
    v_cvt_pk_bf16_f32 v35, v38, v39
    v_mfma_f32_16x16x32_bf16 v[20:23], a[208:211], v[192:195], v[20:23]
    s_add_u32 m0, s26, 32768
    v_exp_f32 v40, v40
    v_exp_f32 v41, v41
    v_mfma_f32_16x16x32_bf16 v[48:51], a[224:227], v[32:35], 0
    buffer_load_dwordx4 v3, s[12:15], s25 offen nt lds
    v_mfma_f32_16x16x32_bf16 v[52:55], a[228:231], v[32:35], 0
    s_add_u32 m0, s26, 33664
    v_add_f32 v119, v119, v40
    v_add_f32 v119, v119, v41
    v_exp_f32 v42, v42
    v_mfma_f32_16x16x32_bf16 v[56:59], a[232:235], v[32:35], 0
    buffer_load_dwordx4 v3, s[12:15], s25 offen offset:128 nt lds
    v_mfma_f32_16x16x32_bf16 v[60:63], a[236:239], v[32:35], 0
    s_add_u32 m0, s26, 98304
    v_exp_f32 v43, v43
    v_mfma_f32_16x16x32_bf16 v[64:67], a[240:243], v[32:35], 0
    buffer_load_dwordx4 v4, s[16:19], s25 offen nt lds
    v_mfma_f32_16x16x32_bf16 v[68:71], a[244:247], v[32:35], 0
    s_add_u32 m0, s26, 99200
    v_cvt_pk_bf16_f32 v40, v40, v41
    v_add_f32 v119, v119, v42
    v_mfma_f32_16x16x32_bf16 v[72:75], a[248:251], v[32:35], 0
    buffer_load_dwordx4 v4, s[16:19], s25 offen offset:128 nt lds
    s_add_u32 s25, s25, 8192
    v_mfma_f32_16x16x32_bf16 v[76:79], a[252:255], v[32:35], 0
    v_exp_f32 v44, v44
    v_mfma_f32_16x16x32_bf16 v[24:27], a[192:195], v[208:211], 0
    v_add_f32 v119, v119, v43
    v_cvt_pk_bf16_f32 v41, v42, v43
    v_mfma_f32_16x16x32_bf16 v[24:27], a[196:199], v[212:215], v[24:27]
    v_exp_f32 v45, v45
    v_mfma_f32_16x16x32_bf16 v[24:27], a[200:203], v[216:219], v[24:27]
    v_add_f32 v119, v119, v44
    v_add_f32 v119, v119, v45
    v_mfma_f32_16x16x32_bf16 v[24:27], a[204:207], v[220:223], v[24:27]
    v_exp_f32 v46, v46
    v_mfma_f32_16x16x32_bf16 v[28:31], a[220:223], v[220:223], 0
    v_exp_f32 v47, v47
    v_mfma_f32_16x16x32_bf16 v[28:31], a[216:219], v[216:219], v[28:31]
    v_cvt_pk_bf16_f32 v42, v44, v45
    v_add_f32 v119, v119, v46
    v_mfma_f32_16x16x32_bf16 v[28:31], a[212:215], v[212:215], v[28:31]
    v_add_f32 v119, v119, v47
    v_cvt_pk_bf16_f32 v43, v46, v47
    v_mfma_f32_16x16x32_bf16 v[28:31], a[208:211], v[208:211], v[28:31]
    v_exp_f32 v16, v16
    v_exp_f32 v17, v17
    v_mfma_f32_16x16x32_bf16 v[80:83], a[224:227], v[40:43], 0
    ds_read_b64_tr_b16 a[224:225], v2 offset:0
    ds_read_b64_tr_b16 a[226:227], v2 offset:4096
    v_mfma_f32_16x16x32_bf16 v[84:87], a[228:231], v[40:43], 0
    v_add_f32 v116, v116, v16
    v_add_f32 v116, v116, v17
    v_exp_f32 v18, v18
    v_mfma_f32_16x16x32_bf16 v[88:91], a[232:235], v[40:43], 0
    ds_read_b64_tr_b16 a[228:229], v2 offset:256
    ds_read_b64_tr_b16 a[230:231], v2 offset:4352
    v_mfma_f32_16x16x32_bf16 v[92:95], a[236:239], v[40:43], 0
    v_exp_f32 v19, v19
    v_cvt_pk_bf16_f32 v16, v16, v17
    v_add_f32 v116, v116, v18
    v_mfma_f32_16x16x32_bf16 v[96:99], a[240:243], v[40:43], 0
    ds_read_b64_tr_b16 a[232:233], v2 offset:512
    ds_read_b64_tr_b16 a[234:235], v2 offset:4608
    v_mfma_f32_16x16x32_bf16 v[100:103], a[244:247], v[40:43], 0
    v_exp_f32 v20, v20
    v_add_f32 v116, v116, v19
    v_cvt_pk_bf16_f32 v17, v18, v19
    v_mfma_f32_16x16x32_bf16 v[104:107], a[248:251], v[40:43], 0
    ds_read_b64_tr_b16 a[236:237], v2 offset:768
    ds_read_b64_tr_b16 a[238:239], v2 offset:4864
    v_mfma_f32_16x16x32_bf16 v[108:111], a[252:255], v[40:43], 0
    v_exp_f32 v21, v21
    v_add_f32 v116, v116, v20
    v_add_f32 v116, v116, v21
    v_mfma_f32_16x16x32_bf16 v[32:35], a[192:195], v[224:227], 0
    ds_read_b64_tr_b16 a[240:241], v2 offset:1024
    ds_read_b64_tr_b16 a[242:243], v2 offset:5120
    v_mfma_f32_16x16x32_bf16 v[32:35], a[196:199], v[228:231], v[32:35]
    v_exp_f32 v22, v22
    v_exp_f32 v23, v23
    v_mfma_f32_16x16x32_bf16 v[32:35], a[200:203], v[232:235], v[32:35]
    ds_read_b64_tr_b16 a[244:245], v2 offset:1280
    ds_read_b64_tr_b16 a[246:247], v2 offset:5376
    v_mfma_f32_16x16x32_bf16 v[32:35], a[204:207], v[236:239], v[32:35]
    v_cvt_pk_bf16_f32 v18, v20, v21
    v_add_f32 v116, v116, v22
    v_mfma_f32_16x16x32_bf16 v[36:39], a[220:223], v[236:239], 0
    ds_read_b64_tr_b16 a[248:249], v2 offset:1536
    ds_read_b64_tr_b16 a[250:251], v2 offset:5632
    v_mfma_f32_16x16x32_bf16 v[36:39], a[216:219], v[232:235], v[36:39]
    v_add_f32 v116, v116, v23
    v_cvt_pk_bf16_f32 v19, v22, v23
    v_mfma_f32_16x16x32_bf16 v[36:39], a[212:215], v[228:231], v[36:39]
    ds_read_b64_tr_b16 a[252:253], v2 offset:1792
    ds_read_b64_tr_b16 a[254:255], v2 offset:5888
    v_mfma_f32_16x16x32_bf16 v[36:39], a[208:211], v[224:227], v[36:39]
    s_waitcnt lgkmcnt(14)
    v_exp_f32 v24, v24
    v_mfma_f32_16x16x32_bf16 a[128:131], a[224:227], v[16:19], a[128:131]
    s_waitcnt lgkmcnt(12)
    v_exp_f32 v25, v25
    v_mfma_f32_16x16x32_bf16 a[132:135], a[228:231], v[16:19], a[132:135]
    s_waitcnt lgkmcnt(10)
    v_add_f32 v117, v117, v24
    v_add_f32 v117, v117, v25
    v_mfma_f32_16x16x32_bf16 a[136:139], a[232:235], v[16:19], a[136:139]
    s_waitcnt lgkmcnt(8)
    v_exp_f32 v26, v26
    v_mfma_f32_16x16x32_bf16 a[140:143], a[236:239], v[16:19], a[140:143]
    s_waitcnt lgkmcnt(6)
    v_exp_f32 v27, v27
    v_mfma_f32_16x16x32_bf16 a[144:147], a[240:243], v[16:19], a[144:147]
    s_waitcnt lgkmcnt(4)
    v_cvt_pk_bf16_f32 v24, v24, v25
    v_add_f32 v117, v117, v26
    v_mfma_f32_16x16x32_bf16 a[148:151], a[244:247], v[16:19], a[148:151]
    s_waitcnt lgkmcnt(2)
    v_exp_f32 v28, v28
    v_mfma_f32_16x16x32_bf16 a[152:155], a[248:251], v[16:19], a[152:155]
    s_waitcnt lgkmcnt(0)
    v_add_f32 v117, v117, v27
    v_cvt_pk_bf16_f32 v25, v26, v27
    v_mfma_f32_16x16x32_bf16 a[156:159], a[252:255], v[16:19], a[156:159]
    v_exp_f32 v29, v29
    v_mfma_f32_16x16x32_bf16 v[40:43], a[192:195], v[240:243], v[124:127]
    v_add_f32 v117, v117, v28
    v_add_f32 v117, v117, v29
    v_mfma_f32_16x16x32_bf16 v[40:43], a[196:199], v[244:247], v[40:43]
    ds_read_b128 a[192:195], v1 offset:8192
    ds_read_b128 a[196:199], v1 offset:8704
    v_mfma_f32_16x16x32_bf16 v[40:43], a[200:203], v[248:251], v[40:43]
    v_exp_f32 v30, v30
    v_mfma_f32_16x16x32_bf16 v[40:43], a[204:207], v[252:255], v[40:43]
    v_exp_f32 v31, v31
    v_mfma_f32_16x16x32_bf16 v[44:47], a[220:223], v[252:255], v[124:127]
    v_cvt_pk_bf16_f32 v26, v28, v29
    v_add_f32 v117, v117, v30
    v_mfma_f32_16x16x32_bf16 v[44:47], a[216:219], v[248:251], v[44:47]
    ds_read_b128 a[200:203], v1 offset:9216
    ds_read_b128 a[204:207], v1 offset:9728
    v_mfma_f32_16x16x32_bf16 v[44:47], a[212:215], v[244:247], v[44:47]
    v_add_f32 v117, v117, v31
    v_cvt_pk_bf16_f32 v27, v30, v31
    v_mfma_f32_16x16x32_bf16 v[44:47], a[208:211], v[240:243], v[44:47]
    v_exp_f32 v32, v32
    v_mfma_f32_16x16x32_bf16 a[160:163], a[224:227], v[24:27], a[160:163]
    v_exp_f32 v33, v33
    v_mfma_f32_16x16x32_bf16 a[164:167], a[228:231], v[24:27], a[164:167]
    ds_read_b128 a[220:223], v1 offset:13824
    ds_read_b128 a[216:219], v1 offset:13312
    v_mfma_f32_16x16x32_bf16 a[168:171], a[232:235], v[24:27], a[168:171]
    v_add_f32 v118, v118, v32
    v_add_f32 v118, v118, v33
    v_mfma_f32_16x16x32_bf16 a[172:175], a[236:239], v[24:27], a[172:175]
    v_exp_f32 v34, v34
    v_mfma_f32_16x16x32_bf16 a[176:179], a[240:243], v[24:27], a[176:179]
    v_exp_f32 v35, v35
    v_mfma_f32_16x16x32_bf16 a[180:183], a[244:247], v[24:27], a[180:183]
    ds_read_b128 a[212:215], v1 offset:12800
    ds_read_b128 a[208:211], v1 offset:12288
    v_mfma_f32_16x16x32_bf16 a[184:187], a[248:251], v[24:27], a[184:187]
    v_cvt_pk_bf16_f32 v32, v32, v33
    v_add_f32 v118, v118, v34
    v_mfma_f32_16x16x32_bf16 a[188:191], a[252:255], v[24:27], a[188:191]
    s_waitcnt lgkmcnt(7)
    v_exp_f32 v36, v36
    v_mfma_f32_16x16x32_bf16 v[16:19], a[192:195], v[192:195], 0
    s_waitcnt lgkmcnt(6)
    v_add_f32 v118, v118, v35
    v_cvt_pk_bf16_f32 v33, v34, v35
    v_mfma_f32_16x16x32_bf16 v[16:19], a[196:199], v[196:199], v[16:19]
    s_waitcnt lgkmcnt(5)
    v_exp_f32 v37, v37
    v_mfma_f32_16x16x32_bf16 v[16:19], a[200:203], v[200:203], v[16:19]
    s_waitcnt lgkmcnt(4)
    v_add_f32 v118, v118, v36
    v_add_f32 v118, v118, v37
    v_mfma_f32_16x16x32_bf16 v[16:19], a[204:207], v[204:207], v[16:19]
    s_waitcnt lgkmcnt(3)
    v_exp_f32 v38, v38
    v_mfma_f32_16x16x32_bf16 v[20:23], a[220:223], v[204:207], 0
    s_waitcnt lgkmcnt(2)
    v_exp_f32 v39, v39
    v_mfma_f32_16x16x32_bf16 v[20:23], a[216:219], v[200:203], v[20:23]
    s_waitcnt lgkmcnt(1)
    v_cvt_pk_bf16_f32 v34, v36, v37
    v_add_f32 v118, v118, v38
    v_mfma_f32_16x16x32_bf16 v[20:23], a[212:215], v[196:199], v[20:23]
    s_waitcnt lgkmcnt(0)
    v_add_f32 v118, v118, v39
    v_cvt_pk_bf16_f32 v35, v38, v39
    v_mfma_f32_16x16x32_bf16 v[20:23], a[208:211], v[192:195], v[20:23]
    s_add_u32 m0, s26, 40960
    v_exp_f32 v40, v40
    v_exp_f32 v41, v41
    v_mfma_f32_16x16x32_bf16 v[48:51], a[224:227], v[32:35], v[48:51]
    buffer_load_dwordx4 v3, s[12:15], s25 offen nt lds
    v_mfma_f32_16x16x32_bf16 v[52:55], a[228:231], v[32:35], v[52:55]
    s_add_u32 m0, s26, 41856
    v_add_f32 v119, v119, v40
    v_add_f32 v119, v119, v41
    v_exp_f32 v42, v42
    v_mfma_f32_16x16x32_bf16 v[56:59], a[232:235], v[32:35], v[56:59]
    buffer_load_dwordx4 v3, s[12:15], s25 offen offset:128 nt lds
    v_mfma_f32_16x16x32_bf16 v[60:63], a[236:239], v[32:35], v[60:63]
    s_add_u32 m0, s26, 106496
    v_exp_f32 v43, v43
    v_mfma_f32_16x16x32_bf16 v[64:67], a[240:243], v[32:35], v[64:67]
    buffer_load_dwordx4 v4, s[16:19], s25 offen nt lds
    v_mfma_f32_16x16x32_bf16 v[68:71], a[244:247], v[32:35], v[68:71]
    s_add_u32 m0, s26, 107392
    v_cvt_pk_bf16_f32 v40, v40, v41
    v_add_f32 v119, v119, v42
    v_mfma_f32_16x16x32_bf16 v[72:75], a[248:251], v[32:35], v[72:75]
    buffer_load_dwordx4 v4, s[16:19], s25 offen offset:128 nt lds
    s_add_u32 s25, s25, 8192
    v_mfma_f32_16x16x32_bf16 v[76:79], a[252:255], v[32:35], v[76:79]
    v_exp_f32 v44, v44
    v_mfma_f32_16x16x32_bf16 v[24:27], a[192:195], v[208:211], 0
    v_add_f32 v119, v119, v43
    v_cvt_pk_bf16_f32 v41, v42, v43
    v_mfma_f32_16x16x32_bf16 v[24:27], a[196:199], v[212:215], v[24:27]
    v_exp_f32 v45, v45
    v_mfma_f32_16x16x32_bf16 v[24:27], a[200:203], v[216:219], v[24:27]
    v_add_f32 v119, v119, v44
    v_add_f32 v119, v119, v45
    v_mfma_f32_16x16x32_bf16 v[24:27], a[204:207], v[220:223], v[24:27]
    v_exp_f32 v46, v46
    v_mfma_f32_16x16x32_bf16 v[28:31], a[220:223], v[220:223], 0
    v_exp_f32 v47, v47
    v_mfma_f32_16x16x32_bf16 v[28:31], a[216:219], v[216:219], v[28:31]
    v_cvt_pk_bf16_f32 v42, v44, v45
    v_add_f32 v119, v119, v46
    v_mfma_f32_16x16x32_bf16 v[28:31], a[212:215], v[212:215], v[28:31]
    v_add_f32 v119, v119, v47
    v_cvt_pk_bf16_f32 v43, v46, v47
    v_mfma_f32_16x16x32_bf16 v[28:31], a[208:211], v[208:211], v[28:31]
    v_exp_f32 v16, v16
    v_exp_f32 v17, v17
    v_mfma_f32_16x16x32_bf16 v[80:83], a[224:227], v[40:43], v[80:83]
    ds_read_b64_tr_b16 a[224:225], v2 offset:8192
    ds_read_b64_tr_b16 a[226:227], v2 offset:12288
    v_mfma_f32_16x16x32_bf16 v[84:87], a[228:231], v[40:43], v[84:87]
    v_add_f32 v116, v116, v16
    v_add_f32 v116, v116, v17
    v_exp_f32 v18, v18
    v_mfma_f32_16x16x32_bf16 v[88:91], a[232:235], v[40:43], v[88:91]
    ds_read_b64_tr_b16 a[228:229], v2 offset:8448
    ds_read_b64_tr_b16 a[230:231], v2 offset:12544
    v_mfma_f32_16x16x32_bf16 v[92:95], a[236:239], v[40:43], v[92:95]
    v_exp_f32 v19, v19
    v_cvt_pk_bf16_f32 v16, v16, v17
    v_add_f32 v116, v116, v18
    v_mfma_f32_16x16x32_bf16 v[96:99], a[240:243], v[40:43], v[96:99]
    ds_read_b64_tr_b16 a[232:233], v2 offset:8704
    ds_read_b64_tr_b16 a[234:235], v2 offset:12800
    v_mfma_f32_16x16x32_bf16 v[100:103], a[244:247], v[40:43], v[100:103]
    v_exp_f32 v20, v20
    v_add_f32 v116, v116, v19
    v_cvt_pk_bf16_f32 v17, v18, v19
    v_mfma_f32_16x16x32_bf16 v[104:107], a[248:251], v[40:43], v[104:107]
    ds_read_b64_tr_b16 a[236:237], v2 offset:8960
    ds_read_b64_tr_b16 a[238:239], v2 offset:13056
    v_mfma_f32_16x16x32_bf16 v[108:111], a[252:255], v[40:43], v[108:111]
    v_exp_f32 v21, v21
    v_add_f32 v116, v116, v20
    v_add_f32 v116, v116, v21
    v_mfma_f32_16x16x32_bf16 v[32:35], a[192:195], v[224:227], 0
    ds_read_b64_tr_b16 a[240:241], v2 offset:9216
    ds_read_b64_tr_b16 a[242:243], v2 offset:13312
    v_mfma_f32_16x16x32_bf16 v[32:35], a[196:199], v[228:231], v[32:35]
    v_exp_f32 v22, v22
    v_exp_f32 v23, v23
    v_mfma_f32_16x16x32_bf16 v[32:35], a[200:203], v[232:235], v[32:35]
    ds_read_b64_tr_b16 a[244:245], v2 offset:9472
    ds_read_b64_tr_b16 a[246:247], v2 offset:13568
    v_mfma_f32_16x16x32_bf16 v[32:35], a[204:207], v[236:239], v[32:35]
    v_cvt_pk_bf16_f32 v18, v20, v21
    v_add_f32 v116, v116, v22
    v_mfma_f32_16x16x32_bf16 v[36:39], a[220:223], v[236:239], 0
    ds_read_b64_tr_b16 a[248:249], v2 offset:9728
    ds_read_b64_tr_b16 a[250:251], v2 offset:13824
    v_mfma_f32_16x16x32_bf16 v[36:39], a[216:219], v[232:235], v[36:39]
    v_add_f32 v116, v116, v23
    v_cvt_pk_bf16_f32 v19, v22, v23
    v_mfma_f32_16x16x32_bf16 v[36:39], a[212:215], v[228:231], v[36:39]
    ds_read_b64_tr_b16 a[252:253], v2 offset:9984
    ds_read_b64_tr_b16 a[254:255], v2 offset:14080
    v_mfma_f32_16x16x32_bf16 v[36:39], a[208:211], v[224:227], v[36:39]
    s_waitcnt lgkmcnt(14)
    v_exp_f32 v24, v24
    v_mfma_f32_16x16x32_bf16 a[128:131], a[224:227], v[16:19], a[128:131]
    s_waitcnt lgkmcnt(12)
    v_exp_f32 v25, v25
    v_mfma_f32_16x16x32_bf16 a[132:135], a[228:231], v[16:19], a[132:135]
    s_waitcnt lgkmcnt(10)
    v_add_f32 v117, v117, v24
    v_add_f32 v117, v117, v25
    v_mfma_f32_16x16x32_bf16 a[136:139], a[232:235], v[16:19], a[136:139]
    s_waitcnt lgkmcnt(8)
    v_exp_f32 v26, v26
    v_mfma_f32_16x16x32_bf16 a[140:143], a[236:239], v[16:19], a[140:143]
    s_waitcnt lgkmcnt(6)
    v_exp_f32 v27, v27
    v_mfma_f32_16x16x32_bf16 a[144:147], a[240:243], v[16:19], a[144:147]
    s_waitcnt lgkmcnt(4)
    v_cvt_pk_bf16_f32 v24, v24, v25
    v_add_f32 v117, v117, v26
    v_mfma_f32_16x16x32_bf16 a[148:151], a[244:247], v[16:19], a[148:151]
    s_waitcnt lgkmcnt(2)
    v_exp_f32 v28, v28
    v_mfma_f32_16x16x32_bf16 a[152:155], a[248:251], v[16:19], a[152:155]
    s_waitcnt lgkmcnt(0)
    v_add_f32 v117, v117, v27
    v_cvt_pk_bf16_f32 v25, v26, v27
    v_mfma_f32_16x16x32_bf16 a[156:159], a[252:255], v[16:19], a[156:159]
    v_exp_f32 v29, v29
    v_mfma_f32_16x16x32_bf16 v[40:43], a[192:195], v[240:243], v[124:127]
    s_waitcnt vmcnt(8)
    v_add_f32 v117, v117, v28
    v_add_f32 v117, v117, v29
    v_mfma_f32_16x16x32_bf16 v[40:43], a[196:199], v[244:247], v[40:43]
    s_barrier
    ds_read_b128 a[192:195], v1 offset:24576
    ds_read_b128 a[196:199], v1 offset:25088
    v_mfma_f32_16x16x32_bf16 v[40:43], a[200:203], v[248:251], v[40:43]
    v_exp_f32 v30, v30
    v_mfma_f32_16x16x32_bf16 v[40:43], a[204:207], v[252:255], v[40:43]
    v_exp_f32 v31, v31
    v_mfma_f32_16x16x32_bf16 v[44:47], a[220:223], v[252:255], v[124:127]
    v_cvt_pk_bf16_f32 v26, v28, v29
    v_add_f32 v117, v117, v30
    v_mfma_f32_16x16x32_bf16 v[44:47], a[216:219], v[248:251], v[44:47]
    ds_read_b128 a[200:203], v1 offset:25600
    ds_read_b128 a[204:207], v1 offset:26112
    v_mfma_f32_16x16x32_bf16 v[44:47], a[212:215], v[244:247], v[44:47]
    v_add_f32 v117, v117, v31
    v_cvt_pk_bf16_f32 v27, v30, v31
    v_mfma_f32_16x16x32_bf16 v[44:47], a[208:211], v[240:243], v[44:47]
    v_exp_f32 v32, v32
    v_mfma_f32_16x16x32_bf16 a[160:163], a[224:227], v[24:27], a[160:163]
    v_exp_f32 v33, v33
    v_mfma_f32_16x16x32_bf16 a[164:167], a[228:231], v[24:27], a[164:167]
    ds_read_b128 a[220:223], v1 offset:30208
    ds_read_b128 a[216:219], v1 offset:29696
    v_mfma_f32_16x16x32_bf16 a[168:171], a[232:235], v[24:27], a[168:171]
    v_add_f32 v118, v118, v32
    v_add_f32 v118, v118, v33
    v_mfma_f32_16x16x32_bf16 a[172:175], a[236:239], v[24:27], a[172:175]
    v_exp_f32 v34, v34
    v_mfma_f32_16x16x32_bf16 a[176:179], a[240:243], v[24:27], a[176:179]
    v_exp_f32 v35, v35
    v_mfma_f32_16x16x32_bf16 a[180:183], a[244:247], v[24:27], a[180:183]
    ds_read_b128 a[212:215], v1 offset:29184
    ds_read_b128 a[208:211], v1 offset:28672
    v_mfma_f32_16x16x32_bf16 a[184:187], a[248:251], v[24:27], a[184:187]
    v_cvt_pk_bf16_f32 v32, v32, v33
    v_add_f32 v118, v118, v34
    v_mfma_f32_16x16x32_bf16 a[188:191], a[252:255], v[24:27], a[188:191]
    s_waitcnt lgkmcnt(7)
    v_exp_f32 v36, v36
    v_mfma_f32_16x16x32_bf16 v[16:19], a[192:195], v[128:131], 0
    s_waitcnt lgkmcnt(6)
    v_add_f32 v118, v118, v35
    v_cvt_pk_bf16_f32 v33, v34, v35
    v_mfma_f32_16x16x32_bf16 v[16:19], a[196:199], v[132:135], v[16:19]
    s_waitcnt lgkmcnt(5)
    v_exp_f32 v37, v37
    v_mfma_f32_16x16x32_bf16 v[16:19], a[200:203], v[136:139], v[16:19]
    s_waitcnt lgkmcnt(4)
    v_add_f32 v118, v118, v36
    v_add_f32 v118, v118, v37
    v_mfma_f32_16x16x32_bf16 v[16:19], a[204:207], v[140:143], v[16:19]
    s_waitcnt lgkmcnt(3)
    v_exp_f32 v38, v38
    v_mfma_f32_16x16x32_bf16 v[20:23], a[220:223], v[140:143], 0
    s_waitcnt lgkmcnt(2)
    v_exp_f32 v39, v39
    v_mfma_f32_16x16x32_bf16 v[20:23], a[216:219], v[136:139], v[20:23]
    s_waitcnt lgkmcnt(1)
    v_cvt_pk_bf16_f32 v34, v36, v37
    v_add_f32 v118, v118, v38
    v_mfma_f32_16x16x32_bf16 v[20:23], a[212:215], v[132:135], v[20:23]
    s_waitcnt lgkmcnt(0)
    v_add_f32 v118, v118, v39
    v_cvt_pk_bf16_f32 v35, v38, v39
    v_mfma_f32_16x16x32_bf16 v[20:23], a[208:211], v[128:131], v[20:23]
    v_exp_f32 v40, v40
    v_exp_f32 v41, v41
    v_mfma_f32_16x16x32_bf16 v[48:51], a[224:227], v[32:35], v[48:51]
    v_add_f32 v119, v119, v40
    v_add_f32 v119, v119, v41
    v_mfma_f32_16x16x32_bf16 v[52:55], a[228:231], v[32:35], v[52:55]
    v_exp_f32 v42, v42
    v_mfma_f32_16x16x32_bf16 v[56:59], a[232:235], v[32:35], v[56:59]
    v_exp_f32 v43, v43
    v_mfma_f32_16x16x32_bf16 v[60:63], a[236:239], v[32:35], v[60:63]
    v_cvt_pk_bf16_f32 v40, v40, v41
    v_add_f32 v119, v119, v42
    v_mfma_f32_16x16x32_bf16 v[64:67], a[240:243], v[32:35], v[64:67]
    v_exp_f32 v44, v44
    v_mfma_f32_16x16x32_bf16 v[68:71], a[244:247], v[32:35], v[68:71]
    v_add_f32 v119, v119, v43
    v_cvt_pk_bf16_f32 v41, v42, v43
    v_mfma_f32_16x16x32_bf16 v[72:75], a[248:251], v[32:35], v[72:75]
    v_exp_f32 v45, v45
    v_mfma_f32_16x16x32_bf16 v[76:79], a[252:255], v[32:35], v[76:79]
    v_add_f32 v119, v119, v44
    v_add_f32 v119, v119, v45
    v_mfma_f32_16x16x32_bf16 v[24:27], a[192:195], v[144:147], 0
    s_add_u32 m0, s26, 49152
    v_exp_f32 v46, v46
    v_mfma_f32_16x16x32_bf16 v[24:27], a[196:199], v[148:151], v[24:27]
    buffer_load_dwordx4 v3, s[12:15], s25 offen nt lds
    v_mfma_f32_16x16x32_bf16 v[24:27], a[200:203], v[152:155], v[24:27]
    s_add_u32 m0, s26, 50048
    v_exp_f32 v47, v47
    v_mfma_f32_16x16x32_bf16 v[24:27], a[204:207], v[156:159], v[24:27]
    buffer_load_dwordx4 v3, s[12:15], s25 offen offset:128 nt lds
    v_mfma_f32_16x16x32_bf16 v[28:31], a[220:223], v[156:159], 0
    s_add_u32 m0, s26, 114688
    v_cvt_pk_bf16_f32 v42, v44, v45
    v_add_f32 v119, v119, v46
    v_mfma_f32_16x16x32_bf16 v[28:31], a[216:219], v[152:155], v[28:31]
    buffer_load_dwordx4 v4, s[16:19], s25 offen nt lds
    v_mfma_f32_16x16x32_bf16 v[28:31], a[212:215], v[148:151], v[28:31]
    s_add_u32 m0, s26, 115584
    v_add_f32 v119, v119, v47
    v_cvt_pk_bf16_f32 v43, v46, v47
    v_mfma_f32_16x16x32_bf16 v[28:31], a[208:211], v[144:147], v[28:31]
    buffer_load_dwordx4 v4, s[16:19], s25 offen offset:128 nt lds
    s_add_u32 s25, s25, 8192
    v_mfma_f32_16x16x32_bf16 v[80:83], a[224:227], v[40:43], v[80:83]
    ds_read_b64_tr_b16 a[224:225], v2 offset:24576
    ds_read_b64_tr_b16 a[226:227], v2 offset:28672
    v_mfma_f32_16x16x32_bf16 v[84:87], a[228:231], v[40:43], v[84:87]
    v_exp_f32 v16, v16
    v_exp_f32 v17, v17
    v_mfma_f32_16x16x32_bf16 v[88:91], a[232:235], v[40:43], v[88:91]
    ds_read_b64_tr_b16 a[228:229], v2 offset:24832
    ds_read_b64_tr_b16 a[230:231], v2 offset:28928
    v_mfma_f32_16x16x32_bf16 v[92:95], a[236:239], v[40:43], v[92:95]
    v_add_f32 v112, v112, v16
    v_add_f32 v112, v112, v17
    v_exp_f32 v18, v18
    v_mfma_f32_16x16x32_bf16 v[96:99], a[240:243], v[40:43], v[96:99]
    ds_read_b64_tr_b16 a[232:233], v2 offset:25088
    ds_read_b64_tr_b16 a[234:235], v2 offset:29184
    v_mfma_f32_16x16x32_bf16 v[100:103], a[244:247], v[40:43], v[100:103]
    v_exp_f32 v19, v19
    v_cvt_pk_bf16_f32 v16, v16, v17
    v_add_f32 v112, v112, v18
    v_mfma_f32_16x16x32_bf16 v[104:107], a[248:251], v[40:43], v[104:107]
    ds_read_b64_tr_b16 a[236:237], v2 offset:25344
    ds_read_b64_tr_b16 a[238:239], v2 offset:29440
    v_mfma_f32_16x16x32_bf16 v[108:111], a[252:255], v[40:43], v[108:111]
    v_exp_f32 v20, v20
    v_add_f32 v112, v112, v19
    v_cvt_pk_bf16_f32 v17, v18, v19
    v_mfma_f32_16x16x32_bf16 v[32:35], a[192:195], v[160:163], 0
    ds_read_b64_tr_b16 a[240:241], v2 offset:25600
    ds_read_b64_tr_b16 a[242:243], v2 offset:29696
    v_mfma_f32_16x16x32_bf16 v[32:35], a[196:199], v[164:167], v[32:35]
    v_exp_f32 v21, v21
    v_add_f32 v112, v112, v20
    v_add_f32 v112, v112, v21
    v_mfma_f32_16x16x32_bf16 v[32:35], a[200:203], v[168:171], v[32:35]
    ds_read_b64_tr_b16 a[244:245], v2 offset:25856
    ds_read_b64_tr_b16 a[246:247], v2 offset:29952
    v_mfma_f32_16x16x32_bf16 v[32:35], a[204:207], v[172:175], v[32:35]
    v_exp_f32 v22, v22
    v_exp_f32 v23, v23
    v_mfma_f32_16x16x32_bf16 v[36:39], a[220:223], v[172:175], 0
    ds_read_b64_tr_b16 a[248:249], v2 offset:26112
    ds_read_b64_tr_b16 a[250:251], v2 offset:30208
    v_mfma_f32_16x16x32_bf16 v[36:39], a[216:219], v[168:171], v[36:39]
    v_cvt_pk_bf16_f32 v18, v20, v21
    v_add_f32 v112, v112, v22
    v_add_f32 v112, v112, v23
    v_cvt_pk_bf16_f32 v19, v22, v23
    v_mfma_f32_16x16x32_bf16 v[36:39], a[212:215], v[164:167], v[36:39]
    ds_read_b64_tr_b16 a[252:253], v2 offset:26368
    ds_read_b64_tr_b16 a[254:255], v2 offset:30464
    v_mfma_f32_16x16x32_bf16 v[36:39], a[208:211], v[160:163], v[36:39]
    s_waitcnt lgkmcnt(14)
    v_exp_f32 v24, v24
    v_mfma_f32_16x16x32_bf16 a[0:3], a[224:227], v[16:19], a[0:3]
    s_waitcnt lgkmcnt(12)
    v_exp_f32 v25, v25
    v_mfma_f32_16x16x32_bf16 a[4:7], a[228:231], v[16:19], a[4:7]
    s_waitcnt lgkmcnt(10)
    v_add_f32 v113, v113, v24
    v_add_f32 v113, v113, v25
    v_mfma_f32_16x16x32_bf16 a[8:11], a[232:235], v[16:19], a[8:11]
    s_waitcnt lgkmcnt(8)
    v_exp_f32 v26, v26
    v_mfma_f32_16x16x32_bf16 a[12:15], a[236:239], v[16:19], a[12:15]
    s_waitcnt lgkmcnt(6)
    v_exp_f32 v27, v27
    v_mfma_f32_16x16x32_bf16 a[16:19], a[240:243], v[16:19], a[16:19]
    s_waitcnt lgkmcnt(4)
    v_cvt_pk_bf16_f32 v24, v24, v25
    v_add_f32 v113, v113, v26
    v_mfma_f32_16x16x32_bf16 a[20:23], a[244:247], v[16:19], a[20:23]
    s_waitcnt lgkmcnt(2)
    v_exp_f32 v28, v28
    v_mfma_f32_16x16x32_bf16 a[24:27], a[248:251], v[16:19], a[24:27]
    s_waitcnt lgkmcnt(0)
    v_add_f32 v113, v113, v27
    v_cvt_pk_bf16_f32 v25, v26, v27
    v_mfma_f32_16x16x32_bf16 a[28:31], a[252:255], v[16:19], a[28:31]
    v_exp_f32 v29, v29
    v_mfma_f32_16x16x32_bf16 v[40:43], a[192:195], v[176:179], 0
    s_waitcnt vmcnt(8)
    v_add_f32 v113, v113, v28
    v_add_f32 v113, v113, v29
    v_mfma_f32_16x16x32_bf16 v[40:43], a[196:199], v[180:183], v[40:43]
    s_barrier
    v_exp_f32 v30, v30
    v_mfma_f32_16x16x32_bf16 v[40:43], a[200:203], v[184:187], v[40:43]
    v_exp_f32 v31, v31
    v_mfma_f32_16x16x32_bf16 v[40:43], a[204:207], v[188:191], v[40:43]
    v_cvt_pk_bf16_f32 v26, v28, v29
    v_add_f32 v113, v113, v30
    v_mfma_f32_16x16x32_bf16 v[44:47], a[220:223], v[188:191], 0
    v_add_f32 v113, v113, v31
    v_cvt_pk_bf16_f32 v27, v30, v31
    v_mfma_f32_16x16x32_bf16 v[44:47], a[216:219], v[184:187], v[44:47]
    v_exp_f32 v32, v32
    v_mfma_f32_16x16x32_bf16 v[44:47], a[212:215], v[180:183], v[44:47]
    v_exp_f32 v33, v33
    v_mfma_f32_16x16x32_bf16 v[44:47], a[208:211], v[176:179], v[44:47]
    v_add_f32 v114, v114, v32
    v_add_f32 v114, v114, v33
    v_mfma_f32_16x16x32_bf16 a[32:35], a[224:227], v[24:27], a[32:35]
    v_exp_f32 v34, v34
    v_mfma_f32_16x16x32_bf16 a[36:39], a[228:231], v[24:27], a[36:39]
    v_exp_f32 v35, v35
    v_mfma_f32_16x16x32_bf16 a[40:43], a[232:235], v[24:27], a[40:43]
    v_cvt_pk_bf16_f32 v32, v32, v33
    v_add_f32 v114, v114, v34
    v_mfma_f32_16x16x32_bf16 a[44:47], a[236:239], v[24:27], a[44:47]
    v_exp_f32 v36, v36
    v_mfma_f32_16x16x32_bf16 a[48:51], a[240:243], v[24:27], a[48:51]
    v_add_f32 v114, v114, v35
    v_cvt_pk_bf16_f32 v33, v34, v35
    v_mfma_f32_16x16x32_bf16 a[52:55], a[244:247], v[24:27], a[52:55]
    v_exp_f32 v37, v37
    v_mfma_f32_16x16x32_bf16 a[56:59], a[248:251], v[24:27], a[56:59]
    v_add_f32 v114, v114, v36
    v_add_f32 v114, v114, v37
    v_mfma_f32_16x16x32_bf16 a[60:63], a[252:255], v[24:27], a[60:63]
    v_exp_f32 v38, v38
    v_mfma_f32_16x16x32_bf16 v[16:19], a[192:195], v[192:195], 0
    v_exp_f32 v39, v39
    v_mfma_f32_16x16x32_bf16 v[16:19], a[196:199], v[196:199], v[16:19]
    v_cvt_pk_bf16_f32 v34, v36, v37
    v_add_f32 v114, v114, v38
    v_mfma_f32_16x16x32_bf16 v[16:19], a[200:203], v[200:203], v[16:19]
    v_add_f32 v114, v114, v39
    v_cvt_pk_bf16_f32 v35, v38, v39
    v_mfma_f32_16x16x32_bf16 v[16:19], a[204:207], v[204:207], v[16:19]
    v_exp_f32 v40, v40
    v_mfma_f32_16x16x32_bf16 v[20:23], a[220:223], v[204:207], 0
    v_exp_f32 v41, v41
    v_mfma_f32_16x16x32_bf16 v[20:23], a[216:219], v[200:203], v[20:23]
    v_add_f32 v115, v115, v40
    v_add_f32 v115, v115, v41
    v_mfma_f32_16x16x32_bf16 v[20:23], a[212:215], v[196:199], v[20:23]
    v_exp_f32 v42, v42
    v_mfma_f32_16x16x32_bf16 v[20:23], a[208:211], v[192:195], v[20:23]
    v_exp_f32 v43, v43
    v_mfma_f32_16x16x32_bf16 a[64:67], a[224:227], v[32:35], a[64:67]
    v_cvt_pk_bf16_f32 v40, v40, v41
    v_add_f32 v115, v115, v42
    v_mfma_f32_16x16x32_bf16 a[68:71], a[228:231], v[32:35], a[68:71]
    v_exp_f32 v44, v44
    v_mfma_f32_16x16x32_bf16 a[72:75], a[232:235], v[32:35], a[72:75]
    v_add_f32 v115, v115, v43
    v_cvt_pk_bf16_f32 v41, v42, v43
    v_mfma_f32_16x16x32_bf16 a[76:79], a[236:239], v[32:35], a[76:79]
    v_exp_f32 v45, v45
    v_mfma_f32_16x16x32_bf16 a[80:83], a[240:243], v[32:35], a[80:83]
    v_add_f32 v115, v115, v44
    v_add_f32 v115, v115, v45
    v_mfma_f32_16x16x32_bf16 a[84:87], a[244:247], v[32:35], a[84:87]
    v_exp_f32 v46, v46
    v_mfma_f32_16x16x32_bf16 a[88:91], a[248:251], v[32:35], a[88:91]
    v_exp_f32 v47, v47
    v_mfma_f32_16x16x32_bf16 a[92:95], a[252:255], v[32:35], a[92:95]
    v_cvt_pk_bf16_f32 v42, v44, v45
    v_add_f32 v115, v115, v46
    v_mfma_f32_16x16x32_bf16 v[24:27], a[192:195], v[208:211], 0
    s_add_u32 m0, s26, 57344
    v_add_f32 v115, v115, v47
    v_cvt_pk_bf16_f32 v43, v46, v47
    v_mfma_f32_16x16x32_bf16 v[24:27], a[196:199], v[212:215], v[24:27]
    buffer_load_dwordx4 v3, s[12:15], s25 offen nt lds
    v_mfma_f32_16x16x32_bf16 v[24:27], a[200:203], v[216:219], v[24:27]
    s_add_u32 m0, s26, 58240
    v_exp_f32 v16, v16
    v_mfma_f32_16x16x32_bf16 v[24:27], a[204:207], v[220:223], v[24:27]
    buffer_load_dwordx4 v3, s[12:15], s25 offen offset:128 nt lds
    v_mfma_f32_16x16x32_bf16 v[28:31], a[220:223], v[220:223], 0
    s_add_u32 m0, s26, 122880
    v_exp_f32 v17, v17
    v_mfma_f32_16x16x32_bf16 v[28:31], a[216:219], v[216:219], v[28:31]
    buffer_load_dwordx4 v4, s[16:19], s25 offen nt lds
    v_mfma_f32_16x16x32_bf16 v[28:31], a[212:215], v[212:215], v[28:31]
    s_add_u32 m0, s26, 123776
    v_add_f32 v116, v116, v16
    v_add_f32 v116, v116, v17
    v_mfma_f32_16x16x32_bf16 v[28:31], a[208:211], v[208:211], v[28:31]
    buffer_load_dwordx4 v4, s[16:19], s25 offen offset:128 nt lds
    s_add_u32 s25, s25, 8192
    v_mfma_f32_16x16x32_bf16 a[96:99], a[224:227], v[40:43], a[96:99]
    v_exp_f32 v18, v18
    v_mfma_f32_16x16x32_bf16 a[100:103], a[228:231], v[40:43], a[100:103]
    v_exp_f32 v19, v19
    v_mfma_f32_16x16x32_bf16 a[104:107], a[232:235], v[40:43], a[104:107]
    v_cvt_pk_bf16_f32 v16, v16, v17
    v_add_f32 v116, v116, v18
    v_mfma_f32_16x16x32_bf16 a[108:111], a[236:239], v[40:43], a[108:111]
    v_exp_f32 v20, v20
    v_mfma_f32_16x16x32_bf16 a[112:115], a[240:243], v[40:43], a[112:115]
    v_add_f32 v116, v116, v19
    v_cvt_pk_bf16_f32 v17, v18, v19
    v_mfma_f32_16x16x32_bf16 a[116:119], a[244:247], v[40:43], a[116:119]
    v_exp_f32 v21, v21
    v_mfma_f32_16x16x32_bf16 a[120:123], a[248:251], v[40:43], a[120:123]
    v_add_f32 v116, v116, v20
    v_add_f32 v116, v116, v21
    v_mfma_f32_16x16x32_bf16 a[124:127], a[252:255], v[40:43], a[124:127]
    v_exp_f32 v22, v22
    v_mfma_f32_16x16x32_bf16 v[32:35], a[192:195], v[224:227], 0
    v_exp_f32 v23, v23
    v_cvt_pk_bf16_f32 v18, v20, v21
    v_add_f32 v116, v116, v22
    v_mfma_f32_16x16x32_bf16 v[32:35], a[196:199], v[228:231], v[32:35]
    v_add_f32 v116, v116, v23
    v_cvt_pk_bf16_f32 v19, v22, v23
    v_exp_f32 v24, v24
    v_mfma_f32_16x16x32_bf16 v[32:35], a[200:203], v[232:235], v[32:35]
    v_exp_f32 v25, v25
    v_add_f32 v117, v117, v24
    v_add_f32 v117, v117, v25
    v_mfma_f32_16x16x32_bf16 v[32:35], a[204:207], v[236:239], v[32:35]
    v_exp_f32 v26, v26
    v_exp_f32 v27, v27
    v_mfma_f32_16x16x32_bf16 v[36:39], a[220:223], v[236:239], 0
    v_cvt_pk_bf16_f32 v24, v24, v25
    v_add_f32 v117, v117, v26
    v_exp_f32 v28, v28
    v_mfma_f32_16x16x32_bf16 v[36:39], a[216:219], v[232:235], v[36:39]
    v_add_f32 v117, v117, v27
    v_cvt_pk_bf16_f32 v25, v26, v27
    v_exp_f32 v29, v29
    v_mfma_f32_16x16x32_bf16 v[36:39], a[212:215], v[228:231], v[36:39]
    v_add_f32 v117, v117, v28
    v_add_f32 v117, v117, v29
    v_exp_f32 v30, v30
    v_mfma_f32_16x16x32_bf16 v[36:39], a[208:211], v[224:227], v[36:39]
    v_exp_f32 v31, v31
    v_cvt_pk_bf16_f32 v26, v28, v29
    v_add_f32 v117, v117, v30
    v_mfma_f32_16x16x32_bf16 a[128:131], a[224:227], v[16:19], a[128:131]
    v_add_f32 v117, v117, v31
    v_cvt_pk_bf16_f32 v27, v30, v31
    v_mfma_f32_16x16x32_bf16 a[132:135], a[228:231], v[16:19], a[132:135]
    v_exp_f32 v32, v32
    v_mfma_f32_16x16x32_bf16 a[136:139], a[232:235], v[16:19], a[136:139]
    v_exp_f32 v33, v33
    v_mfma_f32_16x16x32_bf16 a[140:143], a[236:239], v[16:19], a[140:143]
    v_add_f32 v118, v118, v32
    v_add_f32 v118, v118, v33
    v_mfma_f32_16x16x32_bf16 a[144:147], a[240:243], v[16:19], a[144:147]
    v_exp_f32 v34, v34
    v_mfma_f32_16x16x32_bf16 a[148:151], a[244:247], v[16:19], a[148:151]
    v_exp_f32 v35, v35
    v_mfma_f32_16x16x32_bf16 a[152:155], a[248:251], v[16:19], a[152:155]
    v_cvt_pk_bf16_f32 v32, v32, v33
    v_add_f32 v118, v118, v34
    v_mfma_f32_16x16x32_bf16 a[156:159], a[252:255], v[16:19], a[156:159]
    v_exp_f32 v36, v36
    v_mfma_f32_16x16x32_bf16 v[40:43], a[192:195], v[240:243], v[124:127]
    v_add_f32 v118, v118, v35
    v_cvt_pk_bf16_f32 v33, v34, v35
    v_mfma_f32_16x16x32_bf16 v[40:43], a[196:199], v[244:247], v[40:43]
    ds_read_b128 a[192:195], v1 offset:32768
    ds_read_b128 a[196:199], v1 offset:33280
    v_mfma_f32_16x16x32_bf16 v[40:43], a[200:203], v[248:251], v[40:43]
    v_exp_f32 v37, v37
    v_mfma_f32_16x16x32_bf16 v[40:43], a[204:207], v[252:255], v[40:43]
    v_add_f32 v118, v118, v36
    v_add_f32 v118, v118, v37
    v_mfma_f32_16x16x32_bf16 v[44:47], a[220:223], v[252:255], v[124:127]
    v_exp_f32 v38, v38
    v_mfma_f32_16x16x32_bf16 v[44:47], a[216:219], v[248:251], v[44:47]
    ds_read_b128 a[200:203], v1 offset:33792
    ds_read_b128 a[204:207], v1 offset:34304
    v_mfma_f32_16x16x32_bf16 v[44:47], a[212:215], v[244:247], v[44:47]
    v_exp_f32 v39, v39
    v_mfma_f32_16x16x32_bf16 v[44:47], a[208:211], v[240:243], v[44:47]
    v_cvt_pk_bf16_f32 v34, v36, v37
    v_add_f32 v118, v118, v38
    v_mfma_f32_16x16x32_bf16 a[160:163], a[224:227], v[24:27], a[160:163]
    v_add_f32 v118, v118, v39
    v_cvt_pk_bf16_f32 v35, v38, v39
    v_mfma_f32_16x16x32_bf16 a[164:167], a[228:231], v[24:27], a[164:167]
    ds_read_b128 a[220:223], v1 offset:38400
    ds_read_b128 a[216:219], v1 offset:37888
    v_mfma_f32_16x16x32_bf16 a[168:171], a[232:235], v[24:27], a[168:171]
    v_exp_f32 v40, v40
    v_mfma_f32_16x16x32_bf16 a[172:175], a[236:239], v[24:27], a[172:175]
    v_exp_f32 v41, v41
    v_mfma_f32_16x16x32_bf16 a[176:179], a[240:243], v[24:27], a[176:179]
    v_add_f32 v119, v119, v40
    v_add_f32 v119, v119, v41
    v_mfma_f32_16x16x32_bf16 a[180:183], a[244:247], v[24:27], a[180:183]
    ds_read_b128 a[212:215], v1 offset:37376
    ds_read_b128 a[208:211], v1 offset:36864
    v_mfma_f32_16x16x32_bf16 a[184:187], a[248:251], v[24:27], a[184:187]
    v_exp_f32 v42, v42
    v_mfma_f32_16x16x32_bf16 a[188:191], a[252:255], v[24:27], a[188:191]
    v_exp_f32 v43, v43
    s_waitcnt lgkmcnt(7)
    v_mfma_f32_16x16x32_bf16 v[16:19], a[192:195], v[128:131], 0
    s_waitcnt lgkmcnt(6)
    v_cvt_pk_bf16_f32 v40, v40, v41
    v_add_f32 v119, v119, v42
    v_mfma_f32_16x16x32_bf16 v[16:19], a[196:199], v[132:135], v[16:19]
    s_waitcnt lgkmcnt(5)
    v_exp_f32 v44, v44
    v_mfma_f32_16x16x32_bf16 v[16:19], a[200:203], v[136:139], v[16:19]
    s_waitcnt lgkmcnt(4)
    v_add_f32 v119, v119, v43
    v_cvt_pk_bf16_f32 v41, v42, v43
    v_mfma_f32_16x16x32_bf16 v[16:19], a[204:207], v[140:143], v[16:19]
    s_waitcnt lgkmcnt(3)
    v_exp_f32 v45, v45
    v_mfma_f32_16x16x32_bf16 v[20:23], a[220:223], v[140:143], 0
    s_waitcnt lgkmcnt(2)
    v_add_f32 v119, v119, v44
    v_add_f32 v119, v119, v45
    v_mfma_f32_16x16x32_bf16 v[20:23], a[216:219], v[136:139], v[20:23]
    s_waitcnt lgkmcnt(1)
    v_exp_f32 v46, v46
    v_mfma_f32_16x16x32_bf16 v[20:23], a[212:215], v[132:135], v[20:23]
    s_waitcnt lgkmcnt(0)
    v_exp_f32 v47, v47
    v_mfma_f32_16x16x32_bf16 v[20:23], a[208:211], v[128:131], v[20:23]
    v_cvt_pk_bf16_f32 v42, v44, v45
    v_add_f32 v119, v119, v46
    v_mfma_f32_16x16x32_bf16 v[48:51], a[224:227], v[32:35], v[48:51]
    v_add_f32 v119, v119, v47
    v_cvt_pk_bf16_f32 v43, v46, v47
    v_mfma_f32_16x16x32_bf16 v[52:55], a[228:231], v[32:35], v[52:55]
    v_exp_f32 v16, v16
    v_mfma_f32_16x16x32_bf16 v[56:59], a[232:235], v[32:35], v[56:59]
    v_exp_f32 v17, v17
    v_mfma_f32_16x16x32_bf16 v[60:63], a[236:239], v[32:35], v[60:63]
    v_add_f32 v112, v112, v16
    v_add_f32 v112, v112, v17
    v_mfma_f32_16x16x32_bf16 v[64:67], a[240:243], v[32:35], v[64:67]
    v_exp_f32 v18, v18
    v_mfma_f32_16x16x32_bf16 v[68:71], a[244:247], v[32:35], v[68:71]
    v_exp_f32 v19, v19
    v_mfma_f32_16x16x32_bf16 v[72:75], a[248:251], v[32:35], v[72:75]
    v_cvt_pk_bf16_f32 v16, v16, v17
    v_add_f32 v112, v112, v18
    v_mfma_f32_16x16x32_bf16 v[76:79], a[252:255], v[32:35], v[76:79]
    v_exp_f32 v20, v20
    v_mfma_f32_16x16x32_bf16 v[24:27], a[192:195], v[144:147], 0
    v_add_f32 v112, v112, v19
    v_cvt_pk_bf16_f32 v17, v18, v19
    v_mfma_f32_16x16x32_bf16 v[24:27], a[196:199], v[148:151], v[24:27]
    v_exp_f32 v21, v21
    v_mfma_f32_16x16x32_bf16 v[24:27], a[200:203], v[152:155], v[24:27]
    v_add_f32 v112, v112, v20
    v_add_f32 v112, v112, v21
    v_mfma_f32_16x16x32_bf16 v[24:27], a[204:207], v[156:159], v[24:27]
    v_exp_f32 v22, v22
    v_mfma_f32_16x16x32_bf16 v[28:31], a[220:223], v[156:159], 0
    v_exp_f32 v23, v23
    v_mfma_f32_16x16x32_bf16 v[28:31], a[216:219], v[152:155], v[28:31]
    v_cvt_pk_bf16_f32 v18, v20, v21
    v_add_f32 v112, v112, v22
    v_mfma_f32_16x16x32_bf16 v[28:31], a[212:215], v[148:151], v[28:31]
    v_add_f32 v112, v112, v23
    v_cvt_pk_bf16_f32 v19, v22, v23
    v_mfma_f32_16x16x32_bf16 v[28:31], a[208:211], v[144:147], v[28:31]
    v_exp_f32 v24, v24
    v_mfma_f32_16x16x32_bf16 v[80:83], a[224:227], v[40:43], v[80:83]
    ds_read_b64_tr_b16 a[224:225], v2 offset:32768
    ds_read_b64_tr_b16 a[226:227], v2 offset:36864
    v_mfma_f32_16x16x32_bf16 v[84:87], a[228:231], v[40:43], v[84:87]
    v_exp_f32 v25, v25
    v_mfma_f32_16x16x32_bf16 v[88:91], a[232:235], v[40:43], v[88:91]
    ds_read_b64_tr_b16 a[228:229], v2 offset:33024
    ds_read_b64_tr_b16 a[230:231], v2 offset:37120
    v_mfma_f32_16x16x32_bf16 v[92:95], a[236:239], v[40:43], v[92:95]
    v_add_f32 v113, v113, v24
    v_add_f32 v113, v113, v25
    v_mfma_f32_16x16x32_bf16 v[96:99], a[240:243], v[40:43], v[96:99]
    ds_read_b64_tr_b16 a[232:233], v2 offset:33280
    ds_read_b64_tr_b16 a[234:235], v2 offset:37376
    v_mfma_f32_16x16x32_bf16 v[100:103], a[244:247], v[40:43], v[100:103]
    v_exp_f32 v26, v26
    v_mfma_f32_16x16x32_bf16 v[104:107], a[248:251], v[40:43], v[104:107]
    ds_read_b64_tr_b16 a[236:237], v2 offset:33536
    ds_read_b64_tr_b16 a[238:239], v2 offset:37632
    v_mfma_f32_16x16x32_bf16 v[108:111], a[252:255], v[40:43], v[108:111]
    v_exp_f32 v27, v27
    s_mov_b32 s27, 3
.p2align 6
L_loop:
    v_mfma_f32_16x16x32_bf16 v[32:35], a[192:195], v[160:163], 0
    ds_read_b64_tr_b16 a[240:241], v2 offset:33792
    ds_read_b64_tr_b16 a[242:243], v2 offset:37888
    v_mfma_f32_16x16x32_bf16 v[32:35], a[196:199], v[164:167], v[32:35]
    v_cvt_pk_bf16_f32 v24, v24, v25
    v_add_f32 v113, v113, v26
    v_mfma_f32_16x16x32_bf16 v[32:35], a[200:203], v[168:171], v[32:35]
    ds_read_b64_tr_b16 a[244:245], v2 offset:34048
    ds_read_b64_tr_b16 a[246:247], v2 offset:38144
    v_mfma_f32_16x16x32_bf16 v[32:35], a[204:207], v[172:175], v[32:35]
    v_exp_f32 v28, v28
    v_mfma_f32_16x16x32_bf16 v[36:39], a[220:223], v[172:175], 0
    ds_read_b64_tr_b16 a[248:249], v2 offset:34304
    ds_read_b64_tr_b16 a[250:251], v2 offset:38400
    v_mfma_f32_16x16x32_bf16 v[36:39], a[216:219], v[168:171], v[36:39]
    v_add_f32 v113, v113, v27
    v_cvt_pk_bf16_f32 v25, v26, v27
    v_mfma_f32_16x16x32_bf16 v[36:39], a[212:215], v[164:167], v[36:39]
    ds_read_b64_tr_b16 a[252:253], v2 offset:34560
    ds_read_b64_tr_b16 a[254:255], v2 offset:38656
    v_mfma_f32_16x16x32_bf16 v[36:39], a[208:211], v[160:163], v[36:39]
    s_waitcnt lgkmcnt(14)
    v_exp_f32 v29, v29
    v_mfma_f32_16x16x32_bf16 a[0:3], a[224:227], v[16:19], a[0:3]
    s_waitcnt lgkmcnt(12)
    v_add_f32 v113, v113, v28
    v_add_f32 v113, v113, v29
    v_mfma_f32_16x16x32_bf16 a[4:7], a[228:231], v[16:19], a[4:7]
    s_waitcnt lgkmcnt(10)
    v_exp_f32 v30, v30
    v_mfma_f32_16x16x32_bf16 a[8:11], a[232:235], v[16:19], a[8:11]
    s_waitcnt lgkmcnt(8)
    v_exp_f32 v31, v31
    v_mfma_f32_16x16x32_bf16 a[12:15], a[236:239], v[16:19], a[12:15]
    s_waitcnt lgkmcnt(6)
    v_cvt_pk_bf16_f32 v26, v28, v29
    v_add_f32 v113, v113, v30
    v_mfma_f32_16x16x32_bf16 a[16:19], a[240:243], v[16:19], a[16:19]
    s_waitcnt lgkmcnt(4)
    v_add_f32 v113, v113, v31
    v_cvt_pk_bf16_f32 v27, v30, v31
    v_mfma_f32_16x16x32_bf16 a[20:23], a[244:247], v[16:19], a[20:23]
    s_waitcnt lgkmcnt(2)
    v_exp_f32 v32, v32
    v_mfma_f32_16x16x32_bf16 a[24:27], a[248:251], v[16:19], a[24:27]
    s_waitcnt lgkmcnt(0)
    v_exp_f32 v33, v33
    v_mfma_f32_16x16x32_bf16 a[28:31], a[252:255], v[16:19], a[28:31]
    v_add_f32 v114, v114, v32
    v_add_f32 v114, v114, v33
    v_mfma_f32_16x16x32_bf16 v[40:43], a[192:195], v[176:179], 0
    s_waitcnt vmcnt(8)
    v_exp_f32 v34, v34
    v_mfma_f32_16x16x32_bf16 v[40:43], a[196:199], v[180:183], v[40:43]
    s_barrier
    v_exp_f32 v35, v35
    v_mfma_f32_16x16x32_bf16 v[40:43], a[200:203], v[184:187], v[40:43]
    v_cvt_pk_bf16_f32 v32, v32, v33
    v_add_f32 v114, v114, v34
    v_mfma_f32_16x16x32_bf16 v[40:43], a[204:207], v[188:191], v[40:43]
    s_add_u32 m0, s26, 0
    v_exp_f32 v36, v36
    v_mfma_f32_16x16x32_bf16 v[44:47], a[220:223], v[188:191], 0
    buffer_load_dwordx4 v3, s[12:15], s25 offen nt lds
    v_mfma_f32_16x16x32_bf16 v[44:47], a[216:219], v[184:187], v[44:47]
    v_add_f32 v114, v114, v35
    v_cvt_pk_bf16_f32 v33, v34, v35
    v_mfma_f32_16x16x32_bf16 v[44:47], a[212:215], v[180:183], v[44:47]
    s_add_u32 m0, s26, 896
    v_exp_f32 v37, v37
    v_mfma_f32_16x16x32_bf16 v[44:47], a[208:211], v[176:179], v[44:47]
    buffer_load_dwordx4 v3, s[12:15], s25 offen offset:128 nt lds
    v_mfma_f32_16x16x32_bf16 a[32:35], a[224:227], v[24:27], a[32:35]
    v_add_f32 v114, v114, v36
    v_add_f32 v114, v114, v37
    v_mfma_f32_16x16x32_bf16 a[36:39], a[228:231], v[24:27], a[36:39]
    s_add_u32 m0, s26, 65536
    v_exp_f32 v38, v38
    v_mfma_f32_16x16x32_bf16 a[40:43], a[232:235], v[24:27], a[40:43]
    buffer_load_dwordx4 v4, s[16:19], s25 offen nt lds
    v_mfma_f32_16x16x32_bf16 a[44:47], a[236:239], v[24:27], a[44:47]
    v_exp_f32 v39, v39
    v_mfma_f32_16x16x32_bf16 a[48:51], a[240:243], v[24:27], a[48:51]
    s_add_u32 m0, s26, 66432
    v_cvt_pk_bf16_f32 v34, v36, v37
    v_add_f32 v114, v114, v38
    v_mfma_f32_16x16x32_bf16 a[52:55], a[244:247], v[24:27], a[52:55]
    buffer_load_dwordx4 v4, s[16:19], s25 offen offset:128 nt lds
    v_mfma_f32_16x16x32_bf16 a[56:59], a[248:251], v[24:27], a[56:59]
    s_add_u32 s25, s25, 8192
    v_add_f32 v114, v114, v39
    v_cvt_pk_bf16_f32 v35, v38, v39
    v_mfma_f32_16x16x32_bf16 a[60:63], a[252:255], v[24:27], a[60:63]
    v_exp_f32 v40, v40
    v_mfma_f32_16x16x32_bf16 v[16:19], a[192:195], v[192:195], 0
    v_exp_f32 v41, v41
    v_mfma_f32_16x16x32_bf16 v[16:19], a[196:199], v[196:199], v[16:19]
    v_add_f32 v115, v115, v40
    v_add_f32 v115, v115, v41
    v_mfma_f32_16x16x32_bf16 v[16:19], a[200:203], v[200:203], v[16:19]
    v_exp_f32 v42, v42
    v_mfma_f32_16x16x32_bf16 v[16:19], a[204:207], v[204:207], v[16:19]
    v_exp_f32 v43, v43
    v_mfma_f32_16x16x32_bf16 v[20:23], a[220:223], v[204:207], 0
    v_cvt_pk_bf16_f32 v40, v40, v41
    v_add_f32 v115, v115, v42
    v_mfma_f32_16x16x32_bf16 v[20:23], a[216:219], v[200:203], v[20:23]
    v_exp_f32 v44, v44
    v_mfma_f32_16x16x32_bf16 v[20:23], a[212:215], v[196:199], v[20:23]
    v_add_f32 v115, v115, v43
    v_cvt_pk_bf16_f32 v41, v42, v43
    v_mfma_f32_16x16x32_bf16 v[20:23], a[208:211], v[192:195], v[20:23]
    v_exp_f32 v45, v45
    v_mfma_f32_16x16x32_bf16 a[64:67], a[224:227], v[32:35], a[64:67]
    v_add_f32 v115, v115, v44
    v_add_f32 v115, v115, v45
    v_mfma_f32_16x16x32_bf16 a[68:71], a[228:231], v[32:35], a[68:71]
    v_exp_f32 v46, v46
    v_mfma_f32_16x16x32_bf16 a[72:75], a[232:235], v[32:35], a[72:75]
    v_exp_f32 v47, v47
    v_mfma_f32_16x16x32_bf16 a[76:79], a[236:239], v[32:35], a[76:79]
    v_cvt_pk_bf16_f32 v42, v44, v45
    v_add_f32 v115, v115, v46
    v_mfma_f32_16x16x32_bf16 a[80:83], a[240:243], v[32:35], a[80:83]
    v_add_f32 v115, v115, v47
    v_cvt_pk_bf16_f32 v43, v46, v47
    v_mfma_f32_16x16x32_bf16 a[84:87], a[244:247], v[32:35], a[84:87]
    v_exp_f32 v16, v16
    v_mfma_f32_16x16x32_bf16 a[88:91], a[248:251], v[32:35], a[88:91]
    v_exp_f32 v17, v17
    v_mfma_f32_16x16x32_bf16 a[92:95], a[252:255], v[32:35], a[92:95]
    v_add_f32 v116, v116, v16
    v_add_f32 v116, v116, v17
    v_mfma_f32_16x16x32_bf16 v[24:27], a[192:195], v[208:211], 0
    v_exp_f32 v18, v18
    v_mfma_f32_16x16x32_bf16 v[24:27], a[196:199], v[212:215], v[24:27]
    v_exp_f32 v19, v19
    v_mfma_f32_16x16x32_bf16 v[24:27], a[200:203], v[216:219], v[24:27]
    v_cvt_pk_bf16_f32 v16, v16, v17
    v_add_f32 v116, v116, v18
    v_mfma_f32_16x16x32_bf16 v[24:27], a[204:207], v[220:223], v[24:27]
    v_exp_f32 v20, v20
    v_mfma_f32_16x16x32_bf16 v[28:31], a[220:223], v[220:223], 0
    v_add_f32 v116, v116, v19
    v_cvt_pk_bf16_f32 v17, v18, v19
    v_mfma_f32_16x16x32_bf16 v[28:31], a[216:219], v[216:219], v[28:31]
    v_exp_f32 v21, v21
    v_mfma_f32_16x16x32_bf16 v[28:31], a[212:215], v[212:215], v[28:31]
    v_add_f32 v116, v116, v20
    v_add_f32 v116, v116, v21
    v_mfma_f32_16x16x32_bf16 v[28:31], a[208:211], v[208:211], v[28:31]
    v_exp_f32 v22, v22
    v_mfma_f32_16x16x32_bf16 a[96:99], a[224:227], v[40:43], a[96:99]
    v_exp_f32 v23, v23
    v_mfma_f32_16x16x32_bf16 a[100:103], a[228:231], v[40:43], a[100:103]
    v_cvt_pk_bf16_f32 v18, v20, v21
    v_add_f32 v116, v116, v22
    v_mfma_f32_16x16x32_bf16 a[104:107], a[232:235], v[40:43], a[104:107]
    v_add_f32 v116, v116, v23
    v_cvt_pk_bf16_f32 v19, v22, v23
    v_mfma_f32_16x16x32_bf16 a[108:111], a[236:239], v[40:43], a[108:111]
    v_exp_f32 v24, v24
    v_mfma_f32_16x16x32_bf16 a[112:115], a[240:243], v[40:43], a[112:115]
    v_exp_f32 v25, v25
    v_mfma_f32_16x16x32_bf16 a[116:119], a[244:247], v[40:43], a[116:119]
    v_add_f32 v117, v117, v24
    v_add_f32 v117, v117, v25
    v_mfma_f32_16x16x32_bf16 a[120:123], a[248:251], v[40:43], a[120:123]
    v_exp_f32 v26, v26
    v_mfma_f32_16x16x32_bf16 a[124:127], a[252:255], v[40:43], a[124:127]
    v_exp_f32 v27, v27
    v_mfma_f32_16x16x32_bf16 v[32:35], a[192:195], v[224:227], 0
    v_cvt_pk_bf16_f32 v24, v24, v25
    v_add_f32 v117, v117, v26
    v_mfma_f32_16x16x32_bf16 v[32:35], a[196:199], v[228:231], v[32:35]
    v_exp_f32 v28, v28
    v_mfma_f32_16x16x32_bf16 v[32:35], a[200:203], v[232:235], v[32:35]
    v_add_f32 v117, v117, v27
    v_cvt_pk_bf16_f32 v25, v26, v27
    v_mfma_f32_16x16x32_bf16 v[32:35], a[204:207], v[236:239], v[32:35]
    v_exp_f32 v29, v29
    v_mfma_f32_16x16x32_bf16 v[36:39], a[220:223], v[236:239], 0
    v_add_f32 v117, v117, v28
    v_add_f32 v117, v117, v29
    v_mfma_f32_16x16x32_bf16 v[36:39], a[216:219], v[232:235], v[36:39]
    v_exp_f32 v30, v30
    v_mfma_f32_16x16x32_bf16 v[36:39], a[212:215], v[228:231], v[36:39]
    v_exp_f32 v31, v31
    v_mfma_f32_16x16x32_bf16 v[36:39], a[208:211], v[224:227], v[36:39]
    v_cvt_pk_bf16_f32 v26, v28, v29
    v_add_f32 v117, v117, v30
    v_mfma_f32_16x16x32_bf16 a[128:131], a[224:227], v[16:19], a[128:131]
    v_add_f32 v117, v117, v31
    v_cvt_pk_bf16_f32 v27, v30, v31
    v_mfma_f32_16x16x32_bf16 a[132:135], a[228:231], v[16:19], a[132:135]
    v_exp_f32 v32, v32
    v_mfma_f32_16x16x32_bf16 a[136:139], a[232:235], v[16:19], a[136:139]
    v_exp_f32 v33, v33
    v_mfma_f32_16x16x32_bf16 a[140:143], a[236:239], v[16:19], a[140:143]
    v_add_f32 v118, v118, v32
    v_add_f32 v118, v118, v33
    v_mfma_f32_16x16x32_bf16 a[144:147], a[240:243], v[16:19], a[144:147]
    v_exp_f32 v34, v34
    v_mfma_f32_16x16x32_bf16 a[148:151], a[244:247], v[16:19], a[148:151]
    v_exp_f32 v35, v35
    v_mfma_f32_16x16x32_bf16 a[152:155], a[248:251], v[16:19], a[152:155]
    v_cvt_pk_bf16_f32 v32, v32, v33
    v_add_f32 v118, v118, v34
    v_mfma_f32_16x16x32_bf16 a[156:159], a[252:255], v[16:19], a[156:159]
    v_exp_f32 v36, v36
    v_mfma_f32_16x16x32_bf16 v[40:43], a[192:195], v[240:243], v[124:127]
    v_add_f32 v118, v118, v35
    v_cvt_pk_bf16_f32 v33, v34, v35
    v_mfma_f32_16x16x32_bf16 v[40:43], a[196:199], v[244:247], v[40:43]
    ds_read_b128 a[192:195], v1 offset:40960
    ds_read_b128 a[196:199], v1 offset:41472
    v_mfma_f32_16x16x32_bf16 v[40:43], a[200:203], v[248:251], v[40:43]
    v_exp_f32 v37, v37
    v_mfma_f32_16x16x32_bf16 v[40:43], a[204:207], v[252:255], v[40:43]
    v_add_f32 v118, v118, v36
    v_add_f32 v118, v118, v37
    v_mfma_f32_16x16x32_bf16 v[44:47], a[220:223], v[252:255], v[124:127]
    v_exp_f32 v38, v38
    v_mfma_f32_16x16x32_bf16 v[44:47], a[216:219], v[248:251], v[44:47]
    ds_read_b128 a[200:203], v1 offset:41984
    ds_read_b128 a[204:207], v1 offset:42496
    v_mfma_f32_16x16x32_bf16 v[44:47], a[212:215], v[244:247], v[44:47]
    v_exp_f32 v39, v39
    v_mfma_f32_16x16x32_bf16 v[44:47], a[208:211], v[240:243], v[44:47]
    v_cvt_pk_bf16_f32 v34, v36, v37
    v_add_f32 v118, v118, v38
    v_mfma_f32_16x16x32_bf16 a[160:163], a[224:227], v[24:27], a[160:163]
    v_add_f32 v118, v118, v39
    v_cvt_pk_bf16_f32 v35, v38, v39
    v_mfma_f32_16x16x32_bf16 a[164:167], a[228:231], v[24:27], a[164:167]
    ds_read_b128 a[220:223], v1 offset:46592
    ds_read_b128 a[216:219], v1 offset:46080
    v_mfma_f32_16x16x32_bf16 a[168:171], a[232:235], v[24:27], a[168:171]
    v_exp_f32 v40, v40
    v_mfma_f32_16x16x32_bf16 a[172:175], a[236:239], v[24:27], a[172:175]
    v_exp_f32 v41, v41
    v_mfma_f32_16x16x32_bf16 a[176:179], a[240:243], v[24:27], a[176:179]
    v_add_f32 v119, v119, v40
    v_add_f32 v119, v119, v41
    v_mfma_f32_16x16x32_bf16 a[180:183], a[244:247], v[24:27], a[180:183]
    ds_read_b128 a[212:215], v1 offset:45568
    ds_read_b128 a[208:211], v1 offset:45056
    v_mfma_f32_16x16x32_bf16 a[184:187], a[248:251], v[24:27], a[184:187]
    v_exp_f32 v42, v42
    v_mfma_f32_16x16x32_bf16 a[188:191], a[252:255], v[24:27], a[188:191]
    s_waitcnt lgkmcnt(7)
    v_exp_f32 v43, v43
    v_mfma_f32_16x16x32_bf16 v[16:19], a[192:195], v[128:131], 0
    s_waitcnt lgkmcnt(6)
    v_cvt_pk_bf16_f32 v40, v40, v41
    v_add_f32 v119, v119, v42
    v_mfma_f32_16x16x32_bf16 v[16:19], a[196:199], v[132:135], v[16:19]
    s_waitcnt lgkmcnt(5)
    v_exp_f32 v44, v44
    v_mfma_f32_16x16x32_bf16 v[16:19], a[200:203], v[136:139], v[16:19]
    s_waitcnt lgkmcnt(4)
    v_add_f32 v119, v119, v43
    v_cvt_pk_bf16_f32 v41, v42, v43
    v_mfma_f32_16x16x32_bf16 v[16:19], a[204:207], v[140:143], v[16:19]
    s_waitcnt lgkmcnt(3)
    v_exp_f32 v45, v45
    v_mfma_f32_16x16x32_bf16 v[20:23], a[220:223], v[140:143], 0
    s_waitcnt lgkmcnt(2)
    v_add_f32 v119, v119, v44
    v_add_f32 v119, v119, v45
    v_mfma_f32_16x16x32_bf16 v[20:23], a[216:219], v[136:139], v[20:23]
    s_waitcnt lgkmcnt(1)
    v_exp_f32 v46, v46
    v_mfma_f32_16x16x32_bf16 v[20:23], a[212:215], v[132:135], v[20:23]
    s_waitcnt lgkmcnt(0)
    v_exp_f32 v47, v47
    v_mfma_f32_16x16x32_bf16 v[20:23], a[208:211], v[128:131], v[20:23]
    v_cvt_pk_bf16_f32 v42, v44, v45
    v_add_f32 v119, v119, v46
    v_mfma_f32_16x16x32_bf16 v[48:51], a[224:227], v[32:35], v[48:51]
    v_add_f32 v119, v119, v47
    v_cvt_pk_bf16_f32 v43, v46, v47
    v_mfma_f32_16x16x32_bf16 v[52:55], a[228:231], v[32:35], v[52:55]
    v_exp_f32 v16, v16
    v_mfma_f32_16x16x32_bf16 v[56:59], a[232:235], v[32:35], v[56:59]
    v_exp_f32 v17, v17
    v_mfma_f32_16x16x32_bf16 v[60:63], a[236:239], v[32:35], v[60:63]
    v_add_f32 v112, v112, v16
    v_add_f32 v112, v112, v17
    v_mfma_f32_16x16x32_bf16 v[64:67], a[240:243], v[32:35], v[64:67]
    v_exp_f32 v18, v18
    v_mfma_f32_16x16x32_bf16 v[68:71], a[244:247], v[32:35], v[68:71]
    v_exp_f32 v19, v19
    v_mfma_f32_16x16x32_bf16 v[72:75], a[248:251], v[32:35], v[72:75]
    v_cvt_pk_bf16_f32 v16, v16, v17
    v_add_f32 v112, v112, v18
    v_mfma_f32_16x16x32_bf16 v[76:79], a[252:255], v[32:35], v[76:79]
    v_exp_f32 v20, v20
    v_mfma_f32_16x16x32_bf16 v[24:27], a[192:195], v[144:147], 0
    v_add_f32 v112, v112, v19
    v_cvt_pk_bf16_f32 v17, v18, v19
    v_mfma_f32_16x16x32_bf16 v[24:27], a[196:199], v[148:151], v[24:27]
    v_exp_f32 v21, v21
    v_mfma_f32_16x16x32_bf16 v[24:27], a[200:203], v[152:155], v[24:27]
    v_add_f32 v112, v112, v20
    v_add_f32 v112, v112, v21
    v_mfma_f32_16x16x32_bf16 v[24:27], a[204:207], v[156:159], v[24:27]
    v_exp_f32 v22, v22
    v_mfma_f32_16x16x32_bf16 v[28:31], a[220:223], v[156:159], 0
    v_exp_f32 v23, v23
    v_mfma_f32_16x16x32_bf16 v[28:31], a[216:219], v[152:155], v[28:31]
    v_cvt_pk_bf16_f32 v18, v20, v21
    v_add_f32 v112, v112, v22
    v_mfma_f32_16x16x32_bf16 v[28:31], a[212:215], v[148:151], v[28:31]
    v_add_f32 v112, v112, v23
    v_cvt_pk_bf16_f32 v19, v22, v23
    v_mfma_f32_16x16x32_bf16 v[28:31], a[208:211], v[144:147], v[28:31]
    v_exp_f32 v24, v24
    v_mfma_f32_16x16x32_bf16 v[80:83], a[224:227], v[40:43], v[80:83]
    ds_read_b64_tr_b16 a[224:225], v2 offset:40960
    ds_read_b64_tr_b16 a[226:227], v2 offset:45056
    v_mfma_f32_16x16x32_bf16 v[84:87], a[228:231], v[40:43], v[84:87]
    v_exp_f32 v25, v25
    v_mfma_f32_16x16x32_bf16 v[88:91], a[232:235], v[40:43], v[88:91]
    ds_read_b64_tr_b16 a[228:229], v2 offset:41216
    ds_read_b64_tr_b16 a[230:231], v2 offset:45312
    v_mfma_f32_16x16x32_bf16 v[92:95], a[236:239], v[40:43], v[92:95]
    v_add_f32 v113, v113, v24
    v_add_f32 v113, v113, v25
    v_mfma_f32_16x16x32_bf16 v[96:99], a[240:243], v[40:43], v[96:99]
    ds_read_b64_tr_b16 a[232:233], v2 offset:41472
    ds_read_b64_tr_b16 a[234:235], v2 offset:45568
    v_mfma_f32_16x16x32_bf16 v[100:103], a[244:247], v[40:43], v[100:103]
    v_exp_f32 v26, v26
    v_mfma_f32_16x16x32_bf16 v[104:107], a[248:251], v[40:43], v[104:107]
    ds_read_b64_tr_b16 a[236:237], v2 offset:41728
    ds_read_b64_tr_b16 a[238:239], v2 offset:45824
    v_mfma_f32_16x16x32_bf16 v[108:111], a[252:255], v[40:43], v[108:111]
    v_exp_f32 v27, v27
    v_mfma_f32_16x16x32_bf16 v[32:35], a[192:195], v[160:163], 0
    ds_read_b64_tr_b16 a[240:241], v2 offset:41984
    ds_read_b64_tr_b16 a[242:243], v2 offset:46080
    v_mfma_f32_16x16x32_bf16 v[32:35], a[196:199], v[164:167], v[32:35]
    v_cvt_pk_bf16_f32 v24, v24, v25
    v_add_f32 v113, v113, v26
    v_mfma_f32_16x16x32_bf16 v[32:35], a[200:203], v[168:171], v[32:35]
    ds_read_b64_tr_b16 a[244:245], v2 offset:42240
    ds_read_b64_tr_b16 a[246:247], v2 offset:46336
    v_mfma_f32_16x16x32_bf16 v[32:35], a[204:207], v[172:175], v[32:35]
    v_exp_f32 v28, v28
    v_mfma_f32_16x16x32_bf16 v[36:39], a[220:223], v[172:175], 0
    ds_read_b64_tr_b16 a[248:249], v2 offset:42496
    ds_read_b64_tr_b16 a[250:251], v2 offset:46592
    v_mfma_f32_16x16x32_bf16 v[36:39], a[216:219], v[168:171], v[36:39]
    v_add_f32 v113, v113, v27
    v_cvt_pk_bf16_f32 v25, v26, v27
    v_mfma_f32_16x16x32_bf16 v[36:39], a[212:215], v[164:167], v[36:39]
    ds_read_b64_tr_b16 a[252:253], v2 offset:42752
    ds_read_b64_tr_b16 a[254:255], v2 offset:46848
    v_mfma_f32_16x16x32_bf16 v[36:39], a[208:211], v[160:163], v[36:39]
    s_waitcnt lgkmcnt(14)
    v_exp_f32 v29, v29
    v_mfma_f32_16x16x32_bf16 a[0:3], a[224:227], v[16:19], a[0:3]
    s_waitcnt lgkmcnt(12)
    v_add_f32 v113, v113, v28
    v_add_f32 v113, v113, v29
    v_mfma_f32_16x16x32_bf16 a[4:7], a[228:231], v[16:19], a[4:7]
    s_waitcnt lgkmcnt(10)
    v_exp_f32 v30, v30
    v_mfma_f32_16x16x32_bf16 a[8:11], a[232:235], v[16:19], a[8:11]
    s_waitcnt lgkmcnt(8)
    v_exp_f32 v31, v31
    v_mfma_f32_16x16x32_bf16 a[12:15], a[236:239], v[16:19], a[12:15]
    s_waitcnt lgkmcnt(6)
    v_cvt_pk_bf16_f32 v26, v28, v29
    v_add_f32 v113, v113, v30
    v_mfma_f32_16x16x32_bf16 a[16:19], a[240:243], v[16:19], a[16:19]
    s_waitcnt lgkmcnt(4)
    v_add_f32 v113, v113, v31
    v_cvt_pk_bf16_f32 v27, v30, v31
    v_mfma_f32_16x16x32_bf16 a[20:23], a[244:247], v[16:19], a[20:23]
    s_waitcnt lgkmcnt(2)
    v_exp_f32 v32, v32
    v_mfma_f32_16x16x32_bf16 a[24:27], a[248:251], v[16:19], a[24:27]
    s_waitcnt lgkmcnt(0)
    v_exp_f32 v33, v33
    v_mfma_f32_16x16x32_bf16 a[28:31], a[252:255], v[16:19], a[28:31]
    v_add_f32 v114, v114, v32
    v_add_f32 v114, v114, v33
    v_mfma_f32_16x16x32_bf16 v[40:43], a[192:195], v[176:179], 0
    s_waitcnt vmcnt(8)
    v_exp_f32 v34, v34
    v_mfma_f32_16x16x32_bf16 v[40:43], a[196:199], v[180:183], v[40:43]
    s_barrier
    v_exp_f32 v35, v35
    v_mfma_f32_16x16x32_bf16 v[40:43], a[200:203], v[184:187], v[40:43]
    v_cvt_pk_bf16_f32 v32, v32, v33
    v_add_f32 v114, v114, v34
    v_mfma_f32_16x16x32_bf16 v[40:43], a[204:207], v[188:191], v[40:43]
    s_add_u32 m0, s26, 8192
    v_exp_f32 v36, v36
    v_mfma_f32_16x16x32_bf16 v[44:47], a[220:223], v[188:191], 0
    buffer_load_dwordx4 v3, s[12:15], s25 offen nt lds
    v_mfma_f32_16x16x32_bf16 v[44:47], a[216:219], v[184:187], v[44:47]
    v_add_f32 v114, v114, v35
    v_cvt_pk_bf16_f32 v33, v34, v35
    v_mfma_f32_16x16x32_bf16 v[44:47], a[212:215], v[180:183], v[44:47]
    s_add_u32 m0, s26, 9088
    v_exp_f32 v37, v37
    v_mfma_f32_16x16x32_bf16 v[44:47], a[208:211], v[176:179], v[44:47]
    buffer_load_dwordx4 v3, s[12:15], s25 offen offset:128 nt lds
    v_mfma_f32_16x16x32_bf16 a[32:35], a[224:227], v[24:27], a[32:35]
    v_add_f32 v114, v114, v36
    v_add_f32 v114, v114, v37
    v_mfma_f32_16x16x32_bf16 a[36:39], a[228:231], v[24:27], a[36:39]
    s_add_u32 m0, s26, 73728
    v_exp_f32 v38, v38
    v_mfma_f32_16x16x32_bf16 a[40:43], a[232:235], v[24:27], a[40:43]
    buffer_load_dwordx4 v4, s[16:19], s25 offen nt lds
    v_mfma_f32_16x16x32_bf16 a[44:47], a[236:239], v[24:27], a[44:47]
    v_exp_f32 v39, v39
    v_mfma_f32_16x16x32_bf16 a[48:51], a[240:243], v[24:27], a[48:51]
    s_add_u32 m0, s26, 74624
    v_cvt_pk_bf16_f32 v34, v36, v37
    v_add_f32 v114, v114, v38
    v_mfma_f32_16x16x32_bf16 a[52:55], a[244:247], v[24:27], a[52:55]
    buffer_load_dwordx4 v4, s[16:19], s25 offen offset:128 nt lds
    v_mfma_f32_16x16x32_bf16 a[56:59], a[248:251], v[24:27], a[56:59]
    s_add_u32 s25, s25, 8192
    v_add_f32 v114, v114, v39
    v_cvt_pk_bf16_f32 v35, v38, v39
    v_mfma_f32_16x16x32_bf16 a[60:63], a[252:255], v[24:27], a[60:63]
    v_exp_f32 v40, v40
    v_mfma_f32_16x16x32_bf16 v[16:19], a[192:195], v[192:195], 0
    v_exp_f32 v41, v41
    v_mfma_f32_16x16x32_bf16 v[16:19], a[196:199], v[196:199], v[16:19]
    v_add_f32 v115, v115, v40
    v_add_f32 v115, v115, v41
    v_mfma_f32_16x16x32_bf16 v[16:19], a[200:203], v[200:203], v[16:19]
    v_exp_f32 v42, v42
    v_mfma_f32_16x16x32_bf16 v[16:19], a[204:207], v[204:207], v[16:19]
    v_exp_f32 v43, v43
    v_mfma_f32_16x16x32_bf16 v[20:23], a[220:223], v[204:207], 0
    v_cvt_pk_bf16_f32 v40, v40, v41
    v_add_f32 v115, v115, v42
    v_mfma_f32_16x16x32_bf16 v[20:23], a[216:219], v[200:203], v[20:23]
    v_exp_f32 v44, v44
    v_mfma_f32_16x16x32_bf16 v[20:23], a[212:215], v[196:199], v[20:23]
    v_add_f32 v115, v115, v43
    v_cvt_pk_bf16_f32 v41, v42, v43
    v_mfma_f32_16x16x32_bf16 v[20:23], a[208:211], v[192:195], v[20:23]
    v_exp_f32 v45, v45
    v_mfma_f32_16x16x32_bf16 a[64:67], a[224:227], v[32:35], a[64:67]
    v_add_f32 v115, v115, v44
    v_add_f32 v115, v115, v45
    v_mfma_f32_16x16x32_bf16 a[68:71], a[228:231], v[32:35], a[68:71]
    v_exp_f32 v46, v46
    v_mfma_f32_16x16x32_bf16 a[72:75], a[232:235], v[32:35], a[72:75]
    v_exp_f32 v47, v47
    v_mfma_f32_16x16x32_bf16 a[76:79], a[236:239], v[32:35], a[76:79]
    v_cvt_pk_bf16_f32 v42, v44, v45
    v_add_f32 v115, v115, v46
    v_mfma_f32_16x16x32_bf16 a[80:83], a[240:243], v[32:35], a[80:83]
    v_add_f32 v115, v115, v47
    v_cvt_pk_bf16_f32 v43, v46, v47
    v_mfma_f32_16x16x32_bf16 a[84:87], a[244:247], v[32:35], a[84:87]
    v_exp_f32 v16, v16
    v_mfma_f32_16x16x32_bf16 a[88:91], a[248:251], v[32:35], a[88:91]
    v_exp_f32 v17, v17
    v_mfma_f32_16x16x32_bf16 a[92:95], a[252:255], v[32:35], a[92:95]
    v_add_f32 v116, v116, v16
    v_add_f32 v116, v116, v17
    v_mfma_f32_16x16x32_bf16 v[24:27], a[192:195], v[208:211], 0
    v_exp_f32 v18, v18
    v_mfma_f32_16x16x32_bf16 v[24:27], a[196:199], v[212:215], v[24:27]
    v_exp_f32 v19, v19
    v_mfma_f32_16x16x32_bf16 v[24:27], a[200:203], v[216:219], v[24:27]
    v_cvt_pk_bf16_f32 v16, v16, v17
    v_add_f32 v116, v116, v18
    v_mfma_f32_16x16x32_bf16 v[24:27], a[204:207], v[220:223], v[24:27]
    v_exp_f32 v20, v20
    v_mfma_f32_16x16x32_bf16 v[28:31], a[220:223], v[220:223], 0
    v_add_f32 v116, v116, v19
    v_cvt_pk_bf16_f32 v17, v18, v19
    v_mfma_f32_16x16x32_bf16 v[28:31], a[216:219], v[216:219], v[28:31]
    v_exp_f32 v21, v21
    v_mfma_f32_16x16x32_bf16 v[28:31], a[212:215], v[212:215], v[28:31]
    v_add_f32 v116, v116, v20
    v_add_f32 v116, v116, v21
    v_mfma_f32_16x16x32_bf16 v[28:31], a[208:211], v[208:211], v[28:31]
    v_exp_f32 v22, v22
    v_mfma_f32_16x16x32_bf16 a[96:99], a[224:227], v[40:43], a[96:99]
    v_exp_f32 v23, v23
    v_mfma_f32_16x16x32_bf16 a[100:103], a[228:231], v[40:43], a[100:103]
    v_cvt_pk_bf16_f32 v18, v20, v21
    v_add_f32 v116, v116, v22
    v_mfma_f32_16x16x32_bf16 a[104:107], a[232:235], v[40:43], a[104:107]
    v_add_f32 v116, v116, v23
    v_cvt_pk_bf16_f32 v19, v22, v23
    v_mfma_f32_16x16x32_bf16 a[108:111], a[236:239], v[40:43], a[108:111]
    v_exp_f32 v24, v24
    v_mfma_f32_16x16x32_bf16 a[112:115], a[240:243], v[40:43], a[112:115]
    v_exp_f32 v25, v25
    v_mfma_f32_16x16x32_bf16 a[116:119], a[244:247], v[40:43], a[116:119]
    v_add_f32 v117, v117, v24
    v_add_f32 v117, v117, v25
    v_mfma_f32_16x16x32_bf16 a[120:123], a[248:251], v[40:43], a[120:123]
    v_exp_f32 v26, v26
    v_mfma_f32_16x16x32_bf16 a[124:127], a[252:255], v[40:43], a[124:127]
    v_exp_f32 v27, v27
    v_mfma_f32_16x16x32_bf16 v[32:35], a[192:195], v[224:227], 0
    v_cvt_pk_bf16_f32 v24, v24, v25
    v_add_f32 v117, v117, v26
    v_mfma_f32_16x16x32_bf16 v[32:35], a[196:199], v[228:231], v[32:35]
    v_exp_f32 v28, v28
    v_mfma_f32_16x16x32_bf16 v[32:35], a[200:203], v[232:235], v[32:35]
    v_add_f32 v117, v117, v27
    v_cvt_pk_bf16_f32 v25, v26, v27
    v_mfma_f32_16x16x32_bf16 v[32:35], a[204:207], v[236:239], v[32:35]
    v_exp_f32 v29, v29
    v_mfma_f32_16x16x32_bf16 v[36:39], a[220:223], v[236:239], 0
    v_add_f32 v117, v117, v28
    v_add_f32 v117, v117, v29
    v_mfma_f32_16x16x32_bf16 v[36:39], a[216:219], v[232:235], v[36:39]
    v_exp_f32 v30, v30
    v_mfma_f32_16x16x32_bf16 v[36:39], a[212:215], v[228:231], v[36:39]
    v_exp_f32 v31, v31
    v_mfma_f32_16x16x32_bf16 v[36:39], a[208:211], v[224:227], v[36:39]
    v_cvt_pk_bf16_f32 v26, v28, v29
    v_add_f32 v117, v117, v30
    v_mfma_f32_16x16x32_bf16 a[128:131], a[224:227], v[16:19], a[128:131]
    v_add_f32 v117, v117, v31
    v_cvt_pk_bf16_f32 v27, v30, v31
    v_mfma_f32_16x16x32_bf16 a[132:135], a[228:231], v[16:19], a[132:135]
    v_exp_f32 v32, v32
    v_mfma_f32_16x16x32_bf16 a[136:139], a[232:235], v[16:19], a[136:139]
    v_exp_f32 v33, v33
    v_mfma_f32_16x16x32_bf16 a[140:143], a[236:239], v[16:19], a[140:143]
    v_add_f32 v118, v118, v32
    v_add_f32 v118, v118, v33
    v_mfma_f32_16x16x32_bf16 a[144:147], a[240:243], v[16:19], a[144:147]
    v_exp_f32 v34, v34
    v_mfma_f32_16x16x32_bf16 a[148:151], a[244:247], v[16:19], a[148:151]
    v_exp_f32 v35, v35
    v_mfma_f32_16x16x32_bf16 a[152:155], a[248:251], v[16:19], a[152:155]
    v_cvt_pk_bf16_f32 v32, v32, v33
    v_add_f32 v118, v118, v34
    v_mfma_f32_16x16x32_bf16 a[156:159], a[252:255], v[16:19], a[156:159]
    v_exp_f32 v36, v36
    v_mfma_f32_16x16x32_bf16 v[40:43], a[192:195], v[240:243], v[124:127]
    v_add_f32 v118, v118, v35
    v_cvt_pk_bf16_f32 v33, v34, v35
    v_mfma_f32_16x16x32_bf16 v[40:43], a[196:199], v[244:247], v[40:43]
    ds_read_b128 a[192:195], v1 offset:49152
    ds_read_b128 a[196:199], v1 offset:49664
    v_mfma_f32_16x16x32_bf16 v[40:43], a[200:203], v[248:251], v[40:43]
    v_exp_f32 v37, v37
    v_mfma_f32_16x16x32_bf16 v[40:43], a[204:207], v[252:255], v[40:43]
    v_add_f32 v118, v118, v36
    v_add_f32 v118, v118, v37
    v_mfma_f32_16x16x32_bf16 v[44:47], a[220:223], v[252:255], v[124:127]
    v_exp_f32 v38, v38
    v_mfma_f32_16x16x32_bf16 v[44:47], a[216:219], v[248:251], v[44:47]
    ds_read_b128 a[200:203], v1 offset:50176
    ds_read_b128 a[204:207], v1 offset:50688
    v_mfma_f32_16x16x32_bf16 v[44:47], a[212:215], v[244:247], v[44:47]
    v_exp_f32 v39, v39
    v_mfma_f32_16x16x32_bf16 v[44:47], a[208:211], v[240:243], v[44:47]
    v_cvt_pk_bf16_f32 v34, v36, v37
    v_add_f32 v118, v118, v38
    v_mfma_f32_16x16x32_bf16 a[160:163], a[224:227], v[24:27], a[160:163]
    v_add_f32 v118, v118, v39
    v_cvt_pk_bf16_f32 v35, v38, v39
    v_mfma_f32_16x16x32_bf16 a[164:167], a[228:231], v[24:27], a[164:167]
    ds_read_b128 a[220:223], v1 offset:54784
    ds_read_b128 a[216:219], v1 offset:54272
    v_mfma_f32_16x16x32_bf16 a[168:171], a[232:235], v[24:27], a[168:171]
    v_exp_f32 v40, v40
    v_mfma_f32_16x16x32_bf16 a[172:175], a[236:239], v[24:27], a[172:175]
    v_exp_f32 v41, v41
    v_mfma_f32_16x16x32_bf16 a[176:179], a[240:243], v[24:27], a[176:179]
    v_add_f32 v119, v119, v40
    v_add_f32 v119, v119, v41
    v_mfma_f32_16x16x32_bf16 a[180:183], a[244:247], v[24:27], a[180:183]
    ds_read_b128 a[212:215], v1 offset:53760
    ds_read_b128 a[208:211], v1 offset:53248
    v_mfma_f32_16x16x32_bf16 a[184:187], a[248:251], v[24:27], a[184:187]
    v_exp_f32 v42, v42
    v_mfma_f32_16x16x32_bf16 a[188:191], a[252:255], v[24:27], a[188:191]
    s_waitcnt lgkmcnt(7)
    v_exp_f32 v43, v43
    v_mfma_f32_16x16x32_bf16 v[16:19], a[192:195], v[128:131], 0
    s_waitcnt lgkmcnt(6)
    v_cvt_pk_bf16_f32 v40, v40, v41
    v_add_f32 v119, v119, v42
    v_mfma_f32_16x16x32_bf16 v[16:19], a[196:199], v[132:135], v[16:19]
    s_waitcnt lgkmcnt(5)
    v_exp_f32 v44, v44
    v_mfma_f32_16x16x32_bf16 v[16:19], a[200:203], v[136:139], v[16:19]
    s_waitcnt lgkmcnt(4)
    v_add_f32 v119, v119, v43
    v_cvt_pk_bf16_f32 v41, v42, v43
    v_mfma_f32_16x16x32_bf16 v[16:19], a[204:207], v[140:143], v[16:19]
    s_waitcnt lgkmcnt(3)
    v_exp_f32 v45, v45
    v_mfma_f32_16x16x32_bf16 v[20:23], a[220:223], v[140:143], 0
    s_waitcnt lgkmcnt(2)
    v_add_f32 v119, v119, v44
    v_add_f32 v119, v119, v45
    v_mfma_f32_16x16x32_bf16 v[20:23], a[216:219], v[136:139], v[20:23]
    s_waitcnt lgkmcnt(1)
    v_exp_f32 v46, v46
    v_mfma_f32_16x16x32_bf16 v[20:23], a[212:215], v[132:135], v[20:23]
    s_waitcnt lgkmcnt(0)
    v_exp_f32 v47, v47
    v_mfma_f32_16x16x32_bf16 v[20:23], a[208:211], v[128:131], v[20:23]
    v_cvt_pk_bf16_f32 v42, v44, v45
    v_add_f32 v119, v119, v46
    v_mfma_f32_16x16x32_bf16 v[48:51], a[224:227], v[32:35], v[48:51]
    v_add_f32 v119, v119, v47
    v_cvt_pk_bf16_f32 v43, v46, v47
    v_mfma_f32_16x16x32_bf16 v[52:55], a[228:231], v[32:35], v[52:55]
    v_exp_f32 v16, v16
    v_mfma_f32_16x16x32_bf16 v[56:59], a[232:235], v[32:35], v[56:59]
    v_exp_f32 v17, v17
    v_mfma_f32_16x16x32_bf16 v[60:63], a[236:239], v[32:35], v[60:63]
    v_add_f32 v112, v112, v16
    v_add_f32 v112, v112, v17
    v_mfma_f32_16x16x32_bf16 v[64:67], a[240:243], v[32:35], v[64:67]
    v_exp_f32 v18, v18
    v_mfma_f32_16x16x32_bf16 v[68:71], a[244:247], v[32:35], v[68:71]
    v_exp_f32 v19, v19
    v_mfma_f32_16x16x32_bf16 v[72:75], a[248:251], v[32:35], v[72:75]
    v_cvt_pk_bf16_f32 v16, v16, v17
    v_add_f32 v112, v112, v18
    v_mfma_f32_16x16x32_bf16 v[76:79], a[252:255], v[32:35], v[76:79]
    v_exp_f32 v20, v20
    v_mfma_f32_16x16x32_bf16 v[24:27], a[192:195], v[144:147], 0
    v_add_f32 v112, v112, v19
    v_cvt_pk_bf16_f32 v17, v18, v19
    v_mfma_f32_16x16x32_bf16 v[24:27], a[196:199], v[148:151], v[24:27]
    v_exp_f32 v21, v21
    v_mfma_f32_16x16x32_bf16 v[24:27], a[200:203], v[152:155], v[24:27]
    v_add_f32 v112, v112, v20
    v_add_f32 v112, v112, v21
    v_mfma_f32_16x16x32_bf16 v[24:27], a[204:207], v[156:159], v[24:27]
    v_exp_f32 v22, v22
    v_mfma_f32_16x16x32_bf16 v[28:31], a[220:223], v[156:159], 0
    v_exp_f32 v23, v23
    v_mfma_f32_16x16x32_bf16 v[28:31], a[216:219], v[152:155], v[28:31]
    v_cvt_pk_bf16_f32 v18, v20, v21
    v_add_f32 v112, v112, v22
    v_mfma_f32_16x16x32_bf16 v[28:31], a[212:215], v[148:151], v[28:31]
    v_add_f32 v112, v112, v23
    v_cvt_pk_bf16_f32 v19, v22, v23
    v_mfma_f32_16x16x32_bf16 v[28:31], a[208:211], v[144:147], v[28:31]
    v_exp_f32 v24, v24
    v_mfma_f32_16x16x32_bf16 v[80:83], a[224:227], v[40:43], v[80:83]
    ds_read_b64_tr_b16 a[224:225], v2 offset:49152
    ds_read_b64_tr_b16 a[226:227], v2 offset:53248
    v_mfma_f32_16x16x32_bf16 v[84:87], a[228:231], v[40:43], v[84:87]
    v_exp_f32 v25, v25
    v_mfma_f32_16x16x32_bf16 v[88:91], a[232:235], v[40:43], v[88:91]
    ds_read_b64_tr_b16 a[228:229], v2 offset:49408
    ds_read_b64_tr_b16 a[230:231], v2 offset:53504
    v_mfma_f32_16x16x32_bf16 v[92:95], a[236:239], v[40:43], v[92:95]
    v_add_f32 v113, v113, v24
    v_add_f32 v113, v113, v25
    v_mfma_f32_16x16x32_bf16 v[96:99], a[240:243], v[40:43], v[96:99]
    ds_read_b64_tr_b16 a[232:233], v2 offset:49664
    ds_read_b64_tr_b16 a[234:235], v2 offset:53760
    v_mfma_f32_16x16x32_bf16 v[100:103], a[244:247], v[40:43], v[100:103]
    v_exp_f32 v26, v26
    v_mfma_f32_16x16x32_bf16 v[104:107], a[248:251], v[40:43], v[104:107]
    ds_read_b64_tr_b16 a[236:237], v2 offset:49920
    ds_read_b64_tr_b16 a[238:239], v2 offset:54016
    v_mfma_f32_16x16x32_bf16 v[108:111], a[252:255], v[40:43], v[108:111]
    v_exp_f32 v27, v27
    v_mfma_f32_16x16x32_bf16 v[32:35], a[192:195], v[160:163], 0
    ds_read_b64_tr_b16 a[240:241], v2 offset:50176
    ds_read_b64_tr_b16 a[242:243], v2 offset:54272
    v_mfma_f32_16x16x32_bf16 v[32:35], a[196:199], v[164:167], v[32:35]
    v_cvt_pk_bf16_f32 v24, v24, v25
    v_add_f32 v113, v113, v26
    v_mfma_f32_16x16x32_bf16 v[32:35], a[200:203], v[168:171], v[32:35]
    ds_read_b64_tr_b16 a[244:245], v2 offset:50432
    ds_read_b64_tr_b16 a[246:247], v2 offset:54528
    v_mfma_f32_16x16x32_bf16 v[32:35], a[204:207], v[172:175], v[32:35]
    v_exp_f32 v28, v28
    v_mfma_f32_16x16x32_bf16 v[36:39], a[220:223], v[172:175], 0
    ds_read_b64_tr_b16 a[248:249], v2 offset:50688
    ds_read_b64_tr_b16 a[250:251], v2 offset:54784
    v_mfma_f32_16x16x32_bf16 v[36:39], a[216:219], v[168:171], v[36:39]
    v_add_f32 v113, v113, v27
    v_cvt_pk_bf16_f32 v25, v26, v27
    v_mfma_f32_16x16x32_bf16 v[36:39], a[212:215], v[164:167], v[36:39]
    ds_read_b64_tr_b16 a[252:253], v2 offset:50944
    ds_read_b64_tr_b16 a[254:255], v2 offset:55040
    v_mfma_f32_16x16x32_bf16 v[36:39], a[208:211], v[160:163], v[36:39]
    s_waitcnt lgkmcnt(14)
    v_exp_f32 v29, v29
    v_mfma_f32_16x16x32_bf16 a[0:3], a[224:227], v[16:19], a[0:3]
    s_waitcnt lgkmcnt(12)
    v_add_f32 v113, v113, v28
    v_add_f32 v113, v113, v29
    v_mfma_f32_16x16x32_bf16 a[4:7], a[228:231], v[16:19], a[4:7]
    s_waitcnt lgkmcnt(10)
    v_exp_f32 v30, v30
    v_mfma_f32_16x16x32_bf16 a[8:11], a[232:235], v[16:19], a[8:11]
    s_waitcnt lgkmcnt(8)
    v_exp_f32 v31, v31
    v_mfma_f32_16x16x32_bf16 a[12:15], a[236:239], v[16:19], a[12:15]
    s_waitcnt lgkmcnt(6)
    v_cvt_pk_bf16_f32 v26, v28, v29
    v_add_f32 v113, v113, v30
    v_mfma_f32_16x16x32_bf16 a[16:19], a[240:243], v[16:19], a[16:19]
    s_waitcnt lgkmcnt(4)
    v_add_f32 v113, v113, v31
    v_cvt_pk_bf16_f32 v27, v30, v31
    v_mfma_f32_16x16x32_bf16 a[20:23], a[244:247], v[16:19], a[20:23]
    s_waitcnt lgkmcnt(2)
    v_exp_f32 v32, v32
    v_mfma_f32_16x16x32_bf16 a[24:27], a[248:251], v[16:19], a[24:27]
    s_waitcnt lgkmcnt(0)
    v_exp_f32 v33, v33
    v_mfma_f32_16x16x32_bf16 a[28:31], a[252:255], v[16:19], a[28:31]
    v_add_f32 v114, v114, v32
    v_add_f32 v114, v114, v33
    v_mfma_f32_16x16x32_bf16 v[40:43], a[192:195], v[176:179], 0
    s_waitcnt vmcnt(8)
    v_exp_f32 v34, v34
    v_mfma_f32_16x16x32_bf16 v[40:43], a[196:199], v[180:183], v[40:43]
    s_barrier
    v_exp_f32 v35, v35
    v_mfma_f32_16x16x32_bf16 v[40:43], a[200:203], v[184:187], v[40:43]
    v_cvt_pk_bf16_f32 v32, v32, v33
    v_add_f32 v114, v114, v34
    v_mfma_f32_16x16x32_bf16 v[40:43], a[204:207], v[188:191], v[40:43]
    s_add_u32 m0, s26, 16384
    v_exp_f32 v36, v36
    v_mfma_f32_16x16x32_bf16 v[44:47], a[220:223], v[188:191], 0
    buffer_load_dwordx4 v3, s[12:15], s25 offen nt lds
    v_mfma_f32_16x16x32_bf16 v[44:47], a[216:219], v[184:187], v[44:47]
    v_add_f32 v114, v114, v35
    v_cvt_pk_bf16_f32 v33, v34, v35
    v_mfma_f32_16x16x32_bf16 v[44:47], a[212:215], v[180:183], v[44:47]
    s_add_u32 m0, s26, 17280
    v_exp_f32 v37, v37
    v_mfma_f32_16x16x32_bf16 v[44:47], a[208:211], v[176:179], v[44:47]
    buffer_load_dwordx4 v3, s[12:15], s25 offen offset:128 nt lds
    v_mfma_f32_16x16x32_bf16 a[32:35], a[224:227], v[24:27], a[32:35]
    v_add_f32 v114, v114, v36
    v_add_f32 v114, v114, v37
    v_mfma_f32_16x16x32_bf16 a[36:39], a[228:231], v[24:27], a[36:39]
    s_add_u32 m0, s26, 81920
    v_exp_f32 v38, v38
    v_mfma_f32_16x16x32_bf16 a[40:43], a[232:235], v[24:27], a[40:43]
    buffer_load_dwordx4 v4, s[16:19], s25 offen nt lds
    v_mfma_f32_16x16x32_bf16 a[44:47], a[236:239], v[24:27], a[44:47]
    v_exp_f32 v39, v39
    v_mfma_f32_16x16x32_bf16 a[48:51], a[240:243], v[24:27], a[48:51]
    s_add_u32 m0, s26, 82816
    v_cvt_pk_bf16_f32 v34, v36, v37
    v_add_f32 v114, v114, v38
    v_mfma_f32_16x16x32_bf16 a[52:55], a[244:247], v[24:27], a[52:55]
    buffer_load_dwordx4 v4, s[16:19], s25 offen offset:128 nt lds
    v_mfma_f32_16x16x32_bf16 a[56:59], a[248:251], v[24:27], a[56:59]
    s_add_u32 s25, s25, 8192
    v_add_f32 v114, v114, v39
    v_cvt_pk_bf16_f32 v35, v38, v39
    v_mfma_f32_16x16x32_bf16 a[60:63], a[252:255], v[24:27], a[60:63]
    v_exp_f32 v40, v40
    v_mfma_f32_16x16x32_bf16 v[16:19], a[192:195], v[192:195], 0
    v_exp_f32 v41, v41
    v_mfma_f32_16x16x32_bf16 v[16:19], a[196:199], v[196:199], v[16:19]
    v_add_f32 v115, v115, v40
    v_add_f32 v115, v115, v41
    v_mfma_f32_16x16x32_bf16 v[16:19], a[200:203], v[200:203], v[16:19]
    v_exp_f32 v42, v42
    v_mfma_f32_16x16x32_bf16 v[16:19], a[204:207], v[204:207], v[16:19]
    v_exp_f32 v43, v43
    v_mfma_f32_16x16x32_bf16 v[20:23], a[220:223], v[204:207], 0
    v_cvt_pk_bf16_f32 v40, v40, v41
    v_add_f32 v115, v115, v42
    v_mfma_f32_16x16x32_bf16 v[20:23], a[216:219], v[200:203], v[20:23]
    v_exp_f32 v44, v44
    v_mfma_f32_16x16x32_bf16 v[20:23], a[212:215], v[196:199], v[20:23]
    v_add_f32 v115, v115, v43
    v_cvt_pk_bf16_f32 v41, v42, v43
    v_mfma_f32_16x16x32_bf16 v[20:23], a[208:211], v[192:195], v[20:23]
    v_exp_f32 v45, v45
    v_mfma_f32_16x16x32_bf16 a[64:67], a[224:227], v[32:35], a[64:67]
    v_add_f32 v115, v115, v44
    v_add_f32 v115, v115, v45
    v_mfma_f32_16x16x32_bf16 a[68:71], a[228:231], v[32:35], a[68:71]
    v_exp_f32 v46, v46
    v_mfma_f32_16x16x32_bf16 a[72:75], a[232:235], v[32:35], a[72:75]
    v_exp_f32 v47, v47
    v_mfma_f32_16x16x32_bf16 a[76:79], a[236:239], v[32:35], a[76:79]
    v_cvt_pk_bf16_f32 v42, v44, v45
    v_add_f32 v115, v115, v46
    v_mfma_f32_16x16x32_bf16 a[80:83], a[240:243], v[32:35], a[80:83]
    v_add_f32 v115, v115, v47
    v_cvt_pk_bf16_f32 v43, v46, v47
    v_mfma_f32_16x16x32_bf16 a[84:87], a[244:247], v[32:35], a[84:87]
    v_exp_f32 v16, v16
    v_mfma_f32_16x16x32_bf16 a[88:91], a[248:251], v[32:35], a[88:91]
    v_exp_f32 v17, v17
    v_mfma_f32_16x16x32_bf16 a[92:95], a[252:255], v[32:35], a[92:95]
    v_add_f32 v116, v116, v16
    v_add_f32 v116, v116, v17
    v_mfma_f32_16x16x32_bf16 v[24:27], a[192:195], v[208:211], 0
    v_exp_f32 v18, v18
    v_mfma_f32_16x16x32_bf16 v[24:27], a[196:199], v[212:215], v[24:27]
    v_exp_f32 v19, v19
    v_mfma_f32_16x16x32_bf16 v[24:27], a[200:203], v[216:219], v[24:27]
    v_cvt_pk_bf16_f32 v16, v16, v17
    v_add_f32 v116, v116, v18
    v_mfma_f32_16x16x32_bf16 v[24:27], a[204:207], v[220:223], v[24:27]
    v_exp_f32 v20, v20
    v_mfma_f32_16x16x32_bf16 v[28:31], a[220:223], v[220:223], 0
    v_add_f32 v116, v116, v19
    v_cvt_pk_bf16_f32 v17, v18, v19
    v_mfma_f32_16x16x32_bf16 v[28:31], a[216:219], v[216:219], v[28:31]
    v_exp_f32 v21, v21
    v_mfma_f32_16x16x32_bf16 v[28:31], a[212:215], v[212:215], v[28:31]
    v_add_f32 v116, v116, v20
    v_add_f32 v116, v116, v21
    v_mfma_f32_16x16x32_bf16 v[28:31], a[208:211], v[208:211], v[28:31]
    v_exp_f32 v22, v22
    v_mfma_f32_16x16x32_bf16 a[96:99], a[224:227], v[40:43], a[96:99]
    v_exp_f32 v23, v23
    v_mfma_f32_16x16x32_bf16 a[100:103], a[228:231], v[40:43], a[100:103]
    v_cvt_pk_bf16_f32 v18, v20, v21
    v_add_f32 v116, v116, v22
    v_mfma_f32_16x16x32_bf16 a[104:107], a[232:235], v[40:43], a[104:107]
    v_add_f32 v116, v116, v23
    v_cvt_pk_bf16_f32 v19, v22, v23
    v_mfma_f32_16x16x32_bf16 a[108:111], a[236:239], v[40:43], a[108:111]
    v_exp_f32 v24, v24
    v_mfma_f32_16x16x32_bf16 a[112:115], a[240:243], v[40:43], a[112:115]
    v_exp_f32 v25, v25
    v_mfma_f32_16x16x32_bf16 a[116:119], a[244:247], v[40:43], a[116:119]
    v_add_f32 v117, v117, v24
    v_add_f32 v117, v117, v25
    v_mfma_f32_16x16x32_bf16 a[120:123], a[248:251], v[40:43], a[120:123]
    v_exp_f32 v26, v26
    v_mfma_f32_16x16x32_bf16 a[124:127], a[252:255], v[40:43], a[124:127]
    v_exp_f32 v27, v27
    v_mfma_f32_16x16x32_bf16 v[32:35], a[192:195], v[224:227], 0
    v_cvt_pk_bf16_f32 v24, v24, v25
    v_add_f32 v117, v117, v26
    v_mfma_f32_16x16x32_bf16 v[32:35], a[196:199], v[228:231], v[32:35]
    v_exp_f32 v28, v28
    v_mfma_f32_16x16x32_bf16 v[32:35], a[200:203], v[232:235], v[32:35]
    v_add_f32 v117, v117, v27
    v_cvt_pk_bf16_f32 v25, v26, v27
    v_mfma_f32_16x16x32_bf16 v[32:35], a[204:207], v[236:239], v[32:35]
    v_exp_f32 v29, v29
    v_mfma_f32_16x16x32_bf16 v[36:39], a[220:223], v[236:239], 0
    v_add_f32 v117, v117, v28
    v_add_f32 v117, v117, v29
    v_mfma_f32_16x16x32_bf16 v[36:39], a[216:219], v[232:235], v[36:39]
    v_exp_f32 v30, v30
    v_mfma_f32_16x16x32_bf16 v[36:39], a[212:215], v[228:231], v[36:39]
    v_exp_f32 v31, v31
    v_mfma_f32_16x16x32_bf16 v[36:39], a[208:211], v[224:227], v[36:39]
    v_cvt_pk_bf16_f32 v26, v28, v29
    v_add_f32 v117, v117, v30
    v_mfma_f32_16x16x32_bf16 a[128:131], a[224:227], v[16:19], a[128:131]
    v_add_f32 v117, v117, v31
    v_cvt_pk_bf16_f32 v27, v30, v31
    v_mfma_f32_16x16x32_bf16 a[132:135], a[228:231], v[16:19], a[132:135]
    v_exp_f32 v32, v32
    v_mfma_f32_16x16x32_bf16 a[136:139], a[232:235], v[16:19], a[136:139]
    v_exp_f32 v33, v33
    v_mfma_f32_16x16x32_bf16 a[140:143], a[236:239], v[16:19], a[140:143]
    v_add_f32 v118, v118, v32
    v_add_f32 v118, v118, v33
    v_mfma_f32_16x16x32_bf16 a[144:147], a[240:243], v[16:19], a[144:147]
    v_exp_f32 v34, v34
    v_mfma_f32_16x16x32_bf16 a[148:151], a[244:247], v[16:19], a[148:151]
    v_exp_f32 v35, v35
    v_mfma_f32_16x16x32_bf16 a[152:155], a[248:251], v[16:19], a[152:155]
    v_cvt_pk_bf16_f32 v32, v32, v33
    v_add_f32 v118, v118, v34
    v_mfma_f32_16x16x32_bf16 a[156:159], a[252:255], v[16:19], a[156:159]
    v_exp_f32 v36, v36
    v_mfma_f32_16x16x32_bf16 v[40:43], a[192:195], v[240:243], v[124:127]
    v_add_f32 v118, v118, v35
    v_cvt_pk_bf16_f32 v33, v34, v35
    v_mfma_f32_16x16x32_bf16 v[40:43], a[196:199], v[244:247], v[40:43]
    ds_read_b128 a[192:195], v1 offset:57344
    ds_read_b128 a[196:199], v1 offset:57856
    v_mfma_f32_16x16x32_bf16 v[40:43], a[200:203], v[248:251], v[40:43]
    v_exp_f32 v37, v37
    v_mfma_f32_16x16x32_bf16 v[40:43], a[204:207], v[252:255], v[40:43]
    v_add_f32 v118, v118, v36
    v_add_f32 v118, v118, v37
    v_mfma_f32_16x16x32_bf16 v[44:47], a[220:223], v[252:255], v[124:127]
    v_exp_f32 v38, v38
    v_mfma_f32_16x16x32_bf16 v[44:47], a[216:219], v[248:251], v[44:47]
    ds_read_b128 a[200:203], v1 offset:58368
    ds_read_b128 a[204:207], v1 offset:58880
    v_mfma_f32_16x16x32_bf16 v[44:47], a[212:215], v[244:247], v[44:47]
    v_exp_f32 v39, v39
    v_mfma_f32_16x16x32_bf16 v[44:47], a[208:211], v[240:243], v[44:47]
    v_cvt_pk_bf16_f32 v34, v36, v37
    v_add_f32 v118, v118, v38
    v_mfma_f32_16x16x32_bf16 a[160:163], a[224:227], v[24:27], a[160:163]
    v_add_f32 v118, v118, v39
    v_cvt_pk_bf16_f32 v35, v38, v39
    v_mfma_f32_16x16x32_bf16 a[164:167], a[228:231], v[24:27], a[164:167]
    ds_read_b128 a[220:223], v1 offset:62976
    ds_read_b128 a[216:219], v1 offset:62464
    v_mfma_f32_16x16x32_bf16 a[168:171], a[232:235], v[24:27], a[168:171]
    v_exp_f32 v40, v40
    v_mfma_f32_16x16x32_bf16 a[172:175], a[236:239], v[24:27], a[172:175]
    v_exp_f32 v41, v41
    v_mfma_f32_16x16x32_bf16 a[176:179], a[240:243], v[24:27], a[176:179]
    v_add_f32 v119, v119, v40
    v_add_f32 v119, v119, v41
    v_mfma_f32_16x16x32_bf16 a[180:183], a[244:247], v[24:27], a[180:183]
    ds_read_b128 a[212:215], v1 offset:61952
    ds_read_b128 a[208:211], v1 offset:61440
    v_mfma_f32_16x16x32_bf16 a[184:187], a[248:251], v[24:27], a[184:187]
    v_exp_f32 v42, v42
    v_mfma_f32_16x16x32_bf16 a[188:191], a[252:255], v[24:27], a[188:191]
    s_waitcnt lgkmcnt(7)
    v_exp_f32 v43, v43
    v_mfma_f32_16x16x32_bf16 v[16:19], a[192:195], v[128:131], 0
    s_waitcnt lgkmcnt(6)
    v_cvt_pk_bf16_f32 v40, v40, v41
    v_add_f32 v119, v119, v42
    v_mfma_f32_16x16x32_bf16 v[16:19], a[196:199], v[132:135], v[16:19]
    s_waitcnt lgkmcnt(5)
    v_exp_f32 v44, v44
    v_mfma_f32_16x16x32_bf16 v[16:19], a[200:203], v[136:139], v[16:19]
    s_waitcnt lgkmcnt(4)
    v_add_f32 v119, v119, v43
    v_cvt_pk_bf16_f32 v41, v42, v43
    v_mfma_f32_16x16x32_bf16 v[16:19], a[204:207], v[140:143], v[16:19]
    s_waitcnt lgkmcnt(3)
    v_exp_f32 v45, v45
    v_mfma_f32_16x16x32_bf16 v[20:23], a[220:223], v[140:143], 0
    s_waitcnt lgkmcnt(2)
    v_add_f32 v119, v119, v44
    v_add_f32 v119, v119, v45
    v_mfma_f32_16x16x32_bf16 v[20:23], a[216:219], v[136:139], v[20:23]
    s_waitcnt lgkmcnt(1)
    v_exp_f32 v46, v46
    v_mfma_f32_16x16x32_bf16 v[20:23], a[212:215], v[132:135], v[20:23]
    s_waitcnt lgkmcnt(0)
    v_exp_f32 v47, v47
    v_mfma_f32_16x16x32_bf16 v[20:23], a[208:211], v[128:131], v[20:23]
    v_cvt_pk_bf16_f32 v42, v44, v45
    v_add_f32 v119, v119, v46
    v_mfma_f32_16x16x32_bf16 v[48:51], a[224:227], v[32:35], v[48:51]
    v_add_f32 v119, v119, v47
    v_cvt_pk_bf16_f32 v43, v46, v47
    v_mfma_f32_16x16x32_bf16 v[52:55], a[228:231], v[32:35], v[52:55]
    v_exp_f32 v16, v16
    v_mfma_f32_16x16x32_bf16 v[56:59], a[232:235], v[32:35], v[56:59]
    v_exp_f32 v17, v17
    v_mfma_f32_16x16x32_bf16 v[60:63], a[236:239], v[32:35], v[60:63]
    v_add_f32 v112, v112, v16
    v_add_f32 v112, v112, v17
    v_mfma_f32_16x16x32_bf16 v[64:67], a[240:243], v[32:35], v[64:67]
    v_exp_f32 v18, v18
    v_mfma_f32_16x16x32_bf16 v[68:71], a[244:247], v[32:35], v[68:71]
    v_exp_f32 v19, v19
    v_mfma_f32_16x16x32_bf16 v[72:75], a[248:251], v[32:35], v[72:75]
    v_cvt_pk_bf16_f32 v16, v16, v17
    v_add_f32 v112, v112, v18
    v_mfma_f32_16x16x32_bf16 v[76:79], a[252:255], v[32:35], v[76:79]
    v_exp_f32 v20, v20
    v_mfma_f32_16x16x32_bf16 v[24:27], a[192:195], v[144:147], 0
    v_add_f32 v112, v112, v19
    v_cvt_pk_bf16_f32 v17, v18, v19
    v_mfma_f32_16x16x32_bf16 v[24:27], a[196:199], v[148:151], v[24:27]
    v_exp_f32 v21, v21
    v_mfma_f32_16x16x32_bf16 v[24:27], a[200:203], v[152:155], v[24:27]
    v_add_f32 v112, v112, v20
    v_add_f32 v112, v112, v21
    v_mfma_f32_16x16x32_bf16 v[24:27], a[204:207], v[156:159], v[24:27]
    v_exp_f32 v22, v22
    v_mfma_f32_16x16x32_bf16 v[28:31], a[220:223], v[156:159], 0
    v_exp_f32 v23, v23
    v_mfma_f32_16x16x32_bf16 v[28:31], a[216:219], v[152:155], v[28:31]
    v_cvt_pk_bf16_f32 v18, v20, v21
    v_add_f32 v112, v112, v22
    v_mfma_f32_16x16x32_bf16 v[28:31], a[212:215], v[148:151], v[28:31]
    v_add_f32 v112, v112, v23
    v_cvt_pk_bf16_f32 v19, v22, v23
    v_mfma_f32_16x16x32_bf16 v[28:31], a[208:211], v[144:147], v[28:31]
    v_exp_f32 v24, v24
    v_mfma_f32_16x16x32_bf16 v[80:83], a[224:227], v[40:43], v[80:83]
    ds_read_b64_tr_b16 a[224:225], v2 offset:57344
    ds_read_b64_tr_b16 a[226:227], v2 offset:61440
    v_mfma_f32_16x16x32_bf16 v[84:87], a[228:231], v[40:43], v[84:87]
    v_exp_f32 v25, v25
    v_mfma_f32_16x16x32_bf16 v[88:91], a[232:235], v[40:43], v[88:91]
    ds_read_b64_tr_b16 a[228:229], v2 offset:57600
    ds_read_b64_tr_b16 a[230:231], v2 offset:61696
    v_mfma_f32_16x16x32_bf16 v[92:95], a[236:239], v[40:43], v[92:95]
    v_add_f32 v113, v113, v24
    v_add_f32 v113, v113, v25
    v_mfma_f32_16x16x32_bf16 v[96:99], a[240:243], v[40:43], v[96:99]
    ds_read_b64_tr_b16 a[232:233], v2 offset:57856
    ds_read_b64_tr_b16 a[234:235], v2 offset:61952
    v_mfma_f32_16x16x32_bf16 v[100:103], a[244:247], v[40:43], v[100:103]
    v_exp_f32 v26, v26
    v_mfma_f32_16x16x32_bf16 v[104:107], a[248:251], v[40:43], v[104:107]
    ds_read_b64_tr_b16 a[236:237], v2 offset:58112
    ds_read_b64_tr_b16 a[238:239], v2 offset:62208
    v_mfma_f32_16x16x32_bf16 v[108:111], a[252:255], v[40:43], v[108:111]
    v_exp_f32 v27, v27
    v_mfma_f32_16x16x32_bf16 v[32:35], a[192:195], v[160:163], 0
    ds_read_b64_tr_b16 a[240:241], v2 offset:58368
    ds_read_b64_tr_b16 a[242:243], v2 offset:62464
    v_mfma_f32_16x16x32_bf16 v[32:35], a[196:199], v[164:167], v[32:35]
    v_cvt_pk_bf16_f32 v24, v24, v25
    v_add_f32 v113, v113, v26
    v_mfma_f32_16x16x32_bf16 v[32:35], a[200:203], v[168:171], v[32:35]
    ds_read_b64_tr_b16 a[244:245], v2 offset:58624
    ds_read_b64_tr_b16 a[246:247], v2 offset:62720
    v_mfma_f32_16x16x32_bf16 v[32:35], a[204:207], v[172:175], v[32:35]
    v_exp_f32 v28, v28
    v_mfma_f32_16x16x32_bf16 v[36:39], a[220:223], v[172:175], 0
    ds_read_b64_tr_b16 a[248:249], v2 offset:58880
    ds_read_b64_tr_b16 a[250:251], v2 offset:62976
    v_mfma_f32_16x16x32_bf16 v[36:39], a[216:219], v[168:171], v[36:39]
    v_add_f32 v113, v113, v27
    v_cvt_pk_bf16_f32 v25, v26, v27
    v_mfma_f32_16x16x32_bf16 v[36:39], a[212:215], v[164:167], v[36:39]
    ds_read_b64_tr_b16 a[252:253], v2 offset:59136
    ds_read_b64_tr_b16 a[254:255], v2 offset:63232
    v_mfma_f32_16x16x32_bf16 v[36:39], a[208:211], v[160:163], v[36:39]
    s_waitcnt lgkmcnt(14)
    v_exp_f32 v29, v29
    v_mfma_f32_16x16x32_bf16 a[0:3], a[224:227], v[16:19], a[0:3]
    s_waitcnt lgkmcnt(12)
    v_add_f32 v113, v113, v28
    v_add_f32 v113, v113, v29
    v_mfma_f32_16x16x32_bf16 a[4:7], a[228:231], v[16:19], a[4:7]
    s_waitcnt lgkmcnt(10)
    v_exp_f32 v30, v30
    v_mfma_f32_16x16x32_bf16 a[8:11], a[232:235], v[16:19], a[8:11]
    s_waitcnt lgkmcnt(8)
    v_exp_f32 v31, v31
    v_mfma_f32_16x16x32_bf16 a[12:15], a[236:239], v[16:19], a[12:15]
    s_waitcnt lgkmcnt(6)
    v_cvt_pk_bf16_f32 v26, v28, v29
    v_add_f32 v113, v113, v30
    v_mfma_f32_16x16x32_bf16 a[16:19], a[240:243], v[16:19], a[16:19]
    s_waitcnt lgkmcnt(4)
    v_add_f32 v113, v113, v31
    v_cvt_pk_bf16_f32 v27, v30, v31
    v_mfma_f32_16x16x32_bf16 a[20:23], a[244:247], v[16:19], a[20:23]
    s_waitcnt lgkmcnt(2)
    v_exp_f32 v32, v32
    v_mfma_f32_16x16x32_bf16 a[24:27], a[248:251], v[16:19], a[24:27]
    s_waitcnt lgkmcnt(0)
    v_exp_f32 v33, v33
    v_mfma_f32_16x16x32_bf16 a[28:31], a[252:255], v[16:19], a[28:31]
    v_add_f32 v114, v114, v32
    v_add_f32 v114, v114, v33
    v_mfma_f32_16x16x32_bf16 v[40:43], a[192:195], v[176:179], 0
    s_waitcnt vmcnt(8)
    v_exp_f32 v34, v34
    v_mfma_f32_16x16x32_bf16 v[40:43], a[196:199], v[180:183], v[40:43]
    s_barrier
    v_exp_f32 v35, v35
    v_mfma_f32_16x16x32_bf16 v[40:43], a[200:203], v[184:187], v[40:43]
    v_cvt_pk_bf16_f32 v32, v32, v33
    v_add_f32 v114, v114, v34
    v_mfma_f32_16x16x32_bf16 v[40:43], a[204:207], v[188:191], v[40:43]
    s_add_u32 m0, s26, 24576
    v_exp_f32 v36, v36
    v_mfma_f32_16x16x32_bf16 v[44:47], a[220:223], v[188:191], 0
    buffer_load_dwordx4 v3, s[12:15], s25 offen nt lds
    v_mfma_f32_16x16x32_bf16 v[44:47], a[216:219], v[184:187], v[44:47]
    v_add_f32 v114, v114, v35
    v_cvt_pk_bf16_f32 v33, v34, v35
    v_mfma_f32_16x16x32_bf16 v[44:47], a[212:215], v[180:183], v[44:47]
    s_add_u32 m0, s26, 25472
    v_exp_f32 v37, v37
    v_mfma_f32_16x16x32_bf16 v[44:47], a[208:211], v[176:179], v[44:47]
    buffer_load_dwordx4 v3, s[12:15], s25 offen offset:128 nt lds
    v_mfma_f32_16x16x32_bf16 a[32:35], a[224:227], v[24:27], a[32:35]
    v_add_f32 v114, v114, v36
    v_add_f32 v114, v114, v37
    v_mfma_f32_16x16x32_bf16 a[36:39], a[228:231], v[24:27], a[36:39]
    s_add_u32 m0, s26, 90112
    v_exp_f32 v38, v38
    v_mfma_f32_16x16x32_bf16 a[40:43], a[232:235], v[24:27], a[40:43]
    buffer_load_dwordx4 v4, s[16:19], s25 offen nt lds
    v_mfma_f32_16x16x32_bf16 a[44:47], a[236:239], v[24:27], a[44:47]
    v_exp_f32 v39, v39
    v_mfma_f32_16x16x32_bf16 a[48:51], a[240:243], v[24:27], a[48:51]
    s_add_u32 m0, s26, 91008
    v_cvt_pk_bf16_f32 v34, v36, v37
    v_add_f32 v114, v114, v38
    v_mfma_f32_16x16x32_bf16 a[52:55], a[244:247], v[24:27], a[52:55]
    buffer_load_dwordx4 v4, s[16:19], s25 offen offset:128 nt lds
    v_mfma_f32_16x16x32_bf16 a[56:59], a[248:251], v[24:27], a[56:59]
    s_add_u32 s25, s25, 8192
    v_add_f32 v114, v114, v39
    v_cvt_pk_bf16_f32 v35, v38, v39
    v_mfma_f32_16x16x32_bf16 a[60:63], a[252:255], v[24:27], a[60:63]
    v_exp_f32 v40, v40
    v_mfma_f32_16x16x32_bf16 v[16:19], a[192:195], v[192:195], 0
    v_exp_f32 v41, v41
    v_mfma_f32_16x16x32_bf16 v[16:19], a[196:199], v[196:199], v[16:19]
    v_add_f32 v115, v115, v40
    v_add_f32 v115, v115, v41
    v_mfma_f32_16x16x32_bf16 v[16:19], a[200:203], v[200:203], v[16:19]
    v_exp_f32 v42, v42
    v_mfma_f32_16x16x32_bf16 v[16:19], a[204:207], v[204:207], v[16:19]
    v_exp_f32 v43, v43
    v_mfma_f32_16x16x32_bf16 v[20:23], a[220:223], v[204:207], 0
    v_cvt_pk_bf16_f32 v40, v40, v41
    v_add_f32 v115, v115, v42
    v_mfma_f32_16x16x32_bf16 v[20:23], a[216:219], v[200:203], v[20:23]
    v_exp_f32 v44, v44
    v_mfma_f32_16x16x32_bf16 v[20:23], a[212:215], v[196:199], v[20:23]
    v_add_f32 v115, v115, v43
    v_cvt_pk_bf16_f32 v41, v42, v43
    v_mfma_f32_16x16x32_bf16 v[20:23], a[208:211], v[192:195], v[20:23]
    v_exp_f32 v45, v45
    v_mfma_f32_16x16x32_bf16 a[64:67], a[224:227], v[32:35], a[64:67]
    v_add_f32 v115, v115, v44
    v_add_f32 v115, v115, v45
    v_mfma_f32_16x16x32_bf16 a[68:71], a[228:231], v[32:35], a[68:71]
    v_exp_f32 v46, v46
    v_mfma_f32_16x16x32_bf16 a[72:75], a[232:235], v[32:35], a[72:75]
    v_exp_f32 v47, v47
    v_mfma_f32_16x16x32_bf16 a[76:79], a[236:239], v[32:35], a[76:79]
    v_cvt_pk_bf16_f32 v42, v44, v45
    v_add_f32 v115, v115, v46
    v_mfma_f32_16x16x32_bf16 a[80:83], a[240:243], v[32:35], a[80:83]
    v_add_f32 v115, v115, v47
    v_cvt_pk_bf16_f32 v43, v46, v47
    v_mfma_f32_16x16x32_bf16 a[84:87], a[244:247], v[32:35], a[84:87]
    v_exp_f32 v16, v16
    v_mfma_f32_16x16x32_bf16 a[88:91], a[248:251], v[32:35], a[88:91]
    v_exp_f32 v17, v17
    v_mfma_f32_16x16x32_bf16 a[92:95], a[252:255], v[32:35], a[92:95]
    v_add_f32 v116, v116, v16
    v_add_f32 v116, v116, v17
    v_mfma_f32_16x16x32_bf16 v[24:27], a[192:195], v[208:211], 0
    v_exp_f32 v18, v18
    v_mfma_f32_16x16x32_bf16 v[24:27], a[196:199], v[212:215], v[24:27]
    v_exp_f32 v19, v19
    v_mfma_f32_16x16x32_bf16 v[24:27], a[200:203], v[216:219], v[24:27]
    v_cvt_pk_bf16_f32 v16, v16, v17
    v_add_f32 v116, v116, v18
    v_mfma_f32_16x16x32_bf16 v[24:27], a[204:207], v[220:223], v[24:27]
    v_exp_f32 v20, v20
    v_mfma_f32_16x16x32_bf16 v[28:31], a[220:223], v[220:223], 0
    v_add_f32 v116, v116, v19
    v_cvt_pk_bf16_f32 v17, v18, v19
    v_mfma_f32_16x16x32_bf16 v[28:31], a[216:219], v[216:219], v[28:31]
    v_exp_f32 v21, v21
    v_mfma_f32_16x16x32_bf16 v[28:31], a[212:215], v[212:215], v[28:31]
    v_add_f32 v116, v116, v20
    v_add_f32 v116, v116, v21
    v_mfma_f32_16x16x32_bf16 v[28:31], a[208:211], v[208:211], v[28:31]
    v_exp_f32 v22, v22
    v_mfma_f32_16x16x32_bf16 a[96:99], a[224:227], v[40:43], a[96:99]
    v_exp_f32 v23, v23
    v_mfma_f32_16x16x32_bf16 a[100:103], a[228:231], v[40:43], a[100:103]
    v_cvt_pk_bf16_f32 v18, v20, v21
    v_add_f32 v116, v116, v22
    v_mfma_f32_16x16x32_bf16 a[104:107], a[232:235], v[40:43], a[104:107]
    v_add_f32 v116, v116, v23
    v_cvt_pk_bf16_f32 v19, v22, v23
    v_mfma_f32_16x16x32_bf16 a[108:111], a[236:239], v[40:43], a[108:111]
    v_exp_f32 v24, v24
    v_mfma_f32_16x16x32_bf16 a[112:115], a[240:243], v[40:43], a[112:115]
    v_exp_f32 v25, v25
    v_mfma_f32_16x16x32_bf16 a[116:119], a[244:247], v[40:43], a[116:119]
    v_add_f32 v117, v117, v24
    v_add_f32 v117, v117, v25
    v_mfma_f32_16x16x32_bf16 a[120:123], a[248:251], v[40:43], a[120:123]
    v_exp_f32 v26, v26
    v_mfma_f32_16x16x32_bf16 a[124:127], a[252:255], v[40:43], a[124:127]
    v_exp_f32 v27, v27
    v_mfma_f32_16x16x32_bf16 v[32:35], a[192:195], v[224:227], 0
    v_cvt_pk_bf16_f32 v24, v24, v25
    v_add_f32 v117, v117, v26
    v_mfma_f32_16x16x32_bf16 v[32:35], a[196:199], v[228:231], v[32:35]
    v_exp_f32 v28, v28
    v_mfma_f32_16x16x32_bf16 v[32:35], a[200:203], v[232:235], v[32:35]
    v_add_f32 v117, v117, v27
    v_cvt_pk_bf16_f32 v25, v26, v27
    v_mfma_f32_16x16x32_bf16 v[32:35], a[204:207], v[236:239], v[32:35]
    v_exp_f32 v29, v29
    v_mfma_f32_16x16x32_bf16 v[36:39], a[220:223], v[236:239], 0
    v_add_f32 v117, v117, v28
    v_add_f32 v117, v117, v29
    v_mfma_f32_16x16x32_bf16 v[36:39], a[216:219], v[232:235], v[36:39]
    v_exp_f32 v30, v30
    v_mfma_f32_16x16x32_bf16 v[36:39], a[212:215], v[228:231], v[36:39]
    v_exp_f32 v31, v31
    v_mfma_f32_16x16x32_bf16 v[36:39], a[208:211], v[224:227], v[36:39]
    v_cvt_pk_bf16_f32 v26, v28, v29
    v_add_f32 v117, v117, v30
    v_mfma_f32_16x16x32_bf16 a[128:131], a[224:227], v[16:19], a[128:131]
    v_add_f32 v117, v117, v31
    v_cvt_pk_bf16_f32 v27, v30, v31
    v_mfma_f32_16x16x32_bf16 a[132:135], a[228:231], v[16:19], a[132:135]
    v_exp_f32 v32, v32
    v_mfma_f32_16x16x32_bf16 a[136:139], a[232:235], v[16:19], a[136:139]
    v_exp_f32 v33, v33
    v_mfma_f32_16x16x32_bf16 a[140:143], a[236:239], v[16:19], a[140:143]
    v_add_f32 v118, v118, v32
    v_add_f32 v118, v118, v33
    v_mfma_f32_16x16x32_bf16 a[144:147], a[240:243], v[16:19], a[144:147]
    v_exp_f32 v34, v34
    v_mfma_f32_16x16x32_bf16 a[148:151], a[244:247], v[16:19], a[148:151]
    v_exp_f32 v35, v35
    v_mfma_f32_16x16x32_bf16 a[152:155], a[248:251], v[16:19], a[152:155]
    v_cvt_pk_bf16_f32 v32, v32, v33
    v_add_f32 v118, v118, v34
    v_mfma_f32_16x16x32_bf16 a[156:159], a[252:255], v[16:19], a[156:159]
    v_exp_f32 v36, v36
    v_mfma_f32_16x16x32_bf16 v[40:43], a[192:195], v[240:243], v[124:127]
    v_add_f32 v118, v118, v35
    v_cvt_pk_bf16_f32 v33, v34, v35
    v_mfma_f32_16x16x32_bf16 v[40:43], a[196:199], v[244:247], v[40:43]
    ds_read_b128 a[192:195], v1 offset:0
    ds_read_b128 a[196:199], v1 offset:512
    v_mfma_f32_16x16x32_bf16 v[40:43], a[200:203], v[248:251], v[40:43]
    v_exp_f32 v37, v37
    v_mfma_f32_16x16x32_bf16 v[40:43], a[204:207], v[252:255], v[40:43]
    v_add_f32 v118, v118, v36
    v_add_f32 v118, v118, v37
    v_mfma_f32_16x16x32_bf16 v[44:47], a[220:223], v[252:255], v[124:127]
    v_exp_f32 v38, v38
    v_mfma_f32_16x16x32_bf16 v[44:47], a[216:219], v[248:251], v[44:47]
    ds_read_b128 a[200:203], v1 offset:1024
    ds_read_b128 a[204:207], v1 offset:1536
    v_mfma_f32_16x16x32_bf16 v[44:47], a[212:215], v[244:247], v[44:47]
    v_exp_f32 v39, v39
    v_mfma_f32_16x16x32_bf16 v[44:47], a[208:211], v[240:243], v[44:47]
    v_cvt_pk_bf16_f32 v34, v36, v37
    v_add_f32 v118, v118, v38
    v_mfma_f32_16x16x32_bf16 a[160:163], a[224:227], v[24:27], a[160:163]
    v_add_f32 v118, v118, v39
    v_cvt_pk_bf16_f32 v35, v38, v39
    v_mfma_f32_16x16x32_bf16 a[164:167], a[228:231], v[24:27], a[164:167]
    ds_read_b128 a[220:223], v1 offset:5632
    ds_read_b128 a[216:219], v1 offset:5120
    v_mfma_f32_16x16x32_bf16 a[168:171], a[232:235], v[24:27], a[168:171]
    v_exp_f32 v40, v40
    v_mfma_f32_16x16x32_bf16 a[172:175], a[236:239], v[24:27], a[172:175]
    v_exp_f32 v41, v41
    v_mfma_f32_16x16x32_bf16 a[176:179], a[240:243], v[24:27], a[176:179]
    v_add_f32 v119, v119, v40
    v_add_f32 v119, v119, v41
    v_mfma_f32_16x16x32_bf16 a[180:183], a[244:247], v[24:27], a[180:183]
    ds_read_b128 a[212:215], v1 offset:4608
    ds_read_b128 a[208:211], v1 offset:4096
    v_mfma_f32_16x16x32_bf16 a[184:187], a[248:251], v[24:27], a[184:187]
    v_exp_f32 v42, v42
    v_mfma_f32_16x16x32_bf16 a[188:191], a[252:255], v[24:27], a[188:191]
    s_waitcnt lgkmcnt(7)
    v_exp_f32 v43, v43
    v_mfma_f32_16x16x32_bf16 v[16:19], a[192:195], v[128:131], 0
    s_waitcnt lgkmcnt(6)
    v_cvt_pk_bf16_f32 v40, v40, v41
    v_add_f32 v119, v119, v42
    v_mfma_f32_16x16x32_bf16 v[16:19], a[196:199], v[132:135], v[16:19]
    s_waitcnt lgkmcnt(5)
    v_exp_f32 v44, v44
    v_mfma_f32_16x16x32_bf16 v[16:19], a[200:203], v[136:139], v[16:19]
    s_waitcnt lgkmcnt(4)
    v_add_f32 v119, v119, v43
    v_cvt_pk_bf16_f32 v41, v42, v43
    v_mfma_f32_16x16x32_bf16 v[16:19], a[204:207], v[140:143], v[16:19]
    s_waitcnt lgkmcnt(3)
    v_exp_f32 v45, v45
    v_mfma_f32_16x16x32_bf16 v[20:23], a[220:223], v[140:143], 0
    s_waitcnt lgkmcnt(2)
    v_add_f32 v119, v119, v44
    v_add_f32 v119, v119, v45
    v_mfma_f32_16x16x32_bf16 v[20:23], a[216:219], v[136:139], v[20:23]
    s_waitcnt lgkmcnt(1)
    v_exp_f32 v46, v46
    v_mfma_f32_16x16x32_bf16 v[20:23], a[212:215], v[132:135], v[20:23]
    s_waitcnt lgkmcnt(0)
    v_exp_f32 v47, v47
    v_mfma_f32_16x16x32_bf16 v[20:23], a[208:211], v[128:131], v[20:23]
    v_cvt_pk_bf16_f32 v42, v44, v45
    v_add_f32 v119, v119, v46
    v_mfma_f32_16x16x32_bf16 v[48:51], a[224:227], v[32:35], v[48:51]
    v_add_f32 v119, v119, v47
    v_cvt_pk_bf16_f32 v43, v46, v47
    v_mfma_f32_16x16x32_bf16 v[52:55], a[228:231], v[32:35], v[52:55]
    v_exp_f32 v16, v16
    v_mfma_f32_16x16x32_bf16 v[56:59], a[232:235], v[32:35], v[56:59]
    v_exp_f32 v17, v17
    v_mfma_f32_16x16x32_bf16 v[60:63], a[236:239], v[32:35], v[60:63]
    v_add_f32 v112, v112, v16
    v_add_f32 v112, v112, v17
    v_mfma_f32_16x16x32_bf16 v[64:67], a[240:243], v[32:35], v[64:67]
    v_exp_f32 v18, v18
    v_mfma_f32_16x16x32_bf16 v[68:71], a[244:247], v[32:35], v[68:71]
    v_exp_f32 v19, v19
    v_mfma_f32_16x16x32_bf16 v[72:75], a[248:251], v[32:35], v[72:75]
    v_cvt_pk_bf16_f32 v16, v16, v17
    v_add_f32 v112, v112, v18
    v_mfma_f32_16x16x32_bf16 v[76:79], a[252:255], v[32:35], v[76:79]
    v_exp_f32 v20, v20
    v_mfma_f32_16x16x32_bf16 v[24:27], a[192:195], v[144:147], 0
    v_add_f32 v112, v112, v19
    v_cvt_pk_bf16_f32 v17, v18, v19
    v_mfma_f32_16x16x32_bf16 v[24:27], a[196:199], v[148:151], v[24:27]
    v_exp_f32 v21, v21
    v_mfma_f32_16x16x32_bf16 v[24:27], a[200:203], v[152:155], v[24:27]
    v_add_f32 v112, v112, v20
    v_add_f32 v112, v112, v21
    v_mfma_f32_16x16x32_bf16 v[24:27], a[204:207], v[156:159], v[24:27]
    v_exp_f32 v22, v22
    v_mfma_f32_16x16x32_bf16 v[28:31], a[220:223], v[156:159], 0
    v_exp_f32 v23, v23
    v_mfma_f32_16x16x32_bf16 v[28:31], a[216:219], v[152:155], v[28:31]
    v_cvt_pk_bf16_f32 v18, v20, v21
    v_add_f32 v112, v112, v22
    v_mfma_f32_16x16x32_bf16 v[28:31], a[212:215], v[148:151], v[28:31]
    v_add_f32 v112, v112, v23
    v_cvt_pk_bf16_f32 v19, v22, v23
    v_mfma_f32_16x16x32_bf16 v[28:31], a[208:211], v[144:147], v[28:31]
    v_exp_f32 v24, v24
    v_mfma_f32_16x16x32_bf16 v[80:83], a[224:227], v[40:43], v[80:83]
    ds_read_b64_tr_b16 a[224:225], v2 offset:0
    ds_read_b64_tr_b16 a[226:227], v2 offset:4096
    v_mfma_f32_16x16x32_bf16 v[84:87], a[228:231], v[40:43], v[84:87]
    v_exp_f32 v25, v25
    v_mfma_f32_16x16x32_bf16 v[88:91], a[232:235], v[40:43], v[88:91]
    ds_read_b64_tr_b16 a[228:229], v2 offset:256
    ds_read_b64_tr_b16 a[230:231], v2 offset:4352
    v_mfma_f32_16x16x32_bf16 v[92:95], a[236:239], v[40:43], v[92:95]
    v_add_f32 v113, v113, v24
    v_add_f32 v113, v113, v25
    v_mfma_f32_16x16x32_bf16 v[96:99], a[240:243], v[40:43], v[96:99]
    ds_read_b64_tr_b16 a[232:233], v2 offset:512
    ds_read_b64_tr_b16 a[234:235], v2 offset:4608
    v_mfma_f32_16x16x32_bf16 v[100:103], a[244:247], v[40:43], v[100:103]
    v_exp_f32 v26, v26
    v_mfma_f32_16x16x32_bf16 v[104:107], a[248:251], v[40:43], v[104:107]
    ds_read_b64_tr_b16 a[236:237], v2 offset:768
    ds_read_b64_tr_b16 a[238:239], v2 offset:4864
    v_mfma_f32_16x16x32_bf16 v[108:111], a[252:255], v[40:43], v[108:111]
    v_exp_f32 v27, v27
    v_mfma_f32_16x16x32_bf16 v[32:35], a[192:195], v[160:163], 0
    ds_read_b64_tr_b16 a[240:241], v2 offset:1024
    ds_read_b64_tr_b16 a[242:243], v2 offset:5120
    v_mfma_f32_16x16x32_bf16 v[32:35], a[196:199], v[164:167], v[32:35]
    v_cvt_pk_bf16_f32 v24, v24, v25
    v_add_f32 v113, v113, v26
    v_mfma_f32_16x16x32_bf16 v[32:35], a[200:203], v[168:171], v[32:35]
    ds_read_b64_tr_b16 a[244:245], v2 offset:1280
    ds_read_b64_tr_b16 a[246:247], v2 offset:5376
    v_mfma_f32_16x16x32_bf16 v[32:35], a[204:207], v[172:175], v[32:35]
    v_exp_f32 v28, v28
    v_mfma_f32_16x16x32_bf16 v[36:39], a[220:223], v[172:175], 0
    ds_read_b64_tr_b16 a[248:249], v2 offset:1536
    ds_read_b64_tr_b16 a[250:251], v2 offset:5632
    v_mfma_f32_16x16x32_bf16 v[36:39], a[216:219], v[168:171], v[36:39]
    v_add_f32 v113, v113, v27
    v_cvt_pk_bf16_f32 v25, v26, v27
    v_mfma_f32_16x16x32_bf16 v[36:39], a[212:215], v[164:167], v[36:39]
    ds_read_b64_tr_b16 a[252:253], v2 offset:1792
    ds_read_b64_tr_b16 a[254:255], v2 offset:5888
    v_mfma_f32_16x16x32_bf16 v[36:39], a[208:211], v[160:163], v[36:39]
    s_waitcnt lgkmcnt(14)
    v_exp_f32 v29, v29
    v_mfma_f32_16x16x32_bf16 a[0:3], a[224:227], v[16:19], a[0:3]
    s_waitcnt lgkmcnt(12)
    v_add_f32 v113, v113, v28
    v_add_f32 v113, v113, v29
    v_mfma_f32_16x16x32_bf16 a[4:7], a[228:231], v[16:19], a[4:7]
    s_waitcnt lgkmcnt(10)
    v_exp_f32 v30, v30
    v_mfma_f32_16x16x32_bf16 a[8:11], a[232:235], v[16:19], a[8:11]
    s_waitcnt lgkmcnt(8)
    v_exp_f32 v31, v31
    v_mfma_f32_16x16x32_bf16 a[12:15], a[236:239], v[16:19], a[12:15]
    s_waitcnt lgkmcnt(6)
    v_cvt_pk_bf16_f32 v26, v28, v29
    v_add_f32 v113, v113, v30
    v_mfma_f32_16x16x32_bf16 a[16:19], a[240:243], v[16:19], a[16:19]
    s_waitcnt lgkmcnt(4)
    v_add_f32 v113, v113, v31
    v_cvt_pk_bf16_f32 v27, v30, v31
    v_mfma_f32_16x16x32_bf16 a[20:23], a[244:247], v[16:19], a[20:23]
    s_waitcnt lgkmcnt(2)
    v_exp_f32 v32, v32
    v_mfma_f32_16x16x32_bf16 a[24:27], a[248:251], v[16:19], a[24:27]
    s_waitcnt lgkmcnt(0)
    v_exp_f32 v33, v33
    v_mfma_f32_16x16x32_bf16 a[28:31], a[252:255], v[16:19], a[28:31]
    v_add_f32 v114, v114, v32
    v_add_f32 v114, v114, v33
    v_mfma_f32_16x16x32_bf16 v[40:43], a[192:195], v[176:179], 0
    s_waitcnt vmcnt(8)
    v_exp_f32 v34, v34
    v_mfma_f32_16x16x32_bf16 v[40:43], a[196:199], v[180:183], v[40:43]
    s_barrier
    v_exp_f32 v35, v35
    v_mfma_f32_16x16x32_bf16 v[40:43], a[200:203], v[184:187], v[40:43]
    v_cvt_pk_bf16_f32 v32, v32, v33
    v_add_f32 v114, v114, v34
    v_mfma_f32_16x16x32_bf16 v[40:43], a[204:207], v[188:191], v[40:43]
    s_add_u32 m0, s26, 32768
    v_exp_f32 v36, v36
    v_mfma_f32_16x16x32_bf16 v[44:47], a[220:223], v[188:191], 0
    buffer_load_dwordx4 v3, s[12:15], s25 offen nt lds
    v_mfma_f32_16x16x32_bf16 v[44:47], a[216:219], v[184:187], v[44:47]
    v_add_f32 v114, v114, v35
    v_cvt_pk_bf16_f32 v33, v34, v35
    v_mfma_f32_16x16x32_bf16 v[44:47], a[212:215], v[180:183], v[44:47]
    s_add_u32 m0, s26, 33664
    v_exp_f32 v37, v37
    v_mfma_f32_16x16x32_bf16 v[44:47], a[208:211], v[176:179], v[44:47]
    buffer_load_dwordx4 v3, s[12:15], s25 offen offset:128 nt lds
    v_mfma_f32_16x16x32_bf16 a[32:35], a[224:227], v[24:27], a[32:35]
    v_add_f32 v114, v114, v36
    v_add_f32 v114, v114, v37
    v_mfma_f32_16x16x32_bf16 a[36:39], a[228:231], v[24:27], a[36:39]
    s_add_u32 m0, s26, 98304
    v_exp_f32 v38, v38
    v_mfma_f32_16x16x32_bf16 a[40:43], a[232:235], v[24:27], a[40:43]
    buffer_load_dwordx4 v4, s[16:19], s25 offen nt lds
    v_mfma_f32_16x16x32_bf16 a[44:47], a[236:239], v[24:27], a[44:47]
    v_exp_f32 v39, v39
    v_mfma_f32_16x16x32_bf16 a[48:51], a[240:243], v[24:27], a[48:51]
    s_add_u32 m0, s26, 99200
    v_cvt_pk_bf16_f32 v34, v36, v37
    v_add_f32 v114, v114, v38
    v_mfma_f32_16x16x32_bf16 a[52:55], a[244:247], v[24:27], a[52:55]
    buffer_load_dwordx4 v4, s[16:19], s25 offen offset:128 nt lds
    v_mfma_f32_16x16x32_bf16 a[56:59], a[248:251], v[24:27], a[56:59]
    s_add_u32 s25, s25, 8192
    v_add_f32 v114, v114, v39
    v_cvt_pk_bf16_f32 v35, v38, v39
    v_mfma_f32_16x16x32_bf16 a[60:63], a[252:255], v[24:27], a[60:63]
    v_exp_f32 v40, v40
    v_mfma_f32_16x16x32_bf16 v[16:19], a[192:195], v[192:195], 0
    v_exp_f32 v41, v41
    v_mfma_f32_16x16x32_bf16 v[16:19], a[196:199], v[196:199], v[16:19]
    v_add_f32 v115, v115, v40
    v_add_f32 v115, v115, v41
    v_mfma_f32_16x16x32_bf16 v[16:19], a[200:203], v[200:203], v[16:19]
    v_exp_f32 v42, v42
    v_mfma_f32_16x16x32_bf16 v[16:19], a[204:207], v[204:207], v[16:19]
    v_exp_f32 v43, v43
    v_mfma_f32_16x16x32_bf16 v[20:23], a[220:223], v[204:207], 0
    v_cvt_pk_bf16_f32 v40, v40, v41
    v_add_f32 v115, v115, v42
    v_mfma_f32_16x16x32_bf16 v[20:23], a[216:219], v[200:203], v[20:23]
    v_exp_f32 v44, v44
    v_mfma_f32_16x16x32_bf16 v[20:23], a[212:215], v[196:199], v[20:23]
    v_add_f32 v115, v115, v43
    v_cvt_pk_bf16_f32 v41, v42, v43
    v_mfma_f32_16x16x32_bf16 v[20:23], a[208:211], v[192:195], v[20:23]
    v_exp_f32 v45, v45
    v_mfma_f32_16x16x32_bf16 a[64:67], a[224:227], v[32:35], a[64:67]
    v_add_f32 v115, v115, v44
    v_add_f32 v115, v115, v45
    v_mfma_f32_16x16x32_bf16 a[68:71], a[228:231], v[32:35], a[68:71]
    v_exp_f32 v46, v46
    v_mfma_f32_16x16x32_bf16 a[72:75], a[232:235], v[32:35], a[72:75]
    v_exp_f32 v47, v47
    v_mfma_f32_16x16x32_bf16 a[76:79], a[236:239], v[32:35], a[76:79]
    v_cvt_pk_bf16_f32 v42, v44, v45
    v_add_f32 v115, v115, v46
    v_mfma_f32_16x16x32_bf16 a[80:83], a[240:243], v[32:35], a[80:83]
    v_add_f32 v115, v115, v47
    v_cvt_pk_bf16_f32 v43, v46, v47
    v_mfma_f32_16x16x32_bf16 a[84:87], a[244:247], v[32:35], a[84:87]
    v_exp_f32 v16, v16
    v_mfma_f32_16x16x32_bf16 a[88:91], a[248:251], v[32:35], a[88:91]
    v_exp_f32 v17, v17
    v_mfma_f32_16x16x32_bf16 a[92:95], a[252:255], v[32:35], a[92:95]
    v_add_f32 v116, v116, v16
    v_add_f32 v116, v116, v17
    v_mfma_f32_16x16x32_bf16 v[24:27], a[192:195], v[208:211], 0
    v_exp_f32 v18, v18
    v_mfma_f32_16x16x32_bf16 v[24:27], a[196:199], v[212:215], v[24:27]
    v_exp_f32 v19, v19
    v_mfma_f32_16x16x32_bf16 v[24:27], a[200:203], v[216:219], v[24:27]
    v_cvt_pk_bf16_f32 v16, v16, v17
    v_add_f32 v116, v116, v18
    v_mfma_f32_16x16x32_bf16 v[24:27], a[204:207], v[220:223], v[24:27]
    v_exp_f32 v20, v20
    v_mfma_f32_16x16x32_bf16 v[28:31], a[220:223], v[220:223], 0
    v_add_f32 v116, v116, v19
    v_cvt_pk_bf16_f32 v17, v18, v19
    v_mfma_f32_16x16x32_bf16 v[28:31], a[216:219], v[216:219], v[28:31]
    v_exp_f32 v21, v21
    v_mfma_f32_16x16x32_bf16 v[28:31], a[212:215], v[212:215], v[28:31]
    v_add_f32 v116, v116, v20
    v_add_f32 v116, v116, v21
    v_mfma_f32_16x16x32_bf16 v[28:31], a[208:211], v[208:211], v[28:31]
    v_exp_f32 v22, v22
    v_mfma_f32_16x16x32_bf16 a[96:99], a[224:227], v[40:43], a[96:99]
    v_exp_f32 v23, v23
    v_mfma_f32_16x16x32_bf16 a[100:103], a[228:231], v[40:43], a[100:103]
    v_cvt_pk_bf16_f32 v18, v20, v21
    v_add_f32 v116, v116, v22
    v_mfma_f32_16x16x32_bf16 a[104:107], a[232:235], v[40:43], a[104:107]
    v_add_f32 v116, v116, v23
    v_cvt_pk_bf16_f32 v19, v22, v23
    v_mfma_f32_16x16x32_bf16 a[108:111], a[236:239], v[40:43], a[108:111]
    v_exp_f32 v24, v24
    v_mfma_f32_16x16x32_bf16 a[112:115], a[240:243], v[40:43], a[112:115]
    v_exp_f32 v25, v25
    v_mfma_f32_16x16x32_bf16 a[116:119], a[244:247], v[40:43], a[116:119]
    v_add_f32 v117, v117, v24
    v_add_f32 v117, v117, v25
    v_mfma_f32_16x16x32_bf16 a[120:123], a[248:251], v[40:43], a[120:123]
    v_exp_f32 v26, v26
    v_mfma_f32_16x16x32_bf16 a[124:127], a[252:255], v[40:43], a[124:127]
    v_exp_f32 v27, v27
    v_mfma_f32_16x16x32_bf16 v[32:35], a[192:195], v[224:227], 0
    v_cvt_pk_bf16_f32 v24, v24, v25
    v_add_f32 v117, v117, v26
    v_mfma_f32_16x16x32_bf16 v[32:35], a[196:199], v[228:231], v[32:35]
    v_exp_f32 v28, v28
    v_mfma_f32_16x16x32_bf16 v[32:35], a[200:203], v[232:235], v[32:35]
    v_add_f32 v117, v117, v27
    v_cvt_pk_bf16_f32 v25, v26, v27
    v_mfma_f32_16x16x32_bf16 v[32:35], a[204:207], v[236:239], v[32:35]
    v_exp_f32 v29, v29
    v_mfma_f32_16x16x32_bf16 v[36:39], a[220:223], v[236:239], 0
    v_add_f32 v117, v117, v28
    v_add_f32 v117, v117, v29
    v_mfma_f32_16x16x32_bf16 v[36:39], a[216:219], v[232:235], v[36:39]
    v_exp_f32 v30, v30
    v_mfma_f32_16x16x32_bf16 v[36:39], a[212:215], v[228:231], v[36:39]
    v_exp_f32 v31, v31
    v_mfma_f32_16x16x32_bf16 v[36:39], a[208:211], v[224:227], v[36:39]
    v_cvt_pk_bf16_f32 v26, v28, v29
    v_add_f32 v117, v117, v30
    v_mfma_f32_16x16x32_bf16 a[128:131], a[224:227], v[16:19], a[128:131]
    v_add_f32 v117, v117, v31
    v_cvt_pk_bf16_f32 v27, v30, v31
    v_mfma_f32_16x16x32_bf16 a[132:135], a[228:231], v[16:19], a[132:135]
    v_exp_f32 v32, v32
    v_mfma_f32_16x16x32_bf16 a[136:139], a[232:235], v[16:19], a[136:139]
    v_exp_f32 v33, v33
    v_mfma_f32_16x16x32_bf16 a[140:143], a[236:239], v[16:19], a[140:143]
    v_add_f32 v118, v118, v32
    v_add_f32 v118, v118, v33
    v_mfma_f32_16x16x32_bf16 a[144:147], a[240:243], v[16:19], a[144:147]
    v_exp_f32 v34, v34
    v_mfma_f32_16x16x32_bf16 a[148:151], a[244:247], v[16:19], a[148:151]
    v_exp_f32 v35, v35
    v_mfma_f32_16x16x32_bf16 a[152:155], a[248:251], v[16:19], a[152:155]
    v_cvt_pk_bf16_f32 v32, v32, v33
    v_add_f32 v118, v118, v34
    v_mfma_f32_16x16x32_bf16 a[156:159], a[252:255], v[16:19], a[156:159]
    v_exp_f32 v36, v36
    v_mfma_f32_16x16x32_bf16 v[40:43], a[192:195], v[240:243], v[124:127]
    v_add_f32 v118, v118, v35
    v_cvt_pk_bf16_f32 v33, v34, v35
    v_mfma_f32_16x16x32_bf16 v[40:43], a[196:199], v[244:247], v[40:43]
    ds_read_b128 a[192:195], v1 offset:8192
    ds_read_b128 a[196:199], v1 offset:8704
    v_mfma_f32_16x16x32_bf16 v[40:43], a[200:203], v[248:251], v[40:43]
    v_exp_f32 v37, v37
    v_mfma_f32_16x16x32_bf16 v[40:43], a[204:207], v[252:255], v[40:43]
    v_add_f32 v118, v118, v36
    v_add_f32 v118, v118, v37
    v_mfma_f32_16x16x32_bf16 v[44:47], a[220:223], v[252:255], v[124:127]
    v_exp_f32 v38, v38
    v_mfma_f32_16x16x32_bf16 v[44:47], a[216:219], v[248:251], v[44:47]
    ds_read_b128 a[200:203], v1 offset:9216
    ds_read_b128 a[204:207], v1 offset:9728
    v_mfma_f32_16x16x32_bf16 v[44:47], a[212:215], v[244:247], v[44:47]
    v_exp_f32 v39, v39
    v_mfma_f32_16x16x32_bf16 v[44:47], a[208:211], v[240:243], v[44:47]
    v_cvt_pk_bf16_f32 v34, v36, v37
    v_add_f32 v118, v118, v38
    v_mfma_f32_16x16x32_bf16 a[160:163], a[224:227], v[24:27], a[160:163]
    v_add_f32 v118, v118, v39
    v_cvt_pk_bf16_f32 v35, v38, v39
    v_mfma_f32_16x16x32_bf16 a[164:167], a[228:231], v[24:27], a[164:167]
    ds_read_b128 a[220:223], v1 offset:13824
    ds_read_b128 a[216:219], v1 offset:13312
    v_mfma_f32_16x16x32_bf16 a[168:171], a[232:235], v[24:27], a[168:171]
    v_exp_f32 v40, v40
    v_mfma_f32_16x16x32_bf16 a[172:175], a[236:239], v[24:27], a[172:175]
    v_exp_f32 v41, v41
    v_mfma_f32_16x16x32_bf16 a[176:179], a[240:243], v[24:27], a[176:179]
    v_add_f32 v119, v119, v40
    v_add_f32 v119, v119, v41
    v_mfma_f32_16x16x32_bf16 a[180:183], a[244:247], v[24:27], a[180:183]
    ds_read_b128 a[212:215], v1 offset:12800
    ds_read_b128 a[208:211], v1 offset:12288
    v_mfma_f32_16x16x32_bf16 a[184:187], a[248:251], v[24:27], a[184:187]
    v_exp_f32 v42, v42
    v_mfma_f32_16x16x32_bf16 a[188:191], a[252:255], v[24:27], a[188:191]
    s_waitcnt lgkmcnt(7)
    v_exp_f32 v43, v43
    v_mfma_f32_16x16x32_bf16 v[16:19], a[192:195], v[128:131], 0
    s_waitcnt lgkmcnt(6)
    v_cvt_pk_bf16_f32 v40, v40, v41
    v_add_f32 v119, v119, v42
    v_mfma_f32_16x16x32_bf16 v[16:19], a[196:199], v[132:135], v[16:19]
    s_waitcnt lgkmcnt(5)
    v_exp_f32 v44, v44
    v_mfma_f32_16x16x32_bf16 v[16:19], a[200:203], v[136:139], v[16:19]
    s_waitcnt lgkmcnt(4)
    v_add_f32 v119, v119, v43
    v_cvt_pk_bf16_f32 v41, v42, v43
    v_mfma_f32_16x16x32_bf16 v[16:19], a[204:207], v[140:143], v[16:19]
    s_waitcnt lgkmcnt(3)
    v_exp_f32 v45, v45
    v_mfma_f32_16x16x32_bf16 v[20:23], a[220:223], v[140:143], 0
    s_waitcnt lgkmcnt(2)
    v_add_f32 v119, v119, v44
    v_add_f32 v119, v119, v45
    v_mfma_f32_16x16x32_bf16 v[20:23], a[216:219], v[136:139], v[20:23]
    s_waitcnt lgkmcnt(1)
    v_exp_f32 v46, v46
    v_mfma_f32_16x16x32_bf16 v[20:23], a[212:215], v[132:135], v[20:23]
    s_waitcnt lgkmcnt(0)
    v_exp_f32 v47, v47
    v_mfma_f32_16x16x32_bf16 v[20:23], a[208:211], v[128:131], v[20:23]
    v_cvt_pk_bf16_f32 v42, v44, v45
    v_add_f32 v119, v119, v46
    v_mfma_f32_16x16x32_bf16 v[48:51], a[224:227], v[32:35], v[48:51]
    v_add_f32 v119, v119, v47
    v_cvt_pk_bf16_f32 v43, v46, v47
    v_mfma_f32_16x16x32_bf16 v[52:55], a[228:231], v[32:35], v[52:55]
    v_exp_f32 v16, v16
    v_mfma_f32_16x16x32_bf16 v[56:59], a[232:235], v[32:35], v[56:59]
    v_exp_f32 v17, v17
    v_mfma_f32_16x16x32_bf16 v[60:63], a[236:239], v[32:35], v[60:63]
    v_add_f32 v112, v112, v16
    v_add_f32 v112, v112, v17
    v_mfma_f32_16x16x32_bf16 v[64:67], a[240:243], v[32:35], v[64:67]
    v_exp_f32 v18, v18
    v_mfma_f32_16x16x32_bf16 v[68:71], a[244:247], v[32:35], v[68:71]
    v_exp_f32 v19, v19
    v_mfma_f32_16x16x32_bf16 v[72:75], a[248:251], v[32:35], v[72:75]
    v_cvt_pk_bf16_f32 v16, v16, v17
    v_add_f32 v112, v112, v18
    v_mfma_f32_16x16x32_bf16 v[76:79], a[252:255], v[32:35], v[76:79]
    v_exp_f32 v20, v20
    v_mfma_f32_16x16x32_bf16 v[24:27], a[192:195], v[144:147], 0
    v_add_f32 v112, v112, v19
    v_cvt_pk_bf16_f32 v17, v18, v19
    v_mfma_f32_16x16x32_bf16 v[24:27], a[196:199], v[148:151], v[24:27]
    v_exp_f32 v21, v21
    v_mfma_f32_16x16x32_bf16 v[24:27], a[200:203], v[152:155], v[24:27]
    v_add_f32 v112, v112, v20
    v_add_f32 v112, v112, v21
    v_mfma_f32_16x16x32_bf16 v[24:27], a[204:207], v[156:159], v[24:27]
    v_exp_f32 v22, v22
    v_mfma_f32_16x16x32_bf16 v[28:31], a[220:223], v[156:159], 0
    v_exp_f32 v23, v23
    v_mfma_f32_16x16x32_bf16 v[28:31], a[216:219], v[152:155], v[28:31]
    v_cvt_pk_bf16_f32 v18, v20, v21
    v_add_f32 v112, v112, v22
    v_mfma_f32_16x16x32_bf16 v[28:31], a[212:215], v[148:151], v[28:31]
    v_add_f32 v112, v112, v23
    v_cvt_pk_bf16_f32 v19, v22, v23
    v_mfma_f32_16x16x32_bf16 v[28:31], a[208:211], v[144:147], v[28:31]
    v_exp_f32 v24, v24
    v_mfma_f32_16x16x32_bf16 v[80:83], a[224:227], v[40:43], v[80:83]
    ds_read_b64_tr_b16 a[224:225], v2 offset:8192
    ds_read_b64_tr_b16 a[226:227], v2 offset:12288
    v_mfma_f32_16x16x32_bf16 v[84:87], a[228:231], v[40:43], v[84:87]
    v_exp_f32 v25, v25
    v_mfma_f32_16x16x32_bf16 v[88:91], a[232:235], v[40:43], v[88:91]
    ds_read_b64_tr_b16 a[228:229], v2 offset:8448
    ds_read_b64_tr_b16 a[230:231], v2 offset:12544
    v_mfma_f32_16x16x32_bf16 v[92:95], a[236:239], v[40:43], v[92:95]
    v_add_f32 v113, v113, v24
    v_add_f32 v113, v113, v25
    v_mfma_f32_16x16x32_bf16 v[96:99], a[240:243], v[40:43], v[96:99]
    ds_read_b64_tr_b16 a[232:233], v2 offset:8704
    ds_read_b64_tr_b16 a[234:235], v2 offset:12800
    v_mfma_f32_16x16x32_bf16 v[100:103], a[244:247], v[40:43], v[100:103]
    v_exp_f32 v26, v26
    v_mfma_f32_16x16x32_bf16 v[104:107], a[248:251], v[40:43], v[104:107]
    ds_read_b64_tr_b16 a[236:237], v2 offset:8960
    ds_read_b64_tr_b16 a[238:239], v2 offset:13056
    v_mfma_f32_16x16x32_bf16 v[108:111], a[252:255], v[40:43], v[108:111]
    v_exp_f32 v27, v27
    v_mfma_f32_16x16x32_bf16 v[32:35], a[192:195], v[160:163], 0
    ds_read_b64_tr_b16 a[240:241], v2 offset:9216
    ds_read_b64_tr_b16 a[242:243], v2 offset:13312
    v_mfma_f32_16x16x32_bf16 v[32:35], a[196:199], v[164:167], v[32:35]
    v_cvt_pk_bf16_f32 v24, v24, v25
    v_add_f32 v113, v113, v26
    v_mfma_f32_16x16x32_bf16 v[32:35], a[200:203], v[168:171], v[32:35]
    ds_read_b64_tr_b16 a[244:245], v2 offset:9472
    ds_read_b64_tr_b16 a[246:247], v2 offset:13568
    v_mfma_f32_16x16x32_bf16 v[32:35], a[204:207], v[172:175], v[32:35]
    v_exp_f32 v28, v28
    v_mfma_f32_16x16x32_bf16 v[36:39], a[220:223], v[172:175], 0
    ds_read_b64_tr_b16 a[248:249], v2 offset:9728
    ds_read_b64_tr_b16 a[250:251], v2 offset:13824
    v_mfma_f32_16x16x32_bf16 v[36:39], a[216:219], v[168:171], v[36:39]
    v_add_f32 v113, v113, v27
    v_cvt_pk_bf16_f32 v25, v26, v27
    v_mfma_f32_16x16x32_bf16 v[36:39], a[212:215], v[164:167], v[36:39]
    ds_read_b64_tr_b16 a[252:253], v2 offset:9984
    ds_read_b64_tr_b16 a[254:255], v2 offset:14080
    v_mfma_f32_16x16x32_bf16 v[36:39], a[208:211], v[160:163], v[36:39]
    s_waitcnt lgkmcnt(14)
    v_exp_f32 v29, v29
    v_mfma_f32_16x16x32_bf16 a[0:3], a[224:227], v[16:19], a[0:3]
    s_waitcnt lgkmcnt(12)
    v_add_f32 v113, v113, v28
    v_add_f32 v113, v113, v29
    v_mfma_f32_16x16x32_bf16 a[4:7], a[228:231], v[16:19], a[4:7]
    s_waitcnt lgkmcnt(10)
    v_exp_f32 v30, v30
    v_mfma_f32_16x16x32_bf16 a[8:11], a[232:235], v[16:19], a[8:11]
    s_waitcnt lgkmcnt(8)
    v_exp_f32 v31, v31
    v_mfma_f32_16x16x32_bf16 a[12:15], a[236:239], v[16:19], a[12:15]
    s_waitcnt lgkmcnt(6)
    v_cvt_pk_bf16_f32 v26, v28, v29
    v_add_f32 v113, v113, v30
    v_mfma_f32_16x16x32_bf16 a[16:19], a[240:243], v[16:19], a[16:19]
    s_waitcnt lgkmcnt(4)
    v_add_f32 v113, v113, v31
    v_cvt_pk_bf16_f32 v27, v30, v31
    v_mfma_f32_16x16x32_bf16 a[20:23], a[244:247], v[16:19], a[20:23]
    s_waitcnt lgkmcnt(2)
    v_exp_f32 v32, v32
    v_mfma_f32_16x16x32_bf16 a[24:27], a[248:251], v[16:19], a[24:27]
    s_waitcnt lgkmcnt(0)
    v_exp_f32 v33, v33
    v_mfma_f32_16x16x32_bf16 a[28:31], a[252:255], v[16:19], a[28:31]
    v_add_f32 v114, v114, v32
    v_add_f32 v114, v114, v33
    v_mfma_f32_16x16x32_bf16 v[40:43], a[192:195], v[176:179], 0
    s_waitcnt vmcnt(8)
    v_exp_f32 v34, v34
    v_mfma_f32_16x16x32_bf16 v[40:43], a[196:199], v[180:183], v[40:43]
    s_barrier
    v_exp_f32 v35, v35
    v_mfma_f32_16x16x32_bf16 v[40:43], a[200:203], v[184:187], v[40:43]
    v_cvt_pk_bf16_f32 v32, v32, v33
    v_add_f32 v114, v114, v34
    v_mfma_f32_16x16x32_bf16 v[40:43], a[204:207], v[188:191], v[40:43]
    s_add_u32 m0, s26, 40960
    v_exp_f32 v36, v36
    v_mfma_f32_16x16x32_bf16 v[44:47], a[220:223], v[188:191], 0
    buffer_load_dwordx4 v3, s[12:15], s25 offen nt lds
    v_mfma_f32_16x16x32_bf16 v[44:47], a[216:219], v[184:187], v[44:47]
    v_add_f32 v114, v114, v35
    v_cvt_pk_bf16_f32 v33, v34, v35
    v_mfma_f32_16x16x32_bf16 v[44:47], a[212:215], v[180:183], v[44:47]
    s_add_u32 m0, s26, 41856
    v_exp_f32 v37, v37
    v_mfma_f32_16x16x32_bf16 v[44:47], a[208:211], v[176:179], v[44:47]
    buffer_load_dwordx4 v3, s[12:15], s25 offen offset:128 nt lds
    v_mfma_f32_16x16x32_bf16 a[32:35], a[224:227], v[24:27], a[32:35]
    v_add_f32 v114, v114, v36
    v_add_f32 v114, v114, v37
    v_mfma_f32_16x16x32_bf16 a[36:39], a[228:231], v[24:27], a[36:39]
    s_add_u32 m0, s26, 106496
    v_exp_f32 v38, v38
    v_mfma_f32_16x16x32_bf16 a[40:43], a[232:235], v[24:27], a[40:43]
    buffer_load_dwordx4 v4, s[16:19], s25 offen nt lds
    v_mfma_f32_16x16x32_bf16 a[44:47], a[236:239], v[24:27], a[44:47]
    v_exp_f32 v39, v39
    v_mfma_f32_16x16x32_bf16 a[48:51], a[240:243], v[24:27], a[48:51]
    s_add_u32 m0, s26, 107392
    v_cvt_pk_bf16_f32 v34, v36, v37
    v_add_f32 v114, v114, v38
    v_mfma_f32_16x16x32_bf16 a[52:55], a[244:247], v[24:27], a[52:55]
    buffer_load_dwordx4 v4, s[16:19], s25 offen offset:128 nt lds
    v_mfma_f32_16x16x32_bf16 a[56:59], a[248:251], v[24:27], a[56:59]
    s_add_u32 s25, s25, 8192
    v_add_f32 v114, v114, v39
    v_cvt_pk_bf16_f32 v35, v38, v39
    v_mfma_f32_16x16x32_bf16 a[60:63], a[252:255], v[24:27], a[60:63]
    v_exp_f32 v40, v40
    v_mfma_f32_16x16x32_bf16 v[16:19], a[192:195], v[192:195], 0
    v_exp_f32 v41, v41
    v_mfma_f32_16x16x32_bf16 v[16:19], a[196:199], v[196:199], v[16:19]
    v_add_f32 v115, v115, v40
    v_add_f32 v115, v115, v41
    v_mfma_f32_16x16x32_bf16 v[16:19], a[200:203], v[200:203], v[16:19]
    v_exp_f32 v42, v42
    v_mfma_f32_16x16x32_bf16 v[16:19], a[204:207], v[204:207], v[16:19]
    v_exp_f32 v43, v43
    v_mfma_f32_16x16x32_bf16 v[20:23], a[220:223], v[204:207], 0
    v_cvt_pk_bf16_f32 v40, v40, v41
    v_add_f32 v115, v115, v42
    v_mfma_f32_16x16x32_bf16 v[20:23], a[216:219], v[200:203], v[20:23]
    v_exp_f32 v44, v44
    v_mfma_f32_16x16x32_bf16 v[20:23], a[212:215], v[196:199], v[20:23]
    v_add_f32 v115, v115, v43
    v_cvt_pk_bf16_f32 v41, v42, v43
    v_mfma_f32_16x16x32_bf16 v[20:23], a[208:211], v[192:195], v[20:23]
    v_exp_f32 v45, v45
    v_mfma_f32_16x16x32_bf16 a[64:67], a[224:227], v[32:35], a[64:67]
    v_add_f32 v115, v115, v44
    v_add_f32 v115, v115, v45
    v_mfma_f32_16x16x32_bf16 a[68:71], a[228:231], v[32:35], a[68:71]
    v_exp_f32 v46, v46
    v_mfma_f32_16x16x32_bf16 a[72:75], a[232:235], v[32:35], a[72:75]
    v_exp_f32 v47, v47
    v_mfma_f32_16x16x32_bf16 a[76:79], a[236:239], v[32:35], a[76:79]
    v_cvt_pk_bf16_f32 v42, v44, v45
    v_add_f32 v115, v115, v46
    v_mfma_f32_16x16x32_bf16 a[80:83], a[240:243], v[32:35], a[80:83]
    v_add_f32 v115, v115, v47
    v_cvt_pk_bf16_f32 v43, v46, v47
    v_mfma_f32_16x16x32_bf16 a[84:87], a[244:247], v[32:35], a[84:87]
    v_exp_f32 v16, v16
    v_mfma_f32_16x16x32_bf16 a[88:91], a[248:251], v[32:35], a[88:91]
    v_exp_f32 v17, v17
    v_mfma_f32_16x16x32_bf16 a[92:95], a[252:255], v[32:35], a[92:95]
    v_add_f32 v116, v116, v16
    v_add_f32 v116, v116, v17
    v_mfma_f32_16x16x32_bf16 v[24:27], a[192:195], v[208:211], 0
    v_exp_f32 v18, v18
    v_mfma_f32_16x16x32_bf16 v[24:27], a[196:199], v[212:215], v[24:27]
    v_exp_f32 v19, v19
    v_mfma_f32_16x16x32_bf16 v[24:27], a[200:203], v[216:219], v[24:27]
    v_cvt_pk_bf16_f32 v16, v16, v17
    v_add_f32 v116, v116, v18
    v_mfma_f32_16x16x32_bf16 v[24:27], a[204:207], v[220:223], v[24:27]
    v_exp_f32 v20, v20
    v_mfma_f32_16x16x32_bf16 v[28:31], a[220:223], v[220:223], 0
    v_add_f32 v116, v116, v19
    v_cvt_pk_bf16_f32 v17, v18, v19
    v_mfma_f32_16x16x32_bf16 v[28:31], a[216:219], v[216:219], v[28:31]
    v_exp_f32 v21, v21
    v_mfma_f32_16x16x32_bf16 v[28:31], a[212:215], v[212:215], v[28:31]
    v_add_f32 v116, v116, v20
    v_add_f32 v116, v116, v21
    v_mfma_f32_16x16x32_bf16 v[28:31], a[208:211], v[208:211], v[28:31]
    v_exp_f32 v22, v22
    v_mfma_f32_16x16x32_bf16 a[96:99], a[224:227], v[40:43], a[96:99]
    v_exp_f32 v23, v23
    v_mfma_f32_16x16x32_bf16 a[100:103], a[228:231], v[40:43], a[100:103]
    v_cvt_pk_bf16_f32 v18, v20, v21
    v_add_f32 v116, v116, v22
    v_mfma_f32_16x16x32_bf16 a[104:107], a[232:235], v[40:43], a[104:107]
    v_add_f32 v116, v116, v23
    v_cvt_pk_bf16_f32 v19, v22, v23
    v_mfma_f32_16x16x32_bf16 a[108:111], a[236:239], v[40:43], a[108:111]
    v_exp_f32 v24, v24
    v_mfma_f32_16x16x32_bf16 a[112:115], a[240:243], v[40:43], a[112:115]
    v_exp_f32 v25, v25
    v_mfma_f32_16x16x32_bf16 a[116:119], a[244:247], v[40:43], a[116:119]
    v_add_f32 v117, v117, v24
    v_add_f32 v117, v117, v25
    v_mfma_f32_16x16x32_bf16 a[120:123], a[248:251], v[40:43], a[120:123]
    v_exp_f32 v26, v26
    v_mfma_f32_16x16x32_bf16 a[124:127], a[252:255], v[40:43], a[124:127]
    v_exp_f32 v27, v27
    v_mfma_f32_16x16x32_bf16 v[32:35], a[192:195], v[224:227], 0
    v_cvt_pk_bf16_f32 v24, v24, v25
    v_add_f32 v117, v117, v26
    v_mfma_f32_16x16x32_bf16 v[32:35], a[196:199], v[228:231], v[32:35]
    v_exp_f32 v28, v28
    v_mfma_f32_16x16x32_bf16 v[32:35], a[200:203], v[232:235], v[32:35]
    v_add_f32 v117, v117, v27
    v_cvt_pk_bf16_f32 v25, v26, v27
    v_mfma_f32_16x16x32_bf16 v[32:35], a[204:207], v[236:239], v[32:35]
    v_exp_f32 v29, v29
    v_mfma_f32_16x16x32_bf16 v[36:39], a[220:223], v[236:239], 0
    v_add_f32 v117, v117, v28
    v_add_f32 v117, v117, v29
    v_mfma_f32_16x16x32_bf16 v[36:39], a[216:219], v[232:235], v[36:39]
    v_exp_f32 v30, v30
    v_mfma_f32_16x16x32_bf16 v[36:39], a[212:215], v[228:231], v[36:39]
    v_exp_f32 v31, v31
    v_mfma_f32_16x16x32_bf16 v[36:39], a[208:211], v[224:227], v[36:39]
    v_cvt_pk_bf16_f32 v26, v28, v29
    v_add_f32 v117, v117, v30
    v_mfma_f32_16x16x32_bf16 a[128:131], a[224:227], v[16:19], a[128:131]
    v_add_f32 v117, v117, v31
    v_cvt_pk_bf16_f32 v27, v30, v31
    v_mfma_f32_16x16x32_bf16 a[132:135], a[228:231], v[16:19], a[132:135]
    v_exp_f32 v32, v32
    v_mfma_f32_16x16x32_bf16 a[136:139], a[232:235], v[16:19], a[136:139]
    v_exp_f32 v33, v33
    v_mfma_f32_16x16x32_bf16 a[140:143], a[236:239], v[16:19], a[140:143]
    v_add_f32 v118, v118, v32
    v_add_f32 v118, v118, v33
    v_mfma_f32_16x16x32_bf16 a[144:147], a[240:243], v[16:19], a[144:147]
    v_exp_f32 v34, v34
    v_mfma_f32_16x16x32_bf16 a[148:151], a[244:247], v[16:19], a[148:151]
    v_exp_f32 v35, v35
    v_mfma_f32_16x16x32_bf16 a[152:155], a[248:251], v[16:19], a[152:155]
    v_cvt_pk_bf16_f32 v32, v32, v33
    v_add_f32 v118, v118, v34
    v_mfma_f32_16x16x32_bf16 a[156:159], a[252:255], v[16:19], a[156:159]
    v_exp_f32 v36, v36
    v_mfma_f32_16x16x32_bf16 v[40:43], a[192:195], v[240:243], v[124:127]
    v_add_f32 v118, v118, v35
    v_cvt_pk_bf16_f32 v33, v34, v35
    v_mfma_f32_16x16x32_bf16 v[40:43], a[196:199], v[244:247], v[40:43]
    ds_read_b128 a[192:195], v1 offset:16384
    ds_read_b128 a[196:199], v1 offset:16896
    v_mfma_f32_16x16x32_bf16 v[40:43], a[200:203], v[248:251], v[40:43]
    v_exp_f32 v37, v37
    v_mfma_f32_16x16x32_bf16 v[40:43], a[204:207], v[252:255], v[40:43]
    v_add_f32 v118, v118, v36
    v_add_f32 v118, v118, v37
    v_mfma_f32_16x16x32_bf16 v[44:47], a[220:223], v[252:255], v[124:127]
    v_exp_f32 v38, v38
    v_mfma_f32_16x16x32_bf16 v[44:47], a[216:219], v[248:251], v[44:47]
    ds_read_b128 a[200:203], v1 offset:17408
    ds_read_b128 a[204:207], v1 offset:17920
    v_mfma_f32_16x16x32_bf16 v[44:47], a[212:215], v[244:247], v[44:47]
    v_exp_f32 v39, v39
    v_mfma_f32_16x16x32_bf16 v[44:47], a[208:211], v[240:243], v[44:47]
    v_cvt_pk_bf16_f32 v34, v36, v37
    v_add_f32 v118, v118, v38
    v_mfma_f32_16x16x32_bf16 a[160:163], a[224:227], v[24:27], a[160:163]
    v_add_f32 v118, v118, v39
    v_cvt_pk_bf16_f32 v35, v38, v39
    v_mfma_f32_16x16x32_bf16 a[164:167], a[228:231], v[24:27], a[164:167]
    ds_read_b128 a[220:223], v1 offset:22016
    ds_read_b128 a[216:219], v1 offset:21504
    v_mfma_f32_16x16x32_bf16 a[168:171], a[232:235], v[24:27], a[168:171]
    v_exp_f32 v40, v40
    v_mfma_f32_16x16x32_bf16 a[172:175], a[236:239], v[24:27], a[172:175]
    v_exp_f32 v41, v41
    v_mfma_f32_16x16x32_bf16 a[176:179], a[240:243], v[24:27], a[176:179]
    v_add_f32 v119, v119, v40
    v_add_f32 v119, v119, v41
    v_mfma_f32_16x16x32_bf16 a[180:183], a[244:247], v[24:27], a[180:183]
    ds_read_b128 a[212:215], v1 offset:20992
    ds_read_b128 a[208:211], v1 offset:20480
    v_mfma_f32_16x16x32_bf16 a[184:187], a[248:251], v[24:27], a[184:187]
    v_exp_f32 v42, v42
    v_mfma_f32_16x16x32_bf16 a[188:191], a[252:255], v[24:27], a[188:191]
    s_waitcnt lgkmcnt(7)
    v_exp_f32 v43, v43
    v_mfma_f32_16x16x32_bf16 v[16:19], a[192:195], v[128:131], 0
    s_waitcnt lgkmcnt(6)
    v_cvt_pk_bf16_f32 v40, v40, v41
    v_add_f32 v119, v119, v42
    v_mfma_f32_16x16x32_bf16 v[16:19], a[196:199], v[132:135], v[16:19]
    s_waitcnt lgkmcnt(5)
    v_exp_f32 v44, v44
    v_mfma_f32_16x16x32_bf16 v[16:19], a[200:203], v[136:139], v[16:19]
    s_waitcnt lgkmcnt(4)
    v_add_f32 v119, v119, v43
    v_cvt_pk_bf16_f32 v41, v42, v43
    v_mfma_f32_16x16x32_bf16 v[16:19], a[204:207], v[140:143], v[16:19]
    s_waitcnt lgkmcnt(3)
    v_exp_f32 v45, v45
    v_mfma_f32_16x16x32_bf16 v[20:23], a[220:223], v[140:143], 0
    s_waitcnt lgkmcnt(2)
    v_add_f32 v119, v119, v44
    v_add_f32 v119, v119, v45
    v_mfma_f32_16x16x32_bf16 v[20:23], a[216:219], v[136:139], v[20:23]
    s_waitcnt lgkmcnt(1)
    v_exp_f32 v46, v46
    v_mfma_f32_16x16x32_bf16 v[20:23], a[212:215], v[132:135], v[20:23]
    s_waitcnt lgkmcnt(0)
    v_exp_f32 v47, v47
    v_mfma_f32_16x16x32_bf16 v[20:23], a[208:211], v[128:131], v[20:23]
    v_cvt_pk_bf16_f32 v42, v44, v45
    v_add_f32 v119, v119, v46
    v_mfma_f32_16x16x32_bf16 v[48:51], a[224:227], v[32:35], v[48:51]
    v_add_f32 v119, v119, v47
    v_cvt_pk_bf16_f32 v43, v46, v47
    v_mfma_f32_16x16x32_bf16 v[52:55], a[228:231], v[32:35], v[52:55]
    v_exp_f32 v16, v16
    v_mfma_f32_16x16x32_bf16 v[56:59], a[232:235], v[32:35], v[56:59]
    v_exp_f32 v17, v17
    v_mfma_f32_16x16x32_bf16 v[60:63], a[236:239], v[32:35], v[60:63]
    v_add_f32 v112, v112, v16
    v_add_f32 v112, v112, v17
    v_mfma_f32_16x16x32_bf16 v[64:67], a[240:243], v[32:35], v[64:67]
    v_exp_f32 v18, v18
    v_mfma_f32_16x16x32_bf16 v[68:71], a[244:247], v[32:35], v[68:71]
    v_exp_f32 v19, v19
    v_mfma_f32_16x16x32_bf16 v[72:75], a[248:251], v[32:35], v[72:75]
    v_cvt_pk_bf16_f32 v16, v16, v17
    v_add_f32 v112, v112, v18
    v_mfma_f32_16x16x32_bf16 v[76:79], a[252:255], v[32:35], v[76:79]
    v_exp_f32 v20, v20
    v_mfma_f32_16x16x32_bf16 v[24:27], a[192:195], v[144:147], 0
    v_add_f32 v112, v112, v19
    v_cvt_pk_bf16_f32 v17, v18, v19
    v_mfma_f32_16x16x32_bf16 v[24:27], a[196:199], v[148:151], v[24:27]
    v_exp_f32 v21, v21
    v_mfma_f32_16x16x32_bf16 v[24:27], a[200:203], v[152:155], v[24:27]
    v_add_f32 v112, v112, v20
    v_add_f32 v112, v112, v21
    v_mfma_f32_16x16x32_bf16 v[24:27], a[204:207], v[156:159], v[24:27]
    v_exp_f32 v22, v22
    v_mfma_f32_16x16x32_bf16 v[28:31], a[220:223], v[156:159], 0
    v_exp_f32 v23, v23
    v_mfma_f32_16x16x32_bf16 v[28:31], a[216:219], v[152:155], v[28:31]
    v_cvt_pk_bf16_f32 v18, v20, v21
    v_add_f32 v112, v112, v22
    v_mfma_f32_16x16x32_bf16 v[28:31], a[212:215], v[148:151], v[28:31]
    v_add_f32 v112, v112, v23
    v_cvt_pk_bf16_f32 v19, v22, v23
    v_mfma_f32_16x16x32_bf16 v[28:31], a[208:211], v[144:147], v[28:31]
    v_exp_f32 v24, v24
    v_mfma_f32_16x16x32_bf16 v[80:83], a[224:227], v[40:43], v[80:83]
    ds_read_b64_tr_b16 a[224:225], v2 offset:16384
    ds_read_b64_tr_b16 a[226:227], v2 offset:20480
    v_mfma_f32_16x16x32_bf16 v[84:87], a[228:231], v[40:43], v[84:87]
    v_exp_f32 v25, v25
    v_mfma_f32_16x16x32_bf16 v[88:91], a[232:235], v[40:43], v[88:91]
    ds_read_b64_tr_b16 a[228:229], v2 offset:16640
    ds_read_b64_tr_b16 a[230:231], v2 offset:20736
    v_mfma_f32_16x16x32_bf16 v[92:95], a[236:239], v[40:43], v[92:95]
    v_add_f32 v113, v113, v24
    v_add_f32 v113, v113, v25
    v_mfma_f32_16x16x32_bf16 v[96:99], a[240:243], v[40:43], v[96:99]
    ds_read_b64_tr_b16 a[232:233], v2 offset:16896
    ds_read_b64_tr_b16 a[234:235], v2 offset:20992
    v_mfma_f32_16x16x32_bf16 v[100:103], a[244:247], v[40:43], v[100:103]
    v_exp_f32 v26, v26
    v_mfma_f32_16x16x32_bf16 v[104:107], a[248:251], v[40:43], v[104:107]
    ds_read_b64_tr_b16 a[236:237], v2 offset:17152
    ds_read_b64_tr_b16 a[238:239], v2 offset:21248
    v_mfma_f32_16x16x32_bf16 v[108:111], a[252:255], v[40:43], v[108:111]
    v_exp_f32 v27, v27
    v_mfma_f32_16x16x32_bf16 v[32:35], a[192:195], v[160:163], 0
    ds_read_b64_tr_b16 a[240:241], v2 offset:17408
    ds_read_b64_tr_b16 a[242:243], v2 offset:21504
    v_mfma_f32_16x16x32_bf16 v[32:35], a[196:199], v[164:167], v[32:35]
    v_cvt_pk_bf16_f32 v24, v24, v25
    v_add_f32 v113, v113, v26
    v_mfma_f32_16x16x32_bf16 v[32:35], a[200:203], v[168:171], v[32:35]
    ds_read_b64_tr_b16 a[244:245], v2 offset:17664
    ds_read_b64_tr_b16 a[246:247], v2 offset:21760
    v_mfma_f32_16x16x32_bf16 v[32:35], a[204:207], v[172:175], v[32:35]
    v_exp_f32 v28, v28
    v_mfma_f32_16x16x32_bf16 v[36:39], a[220:223], v[172:175], 0
    ds_read_b64_tr_b16 a[248:249], v2 offset:17920
    ds_read_b64_tr_b16 a[250:251], v2 offset:22016
    v_mfma_f32_16x16x32_bf16 v[36:39], a[216:219], v[168:171], v[36:39]
    v_add_f32 v113, v113, v27
    v_cvt_pk_bf16_f32 v25, v26, v27
    v_mfma_f32_16x16x32_bf16 v[36:39], a[212:215], v[164:167], v[36:39]
    ds_read_b64_tr_b16 a[252:253], v2 offset:18176
    ds_read_b64_tr_b16 a[254:255], v2 offset:22272
    v_mfma_f32_16x16x32_bf16 v[36:39], a[208:211], v[160:163], v[36:39]
    s_waitcnt lgkmcnt(14)
    v_exp_f32 v29, v29
    v_mfma_f32_16x16x32_bf16 a[0:3], a[224:227], v[16:19], a[0:3]
    s_waitcnt lgkmcnt(12)
    v_add_f32 v113, v113, v28
    v_add_f32 v113, v113, v29
    v_mfma_f32_16x16x32_bf16 a[4:7], a[228:231], v[16:19], a[4:7]
    s_waitcnt lgkmcnt(10)
    v_exp_f32 v30, v30
    v_mfma_f32_16x16x32_bf16 a[8:11], a[232:235], v[16:19], a[8:11]
    s_waitcnt lgkmcnt(8)
    v_exp_f32 v31, v31
    v_mfma_f32_16x16x32_bf16 a[12:15], a[236:239], v[16:19], a[12:15]
    s_waitcnt lgkmcnt(6)
    v_cvt_pk_bf16_f32 v26, v28, v29
    v_add_f32 v113, v113, v30
    v_mfma_f32_16x16x32_bf16 a[16:19], a[240:243], v[16:19], a[16:19]
    s_waitcnt lgkmcnt(4)
    v_add_f32 v113, v113, v31
    v_cvt_pk_bf16_f32 v27, v30, v31
    v_mfma_f32_16x16x32_bf16 a[20:23], a[244:247], v[16:19], a[20:23]
    s_waitcnt lgkmcnt(2)
    v_exp_f32 v32, v32
    v_mfma_f32_16x16x32_bf16 a[24:27], a[248:251], v[16:19], a[24:27]
    s_waitcnt lgkmcnt(0)
    v_exp_f32 v33, v33
    v_mfma_f32_16x16x32_bf16 a[28:31], a[252:255], v[16:19], a[28:31]
    v_add_f32 v114, v114, v32
    v_add_f32 v114, v114, v33
    v_mfma_f32_16x16x32_bf16 v[40:43], a[192:195], v[176:179], 0
    s_waitcnt vmcnt(8)
    v_exp_f32 v34, v34
    v_mfma_f32_16x16x32_bf16 v[40:43], a[196:199], v[180:183], v[40:43]
    s_barrier
    v_exp_f32 v35, v35
    v_mfma_f32_16x16x32_bf16 v[40:43], a[200:203], v[184:187], v[40:43]
    v_cvt_pk_bf16_f32 v32, v32, v33
    v_add_f32 v114, v114, v34
    v_mfma_f32_16x16x32_bf16 v[40:43], a[204:207], v[188:191], v[40:43]
    s_add_u32 m0, s26, 49152
    v_exp_f32 v36, v36
    v_mfma_f32_16x16x32_bf16 v[44:47], a[220:223], v[188:191], 0
    buffer_load_dwordx4 v3, s[12:15], s25 offen nt lds
    v_mfma_f32_16x16x32_bf16 v[44:47], a[216:219], v[184:187], v[44:47]
    v_add_f32 v114, v114, v35
    v_cvt_pk_bf16_f32 v33, v34, v35
    v_mfma_f32_16x16x32_bf16 v[44:47], a[212:215], v[180:183], v[44:47]
    s_add_u32 m0, s26, 50048
    v_exp_f32 v37, v37
    v_mfma_f32_16x16x32_bf16 v[44:47], a[208:211], v[176:179], v[44:47]
    buffer_load_dwordx4 v3, s[12:15], s25 offen offset:128 nt lds
    v_mfma_f32_16x16x32_bf16 a[32:35], a[224:227], v[24:27], a[32:35]
    v_add_f32 v114, v114, v36
    v_add_f32 v114, v114, v37
    v_mfma_f32_16x16x32_bf16 a[36:39], a[228:231], v[24:27], a[36:39]
    s_add_u32 m0, s26, 114688
    v_exp_f32 v38, v38
    v_mfma_f32_16x16x32_bf16 a[40:43], a[232:235], v[24:27], a[40:43]
    buffer_load_dwordx4 v4, s[16:19], s25 offen nt lds
    v_mfma_f32_16x16x32_bf16 a[44:47], a[236:239], v[24:27], a[44:47]
    v_exp_f32 v39, v39
    v_mfma_f32_16x16x32_bf16 a[48:51], a[240:243], v[24:27], a[48:51]
    s_add_u32 m0, s26, 115584
    v_cvt_pk_bf16_f32 v34, v36, v37
    v_add_f32 v114, v114, v38
    v_mfma_f32_16x16x32_bf16 a[52:55], a[244:247], v[24:27], a[52:55]
    buffer_load_dwordx4 v4, s[16:19], s25 offen offset:128 nt lds
    v_mfma_f32_16x16x32_bf16 a[56:59], a[248:251], v[24:27], a[56:59]
    s_add_u32 s25, s25, 8192
    v_add_f32 v114, v114, v39
    v_cvt_pk_bf16_f32 v35, v38, v39
    v_mfma_f32_16x16x32_bf16 a[60:63], a[252:255], v[24:27], a[60:63]
    v_exp_f32 v40, v40
    v_mfma_f32_16x16x32_bf16 v[16:19], a[192:195], v[192:195], 0
    v_exp_f32 v41, v41
    v_mfma_f32_16x16x32_bf16 v[16:19], a[196:199], v[196:199], v[16:19]
    v_add_f32 v115, v115, v40
    v_add_f32 v115, v115, v41
    v_mfma_f32_16x16x32_bf16 v[16:19], a[200:203], v[200:203], v[16:19]
    v_exp_f32 v42, v42
    v_mfma_f32_16x16x32_bf16 v[16:19], a[204:207], v[204:207], v[16:19]
    v_exp_f32 v43, v43
    v_mfma_f32_16x16x32_bf16 v[20:23], a[220:223], v[204:207], 0
    v_cvt_pk_bf16_f32 v40, v40, v41
    v_add_f32 v115, v115, v42
    v_mfma_f32_16x16x32_bf16 v[20:23], a[216:219], v[200:203], v[20:23]
    v_exp_f32 v44, v44
    v_mfma_f32_16x16x32_bf16 v[20:23], a[212:215], v[196:199], v[20:23]
    v_add_f32 v115, v115, v43
    v_cvt_pk_bf16_f32 v41, v42, v43
    v_mfma_f32_16x16x32_bf16 v[20:23], a[208:211], v[192:195], v[20:23]
    v_exp_f32 v45, v45
    v_mfma_f32_16x16x32_bf16 a[64:67], a[224:227], v[32:35], a[64:67]
    v_add_f32 v115, v115, v44
    v_add_f32 v115, v115, v45
    v_mfma_f32_16x16x32_bf16 a[68:71], a[228:231], v[32:35], a[68:71]
    v_exp_f32 v46, v46
    v_mfma_f32_16x16x32_bf16 a[72:75], a[232:235], v[32:35], a[72:75]
    v_exp_f32 v47, v47
    v_mfma_f32_16x16x32_bf16 a[76:79], a[236:239], v[32:35], a[76:79]
    v_cvt_pk_bf16_f32 v42, v44, v45
    v_add_f32 v115, v115, v46
    v_mfma_f32_16x16x32_bf16 a[80:83], a[240:243], v[32:35], a[80:83]
    v_add_f32 v115, v115, v47
    v_cvt_pk_bf16_f32 v43, v46, v47
    v_mfma_f32_16x16x32_bf16 a[84:87], a[244:247], v[32:35], a[84:87]
    v_exp_f32 v16, v16
    v_mfma_f32_16x16x32_bf16 a[88:91], a[248:251], v[32:35], a[88:91]
    v_exp_f32 v17, v17
    v_mfma_f32_16x16x32_bf16 a[92:95], a[252:255], v[32:35], a[92:95]
    v_add_f32 v116, v116, v16
    v_add_f32 v116, v116, v17
    v_mfma_f32_16x16x32_bf16 v[24:27], a[192:195], v[208:211], 0
    v_exp_f32 v18, v18
    v_mfma_f32_16x16x32_bf16 v[24:27], a[196:199], v[212:215], v[24:27]
    v_exp_f32 v19, v19
    v_mfma_f32_16x16x32_bf16 v[24:27], a[200:203], v[216:219], v[24:27]
    v_cvt_pk_bf16_f32 v16, v16, v17
    v_add_f32 v116, v116, v18
    v_mfma_f32_16x16x32_bf16 v[24:27], a[204:207], v[220:223], v[24:27]
    v_exp_f32 v20, v20
    v_mfma_f32_16x16x32_bf16 v[28:31], a[220:223], v[220:223], 0
    v_add_f32 v116, v116, v19
    v_cvt_pk_bf16_f32 v17, v18, v19
    v_mfma_f32_16x16x32_bf16 v[28:31], a[216:219], v[216:219], v[28:31]
    v_exp_f32 v21, v21
    v_mfma_f32_16x16x32_bf16 v[28:31], a[212:215], v[212:215], v[28:31]
    v_add_f32 v116, v116, v20
    v_add_f32 v116, v116, v21
    v_mfma_f32_16x16x32_bf16 v[28:31], a[208:211], v[208:211], v[28:31]
    v_exp_f32 v22, v22
    v_mfma_f32_16x16x32_bf16 a[96:99], a[224:227], v[40:43], a[96:99]
    v_exp_f32 v23, v23
    v_mfma_f32_16x16x32_bf16 a[100:103], a[228:231], v[40:43], a[100:103]
    v_cvt_pk_bf16_f32 v18, v20, v21
    v_add_f32 v116, v116, v22
    v_mfma_f32_16x16x32_bf16 a[104:107], a[232:235], v[40:43], a[104:107]
    v_add_f32 v116, v116, v23
    v_cvt_pk_bf16_f32 v19, v22, v23
    v_mfma_f32_16x16x32_bf16 a[108:111], a[236:239], v[40:43], a[108:111]
    v_exp_f32 v24, v24
    v_mfma_f32_16x16x32_bf16 a[112:115], a[240:243], v[40:43], a[112:115]
    v_exp_f32 v25, v25
    v_mfma_f32_16x16x32_bf16 a[116:119], a[244:247], v[40:43], a[116:119]
    v_add_f32 v117, v117, v24
    v_add_f32 v117, v117, v25
    v_mfma_f32_16x16x32_bf16 a[120:123], a[248:251], v[40:43], a[120:123]
    v_exp_f32 v26, v26
    v_mfma_f32_16x16x32_bf16 a[124:127], a[252:255], v[40:43], a[124:127]
    v_exp_f32 v27, v27
    v_mfma_f32_16x16x32_bf16 v[32:35], a[192:195], v[224:227], 0
    v_cvt_pk_bf16_f32 v24, v24, v25
    v_add_f32 v117, v117, v26
    v_mfma_f32_16x16x32_bf16 v[32:35], a[196:199], v[228:231], v[32:35]
    v_exp_f32 v28, v28
    v_mfma_f32_16x16x32_bf16 v[32:35], a[200:203], v[232:235], v[32:35]
    v_add_f32 v117, v117, v27
    v_cvt_pk_bf16_f32 v25, v26, v27
    v_mfma_f32_16x16x32_bf16 v[32:35], a[204:207], v[236:239], v[32:35]
    v_exp_f32 v29, v29
    v_mfma_f32_16x16x32_bf16 v[36:39], a[220:223], v[236:239], 0
    v_add_f32 v117, v117, v28
    v_add_f32 v117, v117, v29
    v_mfma_f32_16x16x32_bf16 v[36:39], a[216:219], v[232:235], v[36:39]
    v_exp_f32 v30, v30
    v_mfma_f32_16x16x32_bf16 v[36:39], a[212:215], v[228:231], v[36:39]
    v_exp_f32 v31, v31
    v_mfma_f32_16x16x32_bf16 v[36:39], a[208:211], v[224:227], v[36:39]
    v_cvt_pk_bf16_f32 v26, v28, v29
    v_add_f32 v117, v117, v30
    v_mfma_f32_16x16x32_bf16 a[128:131], a[224:227], v[16:19], a[128:131]
    v_add_f32 v117, v117, v31
    v_cvt_pk_bf16_f32 v27, v30, v31
    v_mfma_f32_16x16x32_bf16 a[132:135], a[228:231], v[16:19], a[132:135]
    v_exp_f32 v32, v32
    v_mfma_f32_16x16x32_bf16 a[136:139], a[232:235], v[16:19], a[136:139]
    v_exp_f32 v33, v33
    v_mfma_f32_16x16x32_bf16 a[140:143], a[236:239], v[16:19], a[140:143]
    v_add_f32 v118, v118, v32
    v_add_f32 v118, v118, v33
    v_mfma_f32_16x16x32_bf16 a[144:147], a[240:243], v[16:19], a[144:147]
    v_exp_f32 v34, v34
    v_mfma_f32_16x16x32_bf16 a[148:151], a[244:247], v[16:19], a[148:151]
    v_exp_f32 v35, v35
    v_mfma_f32_16x16x32_bf16 a[152:155], a[248:251], v[16:19], a[152:155]
    v_cvt_pk_bf16_f32 v32, v32, v33
    v_add_f32 v118, v118, v34
    v_mfma_f32_16x16x32_bf16 a[156:159], a[252:255], v[16:19], a[156:159]
    v_exp_f32 v36, v36
    v_mfma_f32_16x16x32_bf16 v[40:43], a[192:195], v[240:243], v[124:127]
    v_add_f32 v118, v118, v35
    v_cvt_pk_bf16_f32 v33, v34, v35
    v_mfma_f32_16x16x32_bf16 v[40:43], a[196:199], v[244:247], v[40:43]
    ds_read_b128 a[192:195], v1 offset:24576
    ds_read_b128 a[196:199], v1 offset:25088
    v_mfma_f32_16x16x32_bf16 v[40:43], a[200:203], v[248:251], v[40:43]
    v_exp_f32 v37, v37
    v_mfma_f32_16x16x32_bf16 v[40:43], a[204:207], v[252:255], v[40:43]
    v_add_f32 v118, v118, v36
    v_add_f32 v118, v118, v37
    v_mfma_f32_16x16x32_bf16 v[44:47], a[220:223], v[252:255], v[124:127]
    v_exp_f32 v38, v38
    v_mfma_f32_16x16x32_bf16 v[44:47], a[216:219], v[248:251], v[44:47]
    ds_read_b128 a[200:203], v1 offset:25600
    ds_read_b128 a[204:207], v1 offset:26112
    v_mfma_f32_16x16x32_bf16 v[44:47], a[212:215], v[244:247], v[44:47]
    v_exp_f32 v39, v39
    v_mfma_f32_16x16x32_bf16 v[44:47], a[208:211], v[240:243], v[44:47]
    v_cvt_pk_bf16_f32 v34, v36, v37
    v_add_f32 v118, v118, v38
    v_mfma_f32_16x16x32_bf16 a[160:163], a[224:227], v[24:27], a[160:163]
    v_add_f32 v118, v118, v39
    v_cvt_pk_bf16_f32 v35, v38, v39
    v_mfma_f32_16x16x32_bf16 a[164:167], a[228:231], v[24:27], a[164:167]
    ds_read_b128 a[220:223], v1 offset:30208
    ds_read_b128 a[216:219], v1 offset:29696
    v_mfma_f32_16x16x32_bf16 a[168:171], a[232:235], v[24:27], a[168:171]
    v_exp_f32 v40, v40
    v_mfma_f32_16x16x32_bf16 a[172:175], a[236:239], v[24:27], a[172:175]
    v_exp_f32 v41, v41
    v_mfma_f32_16x16x32_bf16 a[176:179], a[240:243], v[24:27], a[176:179]
    v_add_f32 v119, v119, v40
    v_add_f32 v119, v119, v41
    v_mfma_f32_16x16x32_bf16 a[180:183], a[244:247], v[24:27], a[180:183]
    ds_read_b128 a[212:215], v1 offset:29184
    ds_read_b128 a[208:211], v1 offset:28672
    v_mfma_f32_16x16x32_bf16 a[184:187], a[248:251], v[24:27], a[184:187]
    v_exp_f32 v42, v42
    v_mfma_f32_16x16x32_bf16 a[188:191], a[252:255], v[24:27], a[188:191]
    s_waitcnt lgkmcnt(7)
    v_exp_f32 v43, v43
    v_mfma_f32_16x16x32_bf16 v[16:19], a[192:195], v[128:131], 0
    s_waitcnt lgkmcnt(6)
    v_cvt_pk_bf16_f32 v40, v40, v41
    v_add_f32 v119, v119, v42
    v_mfma_f32_16x16x32_bf16 v[16:19], a[196:199], v[132:135], v[16:19]
    s_waitcnt lgkmcnt(5)
    v_exp_f32 v44, v44
    v_mfma_f32_16x16x32_bf16 v[16:19], a[200:203], v[136:139], v[16:19]
    s_waitcnt lgkmcnt(4)
    v_add_f32 v119, v119, v43
    v_cvt_pk_bf16_f32 v41, v42, v43
    v_mfma_f32_16x16x32_bf16 v[16:19], a[204:207], v[140:143], v[16:19]
    s_waitcnt lgkmcnt(3)
    v_exp_f32 v45, v45
    v_mfma_f32_16x16x32_bf16 v[20:23], a[220:223], v[140:143], 0
    s_waitcnt lgkmcnt(2)
    v_add_f32 v119, v119, v44
    v_add_f32 v119, v119, v45
    v_mfma_f32_16x16x32_bf16 v[20:23], a[216:219], v[136:139], v[20:23]
    s_waitcnt lgkmcnt(1)
    v_exp_f32 v46, v46
    v_mfma_f32_16x16x32_bf16 v[20:23], a[212:215], v[132:135], v[20:23]
    s_waitcnt lgkmcnt(0)
    v_exp_f32 v47, v47
    v_mfma_f32_16x16x32_bf16 v[20:23], a[208:211], v[128:131], v[20:23]
    v_cvt_pk_bf16_f32 v42, v44, v45
    v_add_f32 v119, v119, v46
    v_mfma_f32_16x16x32_bf16 v[48:51], a[224:227], v[32:35], v[48:51]
    v_add_f32 v119, v119, v47
    v_cvt_pk_bf16_f32 v43, v46, v47
    v_mfma_f32_16x16x32_bf16 v[52:55], a[228:231], v[32:35], v[52:55]
    v_exp_f32 v16, v16
    v_mfma_f32_16x16x32_bf16 v[56:59], a[232:235], v[32:35], v[56:59]
    v_exp_f32 v17, v17
    v_mfma_f32_16x16x32_bf16 v[60:63], a[236:239], v[32:35], v[60:63]
    v_add_f32 v112, v112, v16
    v_add_f32 v112, v112, v17
    v_mfma_f32_16x16x32_bf16 v[64:67], a[240:243], v[32:35], v[64:67]
    v_exp_f32 v18, v18
    v_mfma_f32_16x16x32_bf16 v[68:71], a[244:247], v[32:35], v[68:71]
    v_exp_f32 v19, v19
    v_mfma_f32_16x16x32_bf16 v[72:75], a[248:251], v[32:35], v[72:75]
    v_cvt_pk_bf16_f32 v16, v16, v17
    v_add_f32 v112, v112, v18
    v_mfma_f32_16x16x32_bf16 v[76:79], a[252:255], v[32:35], v[76:79]
    v_exp_f32 v20, v20
    v_mfma_f32_16x16x32_bf16 v[24:27], a[192:195], v[144:147], 0
    v_add_f32 v112, v112, v19
    v_cvt_pk_bf16_f32 v17, v18, v19
    v_mfma_f32_16x16x32_bf16 v[24:27], a[196:199], v[148:151], v[24:27]
    v_exp_f32 v21, v21
    v_mfma_f32_16x16x32_bf16 v[24:27], a[200:203], v[152:155], v[24:27]
    v_add_f32 v112, v112, v20
    v_add_f32 v112, v112, v21
    v_mfma_f32_16x16x32_bf16 v[24:27], a[204:207], v[156:159], v[24:27]
    v_exp_f32 v22, v22
    v_mfma_f32_16x16x32_bf16 v[28:31], a[220:223], v[156:159], 0
    v_exp_f32 v23, v23
    v_mfma_f32_16x16x32_bf16 v[28:31], a[216:219], v[152:155], v[28:31]
    v_cvt_pk_bf16_f32 v18, v20, v21
    v_add_f32 v112, v112, v22
    v_mfma_f32_16x16x32_bf16 v[28:31], a[212:215], v[148:151], v[28:31]
    v_add_f32 v112, v112, v23
    v_cvt_pk_bf16_f32 v19, v22, v23
    v_mfma_f32_16x16x32_bf16 v[28:31], a[208:211], v[144:147], v[28:31]
    v_exp_f32 v24, v24
    v_mfma_f32_16x16x32_bf16 v[80:83], a[224:227], v[40:43], v[80:83]
    ds_read_b64_tr_b16 a[224:225], v2 offset:24576
    ds_read_b64_tr_b16 a[226:227], v2 offset:28672
    v_mfma_f32_16x16x32_bf16 v[84:87], a[228:231], v[40:43], v[84:87]
    v_exp_f32 v25, v25
    v_mfma_f32_16x16x32_bf16 v[88:91], a[232:235], v[40:43], v[88:91]
    ds_read_b64_tr_b16 a[228:229], v2 offset:24832
    ds_read_b64_tr_b16 a[230:231], v2 offset:28928
    v_mfma_f32_16x16x32_bf16 v[92:95], a[236:239], v[40:43], v[92:95]
    v_add_f32 v113, v113, v24
    v_add_f32 v113, v113, v25
    v_mfma_f32_16x16x32_bf16 v[96:99], a[240:243], v[40:43], v[96:99]
    ds_read_b64_tr_b16 a[232:233], v2 offset:25088
    ds_read_b64_tr_b16 a[234:235], v2 offset:29184
    v_mfma_f32_16x16x32_bf16 v[100:103], a[244:247], v[40:43], v[100:103]
    v_exp_f32 v26, v26
    v_mfma_f32_16x16x32_bf16 v[104:107], a[248:251], v[40:43], v[104:107]
    ds_read_b64_tr_b16 a[236:237], v2 offset:25344
    ds_read_b64_tr_b16 a[238:239], v2 offset:29440
    v_mfma_f32_16x16x32_bf16 v[108:111], a[252:255], v[40:43], v[108:111]
    v_exp_f32 v27, v27
    v_mfma_f32_16x16x32_bf16 v[32:35], a[192:195], v[160:163], 0
    ds_read_b64_tr_b16 a[240:241], v2 offset:25600
    ds_read_b64_tr_b16 a[242:243], v2 offset:29696
    v_mfma_f32_16x16x32_bf16 v[32:35], a[196:199], v[164:167], v[32:35]
    v_cvt_pk_bf16_f32 v24, v24, v25
    v_add_f32 v113, v113, v26
    v_mfma_f32_16x16x32_bf16 v[32:35], a[200:203], v[168:171], v[32:35]
    ds_read_b64_tr_b16 a[244:245], v2 offset:25856
    ds_read_b64_tr_b16 a[246:247], v2 offset:29952
    v_mfma_f32_16x16x32_bf16 v[32:35], a[204:207], v[172:175], v[32:35]
    v_exp_f32 v28, v28
    v_mfma_f32_16x16x32_bf16 v[36:39], a[220:223], v[172:175], 0
    ds_read_b64_tr_b16 a[248:249], v2 offset:26112
    ds_read_b64_tr_b16 a[250:251], v2 offset:30208
    v_mfma_f32_16x16x32_bf16 v[36:39], a[216:219], v[168:171], v[36:39]
    v_add_f32 v113, v113, v27
    v_cvt_pk_bf16_f32 v25, v26, v27
    v_mfma_f32_16x16x32_bf16 v[36:39], a[212:215], v[164:167], v[36:39]
    ds_read_b64_tr_b16 a[252:253], v2 offset:26368
    ds_read_b64_tr_b16 a[254:255], v2 offset:30464
    v_mfma_f32_16x16x32_bf16 v[36:39], a[208:211], v[160:163], v[36:39]
    s_waitcnt lgkmcnt(14)
    v_exp_f32 v29, v29
    v_mfma_f32_16x16x32_bf16 a[0:3], a[224:227], v[16:19], a[0:3]
    s_waitcnt lgkmcnt(12)
    v_add_f32 v113, v113, v28
    v_add_f32 v113, v113, v29
    v_mfma_f32_16x16x32_bf16 a[4:7], a[228:231], v[16:19], a[4:7]
    s_waitcnt lgkmcnt(10)
    v_exp_f32 v30, v30
    v_mfma_f32_16x16x32_bf16 a[8:11], a[232:235], v[16:19], a[8:11]
    s_waitcnt lgkmcnt(8)
    v_exp_f32 v31, v31
    v_mfma_f32_16x16x32_bf16 a[12:15], a[236:239], v[16:19], a[12:15]
    s_waitcnt lgkmcnt(6)
    v_cvt_pk_bf16_f32 v26, v28, v29
    v_add_f32 v113, v113, v30
    v_mfma_f32_16x16x32_bf16 a[16:19], a[240:243], v[16:19], a[16:19]
    s_waitcnt lgkmcnt(4)
    v_add_f32 v113, v113, v31
    v_cvt_pk_bf16_f32 v27, v30, v31
    v_mfma_f32_16x16x32_bf16 a[20:23], a[244:247], v[16:19], a[20:23]
    s_waitcnt lgkmcnt(2)
    v_exp_f32 v32, v32
    v_mfma_f32_16x16x32_bf16 a[24:27], a[248:251], v[16:19], a[24:27]
    s_waitcnt lgkmcnt(0)
    v_exp_f32 v33, v33
    v_mfma_f32_16x16x32_bf16 a[28:31], a[252:255], v[16:19], a[28:31]
    v_add_f32 v114, v114, v32
    v_add_f32 v114, v114, v33
    v_mfma_f32_16x16x32_bf16 v[40:43], a[192:195], v[176:179], 0
    s_waitcnt vmcnt(8)
    v_exp_f32 v34, v34
    v_mfma_f32_16x16x32_bf16 v[40:43], a[196:199], v[180:183], v[40:43]
    s_barrier
    v_exp_f32 v35, v35
    v_mfma_f32_16x16x32_bf16 v[40:43], a[200:203], v[184:187], v[40:43]
    v_cvt_pk_bf16_f32 v32, v32, v33
    v_add_f32 v114, v114, v34
    v_mfma_f32_16x16x32_bf16 v[40:43], a[204:207], v[188:191], v[40:43]
    s_add_u32 m0, s26, 57344
    v_exp_f32 v36, v36
    v_mfma_f32_16x16x32_bf16 v[44:47], a[220:223], v[188:191], 0
    buffer_load_dwordx4 v3, s[12:15], s25 offen nt lds
    v_mfma_f32_16x16x32_bf16 v[44:47], a[216:219], v[184:187], v[44:47]
    v_add_f32 v114, v114, v35
    v_cvt_pk_bf16_f32 v33, v34, v35
    v_mfma_f32_16x16x32_bf16 v[44:47], a[212:215], v[180:183], v[44:47]
    s_add_u32 m0, s26, 58240
    v_exp_f32 v37, v37
    v_mfma_f32_16x16x32_bf16 v[44:47], a[208:211], v[176:179], v[44:47]
    buffer_load_dwordx4 v3, s[12:15], s25 offen offset:128 nt lds
    v_mfma_f32_16x16x32_bf16 a[32:35], a[224:227], v[24:27], a[32:35]
    v_add_f32 v114, v114, v36
    v_add_f32 v114, v114, v37
    v_mfma_f32_16x16x32_bf16 a[36:39], a[228:231], v[24:27], a[36:39]
    s_add_u32 m0, s26, 122880
    v_exp_f32 v38, v38
    v_mfma_f32_16x16x32_bf16 a[40:43], a[232:235], v[24:27], a[40:43]
    buffer_load_dwordx4 v4, s[16:19], s25 offen nt lds
    v_mfma_f32_16x16x32_bf16 a[44:47], a[236:239], v[24:27], a[44:47]
    v_exp_f32 v39, v39
    v_mfma_f32_16x16x32_bf16 a[48:51], a[240:243], v[24:27], a[48:51]
    s_add_u32 m0, s26, 123776
    v_cvt_pk_bf16_f32 v34, v36, v37
    v_add_f32 v114, v114, v38
    v_mfma_f32_16x16x32_bf16 a[52:55], a[244:247], v[24:27], a[52:55]
    buffer_load_dwordx4 v4, s[16:19], s25 offen offset:128 nt lds
    v_mfma_f32_16x16x32_bf16 a[56:59], a[248:251], v[24:27], a[56:59]
    s_add_u32 s25, s25, 8192
    v_add_f32 v114, v114, v39
    v_cvt_pk_bf16_f32 v35, v38, v39
    v_mfma_f32_16x16x32_bf16 a[60:63], a[252:255], v[24:27], a[60:63]
    v_exp_f32 v40, v40
    v_mfma_f32_16x16x32_bf16 v[16:19], a[192:195], v[192:195], 0
    v_exp_f32 v41, v41
    v_mfma_f32_16x16x32_bf16 v[16:19], a[196:199], v[196:199], v[16:19]
    v_add_f32 v115, v115, v40
    v_add_f32 v115, v115, v41
    v_mfma_f32_16x16x32_bf16 v[16:19], a[200:203], v[200:203], v[16:19]
    v_exp_f32 v42, v42
    v_mfma_f32_16x16x32_bf16 v[16:19], a[204:207], v[204:207], v[16:19]
    v_exp_f32 v43, v43
    v_mfma_f32_16x16x32_bf16 v[20:23], a[220:223], v[204:207], 0
    v_cvt_pk_bf16_f32 v40, v40, v41
    v_add_f32 v115, v115, v42
    v_mfma_f32_16x16x32_bf16 v[20:23], a[216:219], v[200:203], v[20:23]
    v_exp_f32 v44, v44
    v_mfma_f32_16x16x32_bf16 v[20:23], a[212:215], v[196:199], v[20:23]
    v_add_f32 v115, v115, v43
    v_cvt_pk_bf16_f32 v41, v42, v43
    v_mfma_f32_16x16x32_bf16 v[20:23], a[208:211], v[192:195], v[20:23]
    v_exp_f32 v45, v45
    v_mfma_f32_16x16x32_bf16 a[64:67], a[224:227], v[32:35], a[64:67]
    v_add_f32 v115, v115, v44
    v_add_f32 v115, v115, v45
    v_mfma_f32_16x16x32_bf16 a[68:71], a[228:231], v[32:35], a[68:71]
    v_exp_f32 v46, v46
    v_mfma_f32_16x16x32_bf16 a[72:75], a[232:235], v[32:35], a[72:75]
    v_exp_f32 v47, v47
    v_mfma_f32_16x16x32_bf16 a[76:79], a[236:239], v[32:35], a[76:79]
    v_cvt_pk_bf16_f32 v42, v44, v45
    v_add_f32 v115, v115, v46
    v_mfma_f32_16x16x32_bf16 a[80:83], a[240:243], v[32:35], a[80:83]
    v_add_f32 v115, v115, v47
    v_cvt_pk_bf16_f32 v43, v46, v47
    v_mfma_f32_16x16x32_bf16 a[84:87], a[244:247], v[32:35], a[84:87]
    v_exp_f32 v16, v16
    v_mfma_f32_16x16x32_bf16 a[88:91], a[248:251], v[32:35], a[88:91]
    v_exp_f32 v17, v17
    v_mfma_f32_16x16x32_bf16 a[92:95], a[252:255], v[32:35], a[92:95]
    v_add_f32 v116, v116, v16
    v_add_f32 v116, v116, v17
    v_mfma_f32_16x16x32_bf16 v[24:27], a[192:195], v[208:211], 0
    v_exp_f32 v18, v18
    v_mfma_f32_16x16x32_bf16 v[24:27], a[196:199], v[212:215], v[24:27]
    v_exp_f32 v19, v19
    v_mfma_f32_16x16x32_bf16 v[24:27], a[200:203], v[216:219], v[24:27]
    v_cvt_pk_bf16_f32 v16, v16, v17
    v_add_f32 v116, v116, v18
    v_mfma_f32_16x16x32_bf16 v[24:27], a[204:207], v[220:223], v[24:27]
    v_exp_f32 v20, v20
    v_mfma_f32_16x16x32_bf16 v[28:31], a[220:223], v[220:223], 0
    v_add_f32 v116, v116, v19
    v_cvt_pk_bf16_f32 v17, v18, v19
    v_mfma_f32_16x16x32_bf16 v[28:31], a[216:219], v[216:219], v[28:31]
    v_exp_f32 v21, v21
    v_mfma_f32_16x16x32_bf16 v[28:31], a[212:215], v[212:215], v[28:31]
    v_add_f32 v116, v116, v20
    v_add_f32 v116, v116, v21
    v_mfma_f32_16x16x32_bf16 v[28:31], a[208:211], v[208:211], v[28:31]
    v_exp_f32 v22, v22
    v_mfma_f32_16x16x32_bf16 a[96:99], a[224:227], v[40:43], a[96:99]
    v_exp_f32 v23, v23
    v_mfma_f32_16x16x32_bf16 a[100:103], a[228:231], v[40:43], a[100:103]
    v_cvt_pk_bf16_f32 v18, v20, v21
    v_add_f32 v116, v116, v22
    v_mfma_f32_16x16x32_bf16 a[104:107], a[232:235], v[40:43], a[104:107]
    v_add_f32 v116, v116, v23
    v_cvt_pk_bf16_f32 v19, v22, v23
    v_mfma_f32_16x16x32_bf16 a[108:111], a[236:239], v[40:43], a[108:111]
    v_exp_f32 v24, v24
    v_mfma_f32_16x16x32_bf16 a[112:115], a[240:243], v[40:43], a[112:115]
    v_exp_f32 v25, v25
    v_mfma_f32_16x16x32_bf16 a[116:119], a[244:247], v[40:43], a[116:119]
    v_add_f32 v117, v117, v24
    v_add_f32 v117, v117, v25
    v_mfma_f32_16x16x32_bf16 a[120:123], a[248:251], v[40:43], a[120:123]
    v_exp_f32 v26, v26
    v_mfma_f32_16x16x32_bf16 a[124:127], a[252:255], v[40:43], a[124:127]
    v_exp_f32 v27, v27
    v_mfma_f32_16x16x32_bf16 v[32:35], a[192:195], v[224:227], 0
    v_cvt_pk_bf16_f32 v24, v24, v25
    v_add_f32 v117, v117, v26
    v_mfma_f32_16x16x32_bf16 v[32:35], a[196:199], v[228:231], v[32:35]
    v_exp_f32 v28, v28
    v_mfma_f32_16x16x32_bf16 v[32:35], a[200:203], v[232:235], v[32:35]
    v_add_f32 v117, v117, v27
    v_cvt_pk_bf16_f32 v25, v26, v27
    v_mfma_f32_16x16x32_bf16 v[32:35], a[204:207], v[236:239], v[32:35]
    v_exp_f32 v29, v29
    v_mfma_f32_16x16x32_bf16 v[36:39], a[220:223], v[236:239], 0
    v_add_f32 v117, v117, v28
    v_add_f32 v117, v117, v29
    v_mfma_f32_16x16x32_bf16 v[36:39], a[216:219], v[232:235], v[36:39]
    v_exp_f32 v30, v30
    v_mfma_f32_16x16x32_bf16 v[36:39], a[212:215], v[228:231], v[36:39]
    v_exp_f32 v31, v31
    v_mfma_f32_16x16x32_bf16 v[36:39], a[208:211], v[224:227], v[36:39]
    v_cvt_pk_bf16_f32 v26, v28, v29
    v_add_f32 v117, v117, v30
    v_mfma_f32_16x16x32_bf16 a[128:131], a[224:227], v[16:19], a[128:131]
    v_add_f32 v117, v117, v31
    v_cvt_pk_bf16_f32 v27, v30, v31
    v_mfma_f32_16x16x32_bf16 a[132:135], a[228:231], v[16:19], a[132:135]
    v_exp_f32 v32, v32
    v_mfma_f32_16x16x32_bf16 a[136:139], a[232:235], v[16:19], a[136:139]
    v_exp_f32 v33, v33
    v_mfma_f32_16x16x32_bf16 a[140:143], a[236:239], v[16:19], a[140:143]
    v_add_f32 v118, v118, v32
    v_add_f32 v118, v118, v33
    v_mfma_f32_16x16x32_bf16 a[144:147], a[240:243], v[16:19], a[144:147]
    v_exp_f32 v34, v34
    v_mfma_f32_16x16x32_bf16 a[148:151], a[244:247], v[16:19], a[148:151]
    v_exp_f32 v35, v35
    v_mfma_f32_16x16x32_bf16 a[152:155], a[248:251], v[16:19], a[152:155]
    v_cvt_pk_bf16_f32 v32, v32, v33
    v_add_f32 v118, v118, v34
    v_mfma_f32_16x16x32_bf16 a[156:159], a[252:255], v[16:19], a[156:159]
    v_exp_f32 v36, v36
    v_mfma_f32_16x16x32_bf16 v[40:43], a[192:195], v[240:243], v[124:127]
    v_add_f32 v118, v118, v35
    v_cvt_pk_bf16_f32 v33, v34, v35
    v_mfma_f32_16x16x32_bf16 v[40:43], a[196:199], v[244:247], v[40:43]
    ds_read_b128 a[192:195], v1 offset:32768
    ds_read_b128 a[196:199], v1 offset:33280
    v_mfma_f32_16x16x32_bf16 v[40:43], a[200:203], v[248:251], v[40:43]
    v_exp_f32 v37, v37
    v_mfma_f32_16x16x32_bf16 v[40:43], a[204:207], v[252:255], v[40:43]
    v_add_f32 v118, v118, v36
    v_add_f32 v118, v118, v37
    v_mfma_f32_16x16x32_bf16 v[44:47], a[220:223], v[252:255], v[124:127]
    v_exp_f32 v38, v38
    v_mfma_f32_16x16x32_bf16 v[44:47], a[216:219], v[248:251], v[44:47]
    ds_read_b128 a[200:203], v1 offset:33792
    ds_read_b128 a[204:207], v1 offset:34304
    v_mfma_f32_16x16x32_bf16 v[44:47], a[212:215], v[244:247], v[44:47]
    v_exp_f32 v39, v39
    v_mfma_f32_16x16x32_bf16 v[44:47], a[208:211], v[240:243], v[44:47]
    v_cvt_pk_bf16_f32 v34, v36, v37
    v_add_f32 v118, v118, v38
    v_mfma_f32_16x16x32_bf16 a[160:163], a[224:227], v[24:27], a[160:163]
    v_add_f32 v118, v118, v39
    v_cvt_pk_bf16_f32 v35, v38, v39
    v_mfma_f32_16x16x32_bf16 a[164:167], a[228:231], v[24:27], a[164:167]
    ds_read_b128 a[220:223], v1 offset:38400
    ds_read_b128 a[216:219], v1 offset:37888
    v_mfma_f32_16x16x32_bf16 a[168:171], a[232:235], v[24:27], a[168:171]
    v_exp_f32 v40, v40
    v_mfma_f32_16x16x32_bf16 a[172:175], a[236:239], v[24:27], a[172:175]
    v_exp_f32 v41, v41
    v_mfma_f32_16x16x32_bf16 a[176:179], a[240:243], v[24:27], a[176:179]
    v_add_f32 v119, v119, v40
    v_add_f32 v119, v119, v41
    v_mfma_f32_16x16x32_bf16 a[180:183], a[244:247], v[24:27], a[180:183]
    ds_read_b128 a[212:215], v1 offset:37376
    ds_read_b128 a[208:211], v1 offset:36864
    v_mfma_f32_16x16x32_bf16 a[184:187], a[248:251], v[24:27], a[184:187]
    v_exp_f32 v42, v42
    v_mfma_f32_16x16x32_bf16 a[188:191], a[252:255], v[24:27], a[188:191]
    s_waitcnt lgkmcnt(7)
    v_exp_f32 v43, v43
    v_mfma_f32_16x16x32_bf16 v[16:19], a[192:195], v[128:131], 0
    s_waitcnt lgkmcnt(6)
    v_cvt_pk_bf16_f32 v40, v40, v41
    v_add_f32 v119, v119, v42
    v_mfma_f32_16x16x32_bf16 v[16:19], a[196:199], v[132:135], v[16:19]
    s_waitcnt lgkmcnt(5)
    v_exp_f32 v44, v44
    v_mfma_f32_16x16x32_bf16 v[16:19], a[200:203], v[136:139], v[16:19]
    s_waitcnt lgkmcnt(4)
    v_add_f32 v119, v119, v43
    v_cvt_pk_bf16_f32 v41, v42, v43
    v_mfma_f32_16x16x32_bf16 v[16:19], a[204:207], v[140:143], v[16:19]
    s_waitcnt lgkmcnt(3)
    v_exp_f32 v45, v45
    v_mfma_f32_16x16x32_bf16 v[20:23], a[220:223], v[140:143], 0
    s_waitcnt lgkmcnt(2)
    v_add_f32 v119, v119, v44
    v_add_f32 v119, v119, v45
    v_mfma_f32_16x16x32_bf16 v[20:23], a[216:219], v[136:139], v[20:23]
    s_waitcnt lgkmcnt(1)
    v_exp_f32 v46, v46
    v_mfma_f32_16x16x32_bf16 v[20:23], a[212:215], v[132:135], v[20:23]
    s_waitcnt lgkmcnt(0)
    v_exp_f32 v47, v47
    v_mfma_f32_16x16x32_bf16 v[20:23], a[208:211], v[128:131], v[20:23]
    v_cvt_pk_bf16_f32 v42, v44, v45
    v_add_f32 v119, v119, v46
    v_mfma_f32_16x16x32_bf16 v[48:51], a[224:227], v[32:35], v[48:51]
    v_add_f32 v119, v119, v47
    v_cvt_pk_bf16_f32 v43, v46, v47
    v_mfma_f32_16x16x32_bf16 v[52:55], a[228:231], v[32:35], v[52:55]
    v_exp_f32 v16, v16
    v_mfma_f32_16x16x32_bf16 v[56:59], a[232:235], v[32:35], v[56:59]
    v_exp_f32 v17, v17
    v_mfma_f32_16x16x32_bf16 v[60:63], a[236:239], v[32:35], v[60:63]
    v_add_f32 v112, v112, v16
    v_add_f32 v112, v112, v17
    v_mfma_f32_16x16x32_bf16 v[64:67], a[240:243], v[32:35], v[64:67]
    v_exp_f32 v18, v18
    v_mfma_f32_16x16x32_bf16 v[68:71], a[244:247], v[32:35], v[68:71]
    v_exp_f32 v19, v19
    v_mfma_f32_16x16x32_bf16 v[72:75], a[248:251], v[32:35], v[72:75]
    v_cvt_pk_bf16_f32 v16, v16, v17
    v_add_f32 v112, v112, v18
    v_mfma_f32_16x16x32_bf16 v[76:79], a[252:255], v[32:35], v[76:79]
    v_exp_f32 v20, v20
    v_mfma_f32_16x16x32_bf16 v[24:27], a[192:195], v[144:147], 0
    v_add_f32 v112, v112, v19
    v_cvt_pk_bf16_f32 v17, v18, v19
    v_mfma_f32_16x16x32_bf16 v[24:27], a[196:199], v[148:151], v[24:27]
    v_exp_f32 v21, v21
    v_mfma_f32_16x16x32_bf16 v[24:27], a[200:203], v[152:155], v[24:27]
    v_add_f32 v112, v112, v20
    v_add_f32 v112, v112, v21
    v_mfma_f32_16x16x32_bf16 v[24:27], a[204:207], v[156:159], v[24:27]
    v_exp_f32 v22, v22
    v_mfma_f32_16x16x32_bf16 v[28:31], a[220:223], v[156:159], 0
    v_exp_f32 v23, v23
    v_mfma_f32_16x16x32_bf16 v[28:31], a[216:219], v[152:155], v[28:31]
    v_cvt_pk_bf16_f32 v18, v20, v21
    v_add_f32 v112, v112, v22
    v_mfma_f32_16x16x32_bf16 v[28:31], a[212:215], v[148:151], v[28:31]
    v_add_f32 v112, v112, v23
    v_cvt_pk_bf16_f32 v19, v22, v23
    v_mfma_f32_16x16x32_bf16 v[28:31], a[208:211], v[144:147], v[28:31]
    v_exp_f32 v24, v24
    v_mfma_f32_16x16x32_bf16 v[80:83], a[224:227], v[40:43], v[80:83]
    ds_read_b64_tr_b16 a[224:225], v2 offset:32768
    ds_read_b64_tr_b16 a[226:227], v2 offset:36864
    v_mfma_f32_16x16x32_bf16 v[84:87], a[228:231], v[40:43], v[84:87]
    v_exp_f32 v25, v25
    v_mfma_f32_16x16x32_bf16 v[88:91], a[232:235], v[40:43], v[88:91]
    ds_read_b64_tr_b16 a[228:229], v2 offset:33024
    ds_read_b64_tr_b16 a[230:231], v2 offset:37120
    v_mfma_f32_16x16x32_bf16 v[92:95], a[236:239], v[40:43], v[92:95]
    v_add_f32 v113, v113, v24
    v_add_f32 v113, v113, v25
    v_mfma_f32_16x16x32_bf16 v[96:99], a[240:243], v[40:43], v[96:99]
    ds_read_b64_tr_b16 a[232:233], v2 offset:33280
    ds_read_b64_tr_b16 a[234:235], v2 offset:37376
    v_mfma_f32_16x16x32_bf16 v[100:103], a[244:247], v[40:43], v[100:103]
    v_exp_f32 v26, v26
    v_mfma_f32_16x16x32_bf16 v[104:107], a[248:251], v[40:43], v[104:107]
    ds_read_b64_tr_b16 a[236:237], v2 offset:33536
    ds_read_b64_tr_b16 a[238:239], v2 offset:37632
    v_mfma_f32_16x16x32_bf16 v[108:111], a[252:255], v[40:43], v[108:111]
    v_exp_f32 v27, v27
    s_sub_u32 s27, s27, 1
    s_cmp_lg_u32 s27, 0
    s_cbranch_scc1 L_loop
    v_mfma_f32_16x16x32_bf16 v[32:35], a[192:195], v[160:163], 0
    ds_read_b64_tr_b16 a[240:241], v2 offset:33792
    ds_read_b64_tr_b16 a[242:243], v2 offset:37888
    v_mfma_f32_16x16x32_bf16 v[32:35], a[196:199], v[164:167], v[32:35]
    v_cvt_pk_bf16_f32 v24, v24, v25
    v_add_f32 v113, v113, v26
    v_mfma_f32_16x16x32_bf16 v[32:35], a[200:203], v[168:171], v[32:35]
    ds_read_b64_tr_b16 a[244:245], v2 offset:34048
    ds_read_b64_tr_b16 a[246:247], v2 offset:38144
    v_mfma_f32_16x16x32_bf16 v[32:35], a[204:207], v[172:175], v[32:35]
    v_exp_f32 v28, v28
    v_mfma_f32_16x16x32_bf16 v[36:39], a[220:223], v[172:175], 0
    ds_read_b64_tr_b16 a[248:249], v2 offset:34304
    ds_read_b64_tr_b16 a[250:251], v2 offset:38400
    v_mfma_f32_16x16x32_bf16 v[36:39], a[216:219], v[168:171], v[36:39]
    v_add_f32 v113, v113, v27
    v_cvt_pk_bf16_f32 v25, v26, v27
    v_mfma_f32_16x16x32_bf16 v[36:39], a[212:215], v[164:167], v[36:39]
    ds_read_b64_tr_b16 a[252:253], v2 offset:34560
    ds_read_b64_tr_b16 a[254:255], v2 offset:38656
    v_mfma_f32_16x16x32_bf16 v[36:39], a[208:211], v[160:163], v[36:39]
    s_waitcnt lgkmcnt(14)
    v_exp_f32 v29, v29
    v_mfma_f32_16x16x32_bf16 a[0:3], a[224:227], v[16:19], a[0:3]
    s_waitcnt lgkmcnt(12)
    v_add_f32 v113, v113, v28
    v_add_f32 v113, v113, v29
    v_mfma_f32_16x16x32_bf16 a[4:7], a[228:231], v[16:19], a[4:7]
    s_waitcnt lgkmcnt(10)
    v_exp_f32 v30, v30
    v_mfma_f32_16x16x32_bf16 a[8:11], a[232:235], v[16:19], a[8:11]
    s_waitcnt lgkmcnt(8)
    v_exp_f32 v31, v31
    v_mfma_f32_16x16x32_bf16 a[12:15], a[236:239], v[16:19], a[12:15]
    s_waitcnt lgkmcnt(6)
    v_cvt_pk_bf16_f32 v26, v28, v29
    v_add_f32 v113, v113, v30
    v_mfma_f32_16x16x32_bf16 a[16:19], a[240:243], v[16:19], a[16:19]
    s_waitcnt lgkmcnt(4)
    v_add_f32 v113, v113, v31
    v_cvt_pk_bf16_f32 v27, v30, v31
    v_mfma_f32_16x16x32_bf16 a[20:23], a[244:247], v[16:19], a[20:23]
    s_waitcnt lgkmcnt(2)
    v_exp_f32 v32, v32
    v_mfma_f32_16x16x32_bf16 a[24:27], a[248:251], v[16:19], a[24:27]
    s_waitcnt lgkmcnt(0)
    v_exp_f32 v33, v33
    v_mfma_f32_16x16x32_bf16 a[28:31], a[252:255], v[16:19], a[28:31]
    v_add_f32 v114, v114, v32
    v_add_f32 v114, v114, v33
    v_mfma_f32_16x16x32_bf16 v[40:43], a[192:195], v[176:179], 0
    s_waitcnt vmcnt(8)
    v_exp_f32 v34, v34
    v_mfma_f32_16x16x32_bf16 v[40:43], a[196:199], v[180:183], v[40:43]
    s_barrier
    ds_read_b128 a[192:195], v1 offset:40960
    ds_read_b128 a[196:199], v1 offset:41472
    v_mfma_f32_16x16x32_bf16 v[40:43], a[200:203], v[184:187], v[40:43]
    v_exp_f32 v35, v35
    v_mfma_f32_16x16x32_bf16 v[40:43], a[204:207], v[188:191], v[40:43]
    v_cvt_pk_bf16_f32 v32, v32, v33
    v_add_f32 v114, v114, v34
    v_mfma_f32_16x16x32_bf16 v[44:47], a[220:223], v[188:191], 0
    v_exp_f32 v36, v36
    v_mfma_f32_16x16x32_bf16 v[44:47], a[216:219], v[184:187], v[44:47]
    ds_read_b128 a[200:203], v1 offset:41984
    ds_read_b128 a[204:207], v1 offset:42496
    v_mfma_f32_16x16x32_bf16 v[44:47], a[212:215], v[180:183], v[44:47]
    v_add_f32 v114, v114, v35
    v_cvt_pk_bf16_f32 v33, v34, v35
    v_mfma_f32_16x16x32_bf16 v[44:47], a[208:211], v[176:179], v[44:47]
    v_exp_f32 v37, v37
    v_mfma_f32_16x16x32_bf16 a[32:35], a[224:227], v[24:27], a[32:35]
    v_add_f32 v114, v114, v36
    v_add_f32 v114, v114, v37
    v_mfma_f32_16x16x32_bf16 a[36:39], a[228:231], v[24:27], a[36:39]
    ds_read_b128 a[220:223], v1 offset:46592
    ds_read_b128 a[216:219], v1 offset:46080
    v_mfma_f32_16x16x32_bf16 a[40:43], a[232:235], v[24:27], a[40:43]
    v_exp_f32 v38, v38
    v_mfma_f32_16x16x32_bf16 a[44:47], a[236:239], v[24:27], a[44:47]
    v_exp_f32 v39, v39
    v_mfma_f32_16x16x32_bf16 a[48:51], a[240:243], v[24:27], a[48:51]
    v_cvt_pk_bf16_f32 v34, v36, v37
    v_add_f32 v114, v114, v38
    v_mfma_f32_16x16x32_bf16 a[52:55], a[244:247], v[24:27], a[52:55]
    ds_read_b128 a[212:215], v1 offset:45568
    ds_read_b128 a[208:211], v1 offset:45056
    v_mfma_f32_16x16x32_bf16 a[56:59], a[248:251], v[24:27], a[56:59]
    v_add_f32 v114, v114, v39
    v_cvt_pk_bf16_f32 v35, v38, v39
    v_mfma_f32_16x16x32_bf16 a[60:63], a[252:255], v[24:27], a[60:63]
    s_waitcnt lgkmcnt(7)
    v_exp_f32 v40, v40
    v_mfma_f32_16x16x32_bf16 v[16:19], a[192:195], v[128:131], 0
    s_waitcnt lgkmcnt(6)
    v_exp_f32 v41, v41
    v_mfma_f32_16x16x32_bf16 v[16:19], a[196:199], v[132:135], v[16:19]
    s_waitcnt lgkmcnt(5)
    v_add_f32 v115, v115, v40
    v_add_f32 v115, v115, v41
    v_mfma_f32_16x16x32_bf16 v[16:19], a[200:203], v[136:139], v[16:19]
    s_waitcnt lgkmcnt(4)
    v_exp_f32 v42, v42
    v_mfma_f32_16x16x32_bf16 v[16:19], a[204:207], v[140:143], v[16:19]
    s_waitcnt lgkmcnt(3)
    v_exp_f32 v43, v43
    v_mfma_f32_16x16x32_bf16 v[20:23], a[220:223], v[140:143], 0
    s_waitcnt lgkmcnt(2)
    v_cvt_pk_bf16_f32 v40, v40, v41
    v_add_f32 v115, v115, v42
    v_mfma_f32_16x16x32_bf16 v[20:23], a[216:219], v[136:139], v[20:23]
    s_waitcnt lgkmcnt(1)
    v_exp_f32 v44, v44
    v_mfma_f32_16x16x32_bf16 v[20:23], a[212:215], v[132:135], v[20:23]
    s_waitcnt lgkmcnt(0)
    v_add_f32 v115, v115, v43
    v_cvt_pk_bf16_f32 v41, v42, v43
    v_mfma_f32_16x16x32_bf16 v[20:23], a[208:211], v[128:131], v[20:23]
    v_exp_f32 v45, v45
    v_mfma_f32_16x16x32_bf16 a[64:67], a[224:227], v[32:35], a[64:67]
    v_add_f32 v115, v115, v44
    v_add_f32 v115, v115, v45
    v_mfma_f32_16x16x32_bf16 a[68:71], a[228:231], v[32:35], a[68:71]
    v_exp_f32 v46, v46
    v_mfma_f32_16x16x32_bf16 a[72:75], a[232:235], v[32:35], a[72:75]
    v_exp_f32 v47, v47
    v_mfma_f32_16x16x32_bf16 a[76:79], a[236:239], v[32:35], a[76:79]
    v_cvt_pk_bf16_f32 v42, v44, v45
    v_add_f32 v115, v115, v46
    v_mfma_f32_16x16x32_bf16 a[80:83], a[240:243], v[32:35], a[80:83]
    v_add_f32 v115, v115, v47
    v_cvt_pk_bf16_f32 v43, v46, v47
    v_mfma_f32_16x16x32_bf16 a[84:87], a[244:247], v[32:35], a[84:87]
    v_exp_f32 v16, v16
    v_mfma_f32_16x16x32_bf16 a[88:91], a[248:251], v[32:35], a[88:91]
    v_exp_f32 v17, v17
    v_mfma_f32_16x16x32_bf16 a[92:95], a[252:255], v[32:35], a[92:95]
    v_add_f32 v112, v112, v16
    v_add_f32 v112, v112, v17
    v_mfma_f32_16x16x32_bf16 v[24:27], a[192:195], v[144:147], 0
    v_exp_f32 v18, v18
    v_mfma_f32_16x16x32_bf16 v[24:27], a[196:199], v[148:151], v[24:27]
    v_exp_f32 v19, v19
    v_mfma_f32_16x16x32_bf16 v[24:27], a[200:203], v[152:155], v[24:27]
    v_cvt_pk_bf16_f32 v16, v16, v17
    v_add_f32 v112, v112, v18
    v_mfma_f32_16x16x32_bf16 v[24:27], a[204:207], v[156:159], v[24:27]
    v_exp_f32 v20, v20
    v_mfma_f32_16x16x32_bf16 v[28:31], a[220:223], v[156:159], 0
    v_add_f32 v112, v112, v19
    v_cvt_pk_bf16_f32 v17, v18, v19
    v_mfma_f32_16x16x32_bf16 v[28:31], a[216:219], v[152:155], v[28:31]
    v_exp_f32 v21, v21
    v_mfma_f32_16x16x32_bf16 v[28:31], a[212:215], v[148:151], v[28:31]
    v_add_f32 v112, v112, v20
    v_add_f32 v112, v112, v21
    v_mfma_f32_16x16x32_bf16 v[28:31], a[208:211], v[144:147], v[28:31]
    v_exp_f32 v22, v22
    v_mfma_f32_16x16x32_bf16 a[96:99], a[224:227], v[40:43], a[96:99]
    ds_read_b64_tr_b16 a[224:225], v2 offset:40960
    ds_read_b64_tr_b16 a[226:227], v2 offset:45056
    v_mfma_f32_16x16x32_bf16 a[100:103], a[228:231], v[40:43], a[100:103]
    v_exp_f32 v23, v23
    v_mfma_f32_16x16x32_bf16 a[104:107], a[232:235], v[40:43], a[104:107]
    ds_read_b64_tr_b16 a[228:229], v2 offset:41216
    ds_read_b64_tr_b16 a[230:231], v2 offset:45312
    v_mfma_f32_16x16x32_bf16 a[108:111], a[236:239], v[40:43], a[108:111]
    v_cvt_pk_bf16_f32 v18, v20, v21
    v_add_f32 v112, v112, v22
    v_mfma_f32_16x16x32_bf16 a[112:115], a[240:243], v[40:43], a[112:115]
    ds_read_b64_tr_b16 a[232:233], v2 offset:41472
    ds_read_b64_tr_b16 a[234:235], v2 offset:45568
    v_mfma_f32_16x16x32_bf16 a[116:119], a[244:247], v[40:43], a[116:119]
    v_add_f32 v112, v112, v23
    v_cvt_pk_bf16_f32 v19, v22, v23
    v_mfma_f32_16x16x32_bf16 a[120:123], a[248:251], v[40:43], a[120:123]
    ds_read_b64_tr_b16 a[236:237], v2 offset:41728
    ds_read_b64_tr_b16 a[238:239], v2 offset:45824
    v_mfma_f32_16x16x32_bf16 a[124:127], a[252:255], v[40:43], a[124:127]
    v_exp_f32 v24, v24
    v_mfma_f32_16x16x32_bf16 v[32:35], a[192:195], v[160:163], 0
    ds_read_b64_tr_b16 a[240:241], v2 offset:41984
    ds_read_b64_tr_b16 a[242:243], v2 offset:46080
    v_mfma_f32_16x16x32_bf16 v[32:35], a[196:199], v[164:167], v[32:35]
    v_exp_f32 v25, v25
    v_mfma_f32_16x16x32_bf16 v[32:35], a[200:203], v[168:171], v[32:35]
    ds_read_b64_tr_b16 a[244:245], v2 offset:42240
    ds_read_b64_tr_b16 a[246:247], v2 offset:46336
    v_mfma_f32_16x16x32_bf16 v[32:35], a[204:207], v[172:175], v[32:35]
    v_add_f32 v113, v113, v24
    v_add_f32 v113, v113, v25
    v_mfma_f32_16x16x32_bf16 v[36:39], a[220:223], v[172:175], 0
    ds_read_b64_tr_b16 a[248:249], v2 offset:42496
    ds_read_b64_tr_b16 a[250:251], v2 offset:46592
    v_mfma_f32_16x16x32_bf16 v[36:39], a[216:219], v[168:171], v[36:39]
    v_exp_f32 v26, v26
    v_mfma_f32_16x16x32_bf16 v[36:39], a[212:215], v[164:167], v[36:39]
    ds_read_b64_tr_b16 a[252:253], v2 offset:42752
    ds_read_b64_tr_b16 a[254:255], v2 offset:46848
    v_mfma_f32_16x16x32_bf16 v[36:39], a[208:211], v[160:163], v[36:39]
    s_waitcnt lgkmcnt(14)
    v_exp_f32 v27, v27
    v_mfma_f32_16x16x32_bf16 a[0:3], a[224:227], v[16:19], a[0:3]
    s_waitcnt lgkmcnt(12)
    v_cvt_pk_bf16_f32 v24, v24, v25
    v_add_f32 v113, v113, v26
    v_mfma_f32_16x16x32_bf16 a[4:7], a[228:231], v[16:19], a[4:7]
    s_waitcnt lgkmcnt(10)
    v_exp_f32 v28, v28
    v_mfma_f32_16x16x32_bf16 a[8:11], a[232:235], v[16:19], a[8:11]
    s_waitcnt lgkmcnt(8)
    v_add_f32 v113, v113, v27
    v_cvt_pk_bf16_f32 v25, v26, v27
    v_mfma_f32_16x16x32_bf16 a[12:15], a[236:239], v[16:19], a[12:15]
    s_waitcnt lgkmcnt(6)
    v_exp_f32 v29, v29
    v_mfma_f32_16x16x32_bf16 a[16:19], a[240:243], v[16:19], a[16:19]
    s_waitcnt lgkmcnt(4)
    v_add_f32 v113, v113, v28
    v_add_f32 v113, v113, v29
    v_mfma_f32_16x16x32_bf16 a[20:23], a[244:247], v[16:19], a[20:23]
    s_waitcnt lgkmcnt(2)
    v_exp_f32 v30, v30
    v_mfma_f32_16x16x32_bf16 a[24:27], a[248:251], v[16:19], a[24:27]
    s_waitcnt lgkmcnt(0)
    v_exp_f32 v31, v31
    v_mfma_f32_16x16x32_bf16 a[28:31], a[252:255], v[16:19], a[28:31]
    v_cvt_pk_bf16_f32 v26, v28, v29
    v_add_f32 v113, v113, v30
    v_mfma_f32_16x16x32_bf16 v[40:43], a[192:195], v[176:179], 0
    s_waitcnt vmcnt(4)
    v_add_f32 v113, v113, v31
    v_cvt_pk_bf16_f32 v27, v30, v31
    v_mfma_f32_16x16x32_bf16 v[40:43], a[196:199], v[180:183], v[40:43]
    s_barrier
    ds_read_b128 a[192:195], v1 offset:49152
    ds_read_b128 a[196:199], v1 offset:49664
    v_mfma_f32_16x16x32_bf16 v[40:43], a[200:203], v[184:187], v[40:43]
    v_exp_f32 v32, v32
    v_mfma_f32_16x16x32_bf16 v[40:43], a[204:207], v[188:191], v[40:43]
    v_exp_f32 v33, v33
    v_mfma_f32_16x16x32_bf16 v[44:47], a[220:223], v[188:191], 0
    v_add_f32 v114, v114, v32
    v_add_f32 v114, v114, v33
    v_mfma_f32_16x16x32_bf16 v[44:47], a[216:219], v[184:187], v[44:47]
    ds_read_b128 a[200:203], v1 offset:50176
    ds_read_b128 a[204:207], v1 offset:50688
    v_mfma_f32_16x16x32_bf16 v[44:47], a[212:215], v[180:183], v[44:47]
    v_exp_f32 v34, v34
    v_mfma_f32_16x16x32_bf16 v[44:47], a[208:211], v[176:179], v[44:47]
    v_exp_f32 v35, v35
    v_mfma_f32_16x16x32_bf16 a[32:35], a[224:227], v[24:27], a[32:35]
    v_cvt_pk_bf16_f32 v32, v32, v33
    v_add_f32 v114, v114, v34
    v_mfma_f32_16x16x32_bf16 a[36:39], a[228:231], v[24:27], a[36:39]
    ds_read_b128 a[220:223], v1 offset:54784
    ds_read_b128 a[216:219], v1 offset:54272
    v_mfma_f32_16x16x32_bf16 a[40:43], a[232:235], v[24:27], a[40:43]
    v_exp_f32 v36, v36
    v_mfma_f32_16x16x32_bf16 a[44:47], a[236:239], v[24:27], a[44:47]
    v_add_f32 v114, v114, v35
    v_cvt_pk_bf16_f32 v33, v34, v35
    v_mfma_f32_16x16x32_bf16 a[48:51], a[240:243], v[24:27], a[48:51]
    v_exp_f32 v37, v37
    v_mfma_f32_16x16x32_bf16 a[52:55], a[244:247], v[24:27], a[52:55]
    ds_read_b128 a[212:215], v1 offset:53760
    ds_read_b128 a[208:211], v1 offset:53248
    v_mfma_f32_16x16x32_bf16 a[56:59], a[248:251], v[24:27], a[56:59]
    v_add_f32 v114, v114, v36
    v_add_f32 v114, v114, v37
    v_mfma_f32_16x16x32_bf16 a[60:63], a[252:255], v[24:27], a[60:63]
    s_waitcnt lgkmcnt(7)
    v_exp_f32 v38, v38
    v_mfma_f32_16x16x32_bf16 v[16:19], a[192:195], v[128:131], 0
    s_waitcnt lgkmcnt(6)
    v_exp_f32 v39, v39
    v_mfma_f32_16x16x32_bf16 v[16:19], a[196:199], v[132:135], v[16:19]
    s_waitcnt lgkmcnt(5)
    v_cvt_pk_bf16_f32 v34, v36, v37
    v_add_f32 v114, v114, v38
    v_mfma_f32_16x16x32_bf16 v[16:19], a[200:203], v[136:139], v[16:19]
    s_waitcnt lgkmcnt(4)
    v_add_f32 v114, v114, v39
    v_cvt_pk_bf16_f32 v35, v38, v39
    v_mfma_f32_16x16x32_bf16 v[16:19], a[204:207], v[140:143], v[16:19]
    s_waitcnt lgkmcnt(3)
    v_exp_f32 v40, v40
    v_mfma_f32_16x16x32_bf16 v[20:23], a[220:223], v[140:143], 0
    s_waitcnt lgkmcnt(2)
    v_exp_f32 v41, v41
    v_mfma_f32_16x16x32_bf16 v[20:23], a[216:219], v[136:139], v[20:23]
    s_waitcnt lgkmcnt(1)
    v_add_f32 v115, v115, v40
    v_add_f32 v115, v115, v41
    v_mfma_f32_16x16x32_bf16 v[20:23], a[212:215], v[132:135], v[20:23]
    s_waitcnt lgkmcnt(0)
    v_exp_f32 v42, v42
    v_mfma_f32_16x16x32_bf16 v[20:23], a[208:211], v[128:131], v[20:23]
    v_exp_f32 v43, v43
    v_mfma_f32_16x16x32_bf16 a[64:67], a[224:227], v[32:35], a[64:67]
    v_cvt_pk_bf16_f32 v40, v40, v41
    v_add_f32 v115, v115, v42
    v_mfma_f32_16x16x32_bf16 a[68:71], a[228:231], v[32:35], a[68:71]
    v_exp_f32 v44, v44
    v_mfma_f32_16x16x32_bf16 a[72:75], a[232:235], v[32:35], a[72:75]
    v_add_f32 v115, v115, v43
    v_cvt_pk_bf16_f32 v41, v42, v43
    v_mfma_f32_16x16x32_bf16 a[76:79], a[236:239], v[32:35], a[76:79]
    v_exp_f32 v45, v45
    v_mfma_f32_16x16x32_bf16 a[80:83], a[240:243], v[32:35], a[80:83]
    v_add_f32 v115, v115, v44
    v_add_f32 v115, v115, v45
    v_mfma_f32_16x16x32_bf16 a[84:87], a[244:247], v[32:35], a[84:87]
    v_exp_f32 v46, v46
    v_mfma_f32_16x16x32_bf16 a[88:91], a[248:251], v[32:35], a[88:91]
    v_exp_f32 v47, v47
    v_mfma_f32_16x16x32_bf16 a[92:95], a[252:255], v[32:35], a[92:95]
    v_cvt_pk_bf16_f32 v42, v44, v45
    v_add_f32 v115, v115, v46
    v_mfma_f32_16x16x32_bf16 v[24:27], a[192:195], v[144:147], 0
    v_add_f32 v115, v115, v47
    v_cvt_pk_bf16_f32 v43, v46, v47
    v_mfma_f32_16x16x32_bf16 v[24:27], a[196:199], v[148:151], v[24:27]
    v_exp_f32 v16, v16
    v_mfma_f32_16x16x32_bf16 v[24:27], a[200:203], v[152:155], v[24:27]
    v_exp_f32 v17, v17
    v_mfma_f32_16x16x32_bf16 v[24:27], a[204:207], v[156:159], v[24:27]
    v_add_f32 v112, v112, v16
    v_add_f32 v112, v112, v17
    v_mfma_f32_16x16x32_bf16 v[28:31], a[220:223], v[156:159], 0
    v_exp_f32 v18, v18
    v_mfma_f32_16x16x32_bf16 v[28:31], a[216:219], v[152:155], v[28:31]
    v_exp_f32 v19, v19
    v_mfma_f32_16x16x32_bf16 v[28:31], a[212:215], v[148:151], v[28:31]
    v_cvt_pk_bf16_f32 v16, v16, v17
    v_add_f32 v112, v112, v18
    v_mfma_f32_16x16x32_bf16 v[28:31], a[208:211], v[144:147], v[28:31]
    v_exp_f32 v20, v20
    v_mfma_f32_16x16x32_bf16 a[96:99], a[224:227], v[40:43], a[96:99]
    ds_read_b64_tr_b16 a[224:225], v2 offset:49152
    ds_read_b64_tr_b16 a[226:227], v2 offset:53248
    v_mfma_f32_16x16x32_bf16 a[100:103], a[228:231], v[40:43], a[100:103]
    v_add_f32 v112, v112, v19
    v_cvt_pk_bf16_f32 v17, v18, v19
    v_mfma_f32_16x16x32_bf16 a[104:107], a[232:235], v[40:43], a[104:107]
    ds_read_b64_tr_b16 a[228:229], v2 offset:49408
    ds_read_b64_tr_b16 a[230:231], v2 offset:53504
    v_mfma_f32_16x16x32_bf16 a[108:111], a[236:239], v[40:43], a[108:111]
    v_exp_f32 v21, v21
    v_mfma_f32_16x16x32_bf16 a[112:115], a[240:243], v[40:43], a[112:115]
    ds_read_b64_tr_b16 a[232:233], v2 offset:49664
    ds_read_b64_tr_b16 a[234:235], v2 offset:53760
    v_mfma_f32_16x16x32_bf16 a[116:119], a[244:247], v[40:43], a[116:119]
    v_add_f32 v112, v112, v20
    v_add_f32 v112, v112, v21
    v_mfma_f32_16x16x32_bf16 a[120:123], a[248:251], v[40:43], a[120:123]
    ds_read_b64_tr_b16 a[236:237], v2 offset:49920
    ds_read_b64_tr_b16 a[238:239], v2 offset:54016
    v_mfma_f32_16x16x32_bf16 a[124:127], a[252:255], v[40:43], a[124:127]
    v_exp_f32 v22, v22
    v_mfma_f32_16x16x32_bf16 v[32:35], a[192:195], v[160:163], 0
    ds_read_b64_tr_b16 a[240:241], v2 offset:50176
    ds_read_b64_tr_b16 a[242:243], v2 offset:54272
    v_mfma_f32_16x16x32_bf16 v[32:35], a[196:199], v[164:167], v[32:35]
    v_exp_f32 v23, v23
    v_mfma_f32_16x16x32_bf16 v[32:35], a[200:203], v[168:171], v[32:35]
    ds_read_b64_tr_b16 a[244:245], v2 offset:50432
    ds_read_b64_tr_b16 a[246:247], v2 offset:54528
    v_mfma_f32_16x16x32_bf16 v[32:35], a[204:207], v[172:175], v[32:35]
    v_cvt_pk_bf16_f32 v18, v20, v21
    v_add_f32 v112, v112, v22
    v_mfma_f32_16x16x32_bf16 v[36:39], a[220:223], v[172:175], 0
    ds_read_b64_tr_b16 a[248:249], v2 offset:50688
    ds_read_b64_tr_b16 a[250:251], v2 offset:54784
    v_mfma_f32_16x16x32_bf16 v[36:39], a[216:219], v[168:171], v[36:39]
    v_add_f32 v112, v112, v23
    v_cvt_pk_bf16_f32 v19, v22, v23
    v_mfma_f32_16x16x32_bf16 v[36:39], a[212:215], v[164:167], v[36:39]
    ds_read_b64_tr_b16 a[252:253], v2 offset:50944
    ds_read_b64_tr_b16 a[254:255], v2 offset:55040
    v_mfma_f32_16x16x32_bf16 v[36:39], a[208:211], v[160:163], v[36:39]
    s_waitcnt lgkmcnt(14)
    v_exp_f32 v24, v24
    v_mfma_f32_16x16x32_bf16 a[0:3], a[224:227], v[16:19], a[0:3]
    s_waitcnt lgkmcnt(12)
    v_exp_f32 v25, v25
    v_mfma_f32_16x16x32_bf16 a[4:7], a[228:231], v[16:19], a[4:7]
    s_waitcnt lgkmcnt(10)
    v_add_f32 v113, v113, v24
    v_add_f32 v113, v113, v25
    v_mfma_f32_16x16x32_bf16 a[8:11], a[232:235], v[16:19], a[8:11]
    s_waitcnt lgkmcnt(8)
    v_exp_f32 v26, v26
    v_mfma_f32_16x16x32_bf16 a[12:15], a[236:239], v[16:19], a[12:15]
    s_waitcnt lgkmcnt(6)
    v_exp_f32 v27, v27
    v_mfma_f32_16x16x32_bf16 a[16:19], a[240:243], v[16:19], a[16:19]
    s_waitcnt lgkmcnt(4)
    v_cvt_pk_bf16_f32 v24, v24, v25
    v_add_f32 v113, v113, v26
    v_mfma_f32_16x16x32_bf16 a[20:23], a[244:247], v[16:19], a[20:23]
    s_waitcnt lgkmcnt(2)
    v_exp_f32 v28, v28
    v_mfma_f32_16x16x32_bf16 a[24:27], a[248:251], v[16:19], a[24:27]
    s_waitcnt lgkmcnt(0)
    v_add_f32 v113, v113, v27
    v_cvt_pk_bf16_f32 v25, v26, v27
    v_mfma_f32_16x16x32_bf16 a[28:31], a[252:255], v[16:19], a[28:31]
    v_exp_f32 v29, v29
    v_mfma_f32_16x16x32_bf16 v[40:43], a[192:195], v[176:179], 0
    s_waitcnt vmcnt(0)
    v_add_f32 v113, v113, v28
    v_add_f32 v113, v113, v29
    v_mfma_f32_16x16x32_bf16 v[40:43], a[196:199], v[180:183], v[40:43]
    s_barrier
    ds_read_b128 a[192:195], v1 offset:57344
    ds_read_b128 a[196:199], v1 offset:57856
    v_mfma_f32_16x16x32_bf16 v[40:43], a[200:203], v[184:187], v[40:43]
    v_exp_f32 v30, v30
    v_mfma_f32_16x16x32_bf16 v[40:43], a[204:207], v[188:191], v[40:43]
    v_exp_f32 v31, v31
    v_mfma_f32_16x16x32_bf16 v[44:47], a[220:223], v[188:191], 0
    v_cvt_pk_bf16_f32 v26, v28, v29
    v_add_f32 v113, v113, v30
    v_mfma_f32_16x16x32_bf16 v[44:47], a[216:219], v[184:187], v[44:47]
    ds_read_b128 a[200:203], v1 offset:58368
    ds_read_b128 a[204:207], v1 offset:58880
    v_mfma_f32_16x16x32_bf16 v[44:47], a[212:215], v[180:183], v[44:47]
    v_add_f32 v113, v113, v31
    v_cvt_pk_bf16_f32 v27, v30, v31
    v_mfma_f32_16x16x32_bf16 v[44:47], a[208:211], v[176:179], v[44:47]
    v_exp_f32 v32, v32
    v_mfma_f32_16x16x32_bf16 a[32:35], a[224:227], v[24:27], a[32:35]
    v_exp_f32 v33, v33
    v_mfma_f32_16x16x32_bf16 a[36:39], a[228:231], v[24:27], a[36:39]
    ds_read_b128 a[220:223], v1 offset:62976
    ds_read_b128 a[216:219], v1 offset:62464
    v_mfma_f32_16x16x32_bf16 a[40:43], a[232:235], v[24:27], a[40:43]
    v_add_f32 v114, v114, v32
    v_add_f32 v114, v114, v33
    v_mfma_f32_16x16x32_bf16 a[44:47], a[236:239], v[24:27], a[44:47]
    v_exp_f32 v34, v34
    v_mfma_f32_16x16x32_bf16 a[48:51], a[240:243], v[24:27], a[48:51]
    v_exp_f32 v35, v35
    v_mfma_f32_16x16x32_bf16 a[52:55], a[244:247], v[24:27], a[52:55]
    ds_read_b128 a[212:215], v1 offset:61952
    ds_read_b128 a[208:211], v1 offset:61440
    v_mfma_f32_16x16x32_bf16 a[56:59], a[248:251], v[24:27], a[56:59]
    v_cvt_pk_bf16_f32 v32, v32, v33
    v_add_f32 v114, v114, v34
    v_mfma_f32_16x16x32_bf16 a[60:63], a[252:255], v[24:27], a[60:63]
    s_waitcnt lgkmcnt(7)
    v_exp_f32 v36, v36
    v_mfma_f32_16x16x32_bf16 v[16:19], a[192:195], v[128:131], 0
    s_waitcnt lgkmcnt(6)
    v_add_f32 v114, v114, v35
    v_cvt_pk_bf16_f32 v33, v34, v35
    v_mfma_f32_16x16x32_bf16 v[16:19], a[196:199], v[132:135], v[16:19]
    s_waitcnt lgkmcnt(5)
    v_exp_f32 v37, v37
    v_mfma_f32_16x16x32_bf16 v[16:19], a[200:203], v[136:139], v[16:19]
    s_waitcnt lgkmcnt(4)
    v_add_f32 v114, v114, v36
    v_add_f32 v114, v114, v37
    v_mfma_f32_16x16x32_bf16 v[16:19], a[204:207], v[140:143], v[16:19]
    s_waitcnt lgkmcnt(3)
    v_exp_f32 v38, v38
    v_mfma_f32_16x16x32_bf16 v[20:23], a[220:223], v[140:143], 0
    s_waitcnt lgkmcnt(2)
    v_exp_f32 v39, v39
    v_mfma_f32_16x16x32_bf16 v[20:23], a[216:219], v[136:139], v[20:23]
    s_waitcnt lgkmcnt(1)
    v_cvt_pk_bf16_f32 v34, v36, v37
    v_add_f32 v114, v114, v38
    v_mfma_f32_16x16x32_bf16 v[20:23], a[212:215], v[132:135], v[20:23]
    s_waitcnt lgkmcnt(0)
    v_add_f32 v114, v114, v39
    v_cvt_pk_bf16_f32 v35, v38, v39
    v_mfma_f32_16x16x32_bf16 v[20:23], a[208:211], v[128:131], v[20:23]
    v_exp_f32 v40, v40
    v_mfma_f32_16x16x32_bf16 a[64:67], a[224:227], v[32:35], a[64:67]
    v_exp_f32 v41, v41
    v_mfma_f32_16x16x32_bf16 a[68:71], a[228:231], v[32:35], a[68:71]
    v_add_f32 v115, v115, v40
    v_add_f32 v115, v115, v41
    v_mfma_f32_16x16x32_bf16 a[72:75], a[232:235], v[32:35], a[72:75]
    v_exp_f32 v42, v42
    v_mfma_f32_16x16x32_bf16 a[76:79], a[236:239], v[32:35], a[76:79]
    v_exp_f32 v43, v43
    v_mfma_f32_16x16x32_bf16 a[80:83], a[240:243], v[32:35], a[80:83]
    v_cvt_pk_bf16_f32 v40, v40, v41
    v_add_f32 v115, v115, v42
    v_mfma_f32_16x16x32_bf16 a[84:87], a[244:247], v[32:35], a[84:87]
    v_exp_f32 v44, v44
    v_mfma_f32_16x16x32_bf16 a[88:91], a[248:251], v[32:35], a[88:91]
    v_add_f32 v115, v115, v43
    v_cvt_pk_bf16_f32 v41, v42, v43
    v_mfma_f32_16x16x32_bf16 a[92:95], a[252:255], v[32:35], a[92:95]
    v_exp_f32 v45, v45
    v_mfma_f32_16x16x32_bf16 v[24:27], a[192:195], v[144:147], 0
    v_add_f32 v115, v115, v44
    v_add_f32 v115, v115, v45
    v_mfma_f32_16x16x32_bf16 v[24:27], a[196:199], v[148:151], v[24:27]
    v_exp_f32 v46, v46
    v_mfma_f32_16x16x32_bf16 v[24:27], a[200:203], v[152:155], v[24:27]
    v_exp_f32 v47, v47
    v_mfma_f32_16x16x32_bf16 v[24:27], a[204:207], v[156:159], v[24:27]
    v_cvt_pk_bf16_f32 v42, v44, v45
    v_add_f32 v115, v115, v46
    v_mfma_f32_16x16x32_bf16 v[28:31], a[220:223], v[156:159], 0
    v_add_f32 v115, v115, v47
    v_cvt_pk_bf16_f32 v43, v46, v47
    v_mfma_f32_16x16x32_bf16 v[28:31], a[216:219], v[152:155], v[28:31]
    v_exp_f32 v16, v16
    v_exp_f32 v17, v17
    v_mfma_f32_16x16x32_bf16 v[28:31], a[212:215], v[148:151], v[28:31]
    v_add_f32 v112, v112, v16
    v_add_f32 v112, v112, v17
    v_exp_f32 v18, v18
    v_mfma_f32_16x16x32_bf16 v[28:31], a[208:211], v[144:147], v[28:31]
    v_exp_f32 v19, v19
    v_cvt_pk_bf16_f32 v16, v16, v17
    v_add_f32 v112, v112, v18
    v_mfma_f32_16x16x32_bf16 a[96:99], a[224:227], v[40:43], a[96:99]
    ds_read_b64_tr_b16 a[224:225], v2 offset:57344
    ds_read_b64_tr_b16 a[226:227], v2 offset:61440
    v_mfma_f32_16x16x32_bf16 a[100:103], a[228:231], v[40:43], a[100:103]
    v_exp_f32 v20, v20
    v_add_f32 v112, v112, v19
    v_cvt_pk_bf16_f32 v17, v18, v19
    v_mfma_f32_16x16x32_bf16 a[104:107], a[232:235], v[40:43], a[104:107]
    ds_read_b64_tr_b16 a[228:229], v2 offset:57600
    ds_read_b64_tr_b16 a[230:231], v2 offset:61696
    v_mfma_f32_16x16x32_bf16 a[108:111], a[236:239], v[40:43], a[108:111]
    v_exp_f32 v21, v21
    v_mfma_f32_16x16x32_bf16 a[112:115], a[240:243], v[40:43], a[112:115]
    ds_read_b64_tr_b16 a[232:233], v2 offset:57856
    ds_read_b64_tr_b16 a[234:235], v2 offset:61952
    v_mfma_f32_16x16x32_bf16 a[116:119], a[244:247], v[40:43], a[116:119]
    v_add_f32 v112, v112, v20
    v_add_f32 v112, v112, v21
    v_mfma_f32_16x16x32_bf16 a[120:123], a[248:251], v[40:43], a[120:123]
    ds_read_b64_tr_b16 a[236:237], v2 offset:58112
    ds_read_b64_tr_b16 a[238:239], v2 offset:62208
    v_mfma_f32_16x16x32_bf16 a[124:127], a[252:255], v[40:43], a[124:127]
    v_exp_f32 v22, v22
    v_mfma_f32_16x16x32_bf16 v[32:35], a[192:195], v[160:163], 0
    ds_read_b64_tr_b16 a[240:241], v2 offset:58368
    ds_read_b64_tr_b16 a[242:243], v2 offset:62464
    v_mfma_f32_16x16x32_bf16 v[32:35], a[196:199], v[164:167], v[32:35]
    v_exp_f32 v23, v23
    v_mfma_f32_16x16x32_bf16 v[32:35], a[200:203], v[168:171], v[32:35]
    ds_read_b64_tr_b16 a[244:245], v2 offset:58624
    ds_read_b64_tr_b16 a[246:247], v2 offset:62720
    v_mfma_f32_16x16x32_bf16 v[32:35], a[204:207], v[172:175], v[32:35]
    v_cvt_pk_bf16_f32 v18, v20, v21
    v_add_f32 v112, v112, v22
    v_mfma_f32_16x16x32_bf16 v[36:39], a[220:223], v[172:175], 0
    ds_read_b64_tr_b16 a[248:249], v2 offset:58880
    ds_read_b64_tr_b16 a[250:251], v2 offset:62976
    v_mfma_f32_16x16x32_bf16 v[36:39], a[216:219], v[168:171], v[36:39]
    v_add_f32 v112, v112, v23
    v_cvt_pk_bf16_f32 v19, v22, v23
    v_mfma_f32_16x16x32_bf16 v[36:39], a[212:215], v[164:167], v[36:39]
    ds_read_b64_tr_b16 a[252:253], v2 offset:59136
    ds_read_b64_tr_b16 a[254:255], v2 offset:63232
    v_mfma_f32_16x16x32_bf16 v[36:39], a[208:211], v[160:163], v[36:39]
    s_waitcnt lgkmcnt(14)
    v_exp_f32 v24, v24
    v_mfma_f32_16x16x32_bf16 a[0:3], a[224:227], v[16:19], a[0:3]
    s_waitcnt lgkmcnt(12)
    v_exp_f32 v25, v25
    v_mfma_f32_16x16x32_bf16 a[4:7], a[228:231], v[16:19], a[4:7]
    s_waitcnt lgkmcnt(10)
    v_add_f32 v113, v113, v24
    v_add_f32 v113, v113, v25
    v_mfma_f32_16x16x32_bf16 a[8:11], a[232:235], v[16:19], a[8:11]
    s_waitcnt lgkmcnt(8)
    v_exp_f32 v26, v26
    v_mfma_f32_16x16x32_bf16 a[12:15], a[236:239], v[16:19], a[12:15]
    s_waitcnt lgkmcnt(6)
    v_exp_f32 v27, v27
    v_mfma_f32_16x16x32_bf16 a[16:19], a[240:243], v[16:19], a[16:19]
    s_waitcnt lgkmcnt(4)
    v_cvt_pk_bf16_f32 v24, v24, v25
    v_add_f32 v113, v113, v26
    v_mfma_f32_16x16x32_bf16 a[20:23], a[244:247], v[16:19], a[20:23]
    s_waitcnt lgkmcnt(2)
    v_exp_f32 v28, v28
    v_mfma_f32_16x16x32_bf16 a[24:27], a[248:251], v[16:19], a[24:27]
    s_waitcnt lgkmcnt(0)
    v_add_f32 v113, v113, v27
    v_cvt_pk_bf16_f32 v25, v26, v27
    v_mfma_f32_16x16x32_bf16 a[28:31], a[252:255], v[16:19], a[28:31]
    v_exp_f32 v29, v29
    v_mfma_f32_16x16x32_bf16 v[40:43], a[192:195], v[176:179], 0
    v_add_f32 v113, v113, v28
    v_add_f32 v113, v113, v29
    v_mfma_f32_16x16x32_bf16 v[40:43], a[196:199], v[180:183], v[40:43]
    ds_read_b128 a[192:195], v1 offset:32768
    ds_read_b128 a[196:199], v1 offset:33280
    v_mfma_f32_16x16x32_bf16 v[40:43], a[200:203], v[184:187], v[40:43]
    v_exp_f32 v30, v30
    v_mov_b32 v8, v112
    v_accvgpr_read_b32 v128, a0
    v_accvgpr_read_b32 v129, a1
    v_permlane16_swap_b32 v8, v112
    v_add_f32 v112, v112, v8
    v_mov_b32 v8, v112
    v_accvgpr_read_b32 v130, a2
    v_accvgpr_read_b32 v131, a3
    v_permlane32_swap_b32 v8, v112
    v_add_f32 v112, v112, v8
    v_subrev_u32 v8, 0x33800000, v112
    v_cmp_lt_u32 vcc, 0x20000000, v8
    v_rcp_f32 v112, v112
    s_cbranch_vccnz L_fallback
    v_accvgpr_read_b32 v132, a4
    v_accvgpr_read_b32 v133, a5
    v_accvgpr_read_b32 v134, a6
    v_accvgpr_read_b32 v135, a7
    v_add_u32 v7, 0, v6
    v_pk_mul_f32 v[128:129], v[128:129], v[112:113] op_sel_hi:[1,0]
    v_pk_mul_f32 v[130:131], v[130:131], v[112:113] op_sel_hi:[1,0]
    v_pk_mul_f32 v[132:133], v[132:133], v[112:113] op_sel_hi:[1,0]
    v_pk_mul_f32 v[134:135], v[134:135], v[112:113] op_sel_hi:[1,0]
    v_cvt_pk_bf16_f32 v128, v128, v129
    v_cvt_pk_bf16_f32 v129, v130, v131
    v_cvt_pk_bf16_f32 v130, v132, v133
    v_cvt_pk_bf16_f32 v131, v134, v135
    v_accvgpr_read_b32 v136, a8
    v_accvgpr_read_b32 v137, a9
    v_permlane16_swap_b32 v128, v130
    v_permlane16_swap_b32 v129, v131
    buffer_store_dwordx4 v[128:131], v7, s[20:23], 0 offen sc0 nt sc1
    v_accvgpr_read_b32 v138, a10
    v_accvgpr_read_b32 v139, a11
    v_accvgpr_read_b32 v140, a12
    v_accvgpr_read_b32 v141, a13
    v_accvgpr_read_b32 v142, a14
    v_accvgpr_read_b32 v143, a15
    v_pk_mul_f32 v[136:137], v[136:137], v[112:113] op_sel_hi:[1,0]
    v_pk_mul_f32 v[138:139], v[138:139], v[112:113] op_sel_hi:[1,0]
    v_pk_mul_f32 v[140:141], v[140:141], v[112:113] op_sel_hi:[1,0]
    v_pk_mul_f32 v[142:143], v[142:143], v[112:113] op_sel_hi:[1,0]
    v_cvt_pk_bf16_f32 v136, v136, v137
    v_cvt_pk_bf16_f32 v137, v138, v139
    v_cvt_pk_bf16_f32 v138, v140, v141
    v_cvt_pk_bf16_f32 v139, v142, v143
    v_accvgpr_read_b32 v132, a20
    v_accvgpr_read_b32 v133, a21
    v_permlane16_swap_b32 v136, v138
    v_permlane16_swap_b32 v137, v139
    buffer_store_dwordx4 v[136:139], v7, s[20:23], 0 offen offset:64 sc0 nt sc1
    v_accvgpr_read_b32 v134, a22
    v_accvgpr_read_b32 v135, a23
    v_accvgpr_read_b32 v128, a16
    v_accvgpr_read_b32 v129, a17
    v_accvgpr_read_b32 v130, a18
    v_accvgpr_read_b32 v131, a19
    v_pk_mul_f32 v[128:129], v[128:129], v[112:113] op_sel_hi:[1,0]
    v_pk_mul_f32 v[130:131], v[130:131], v[112:113] op_sel_hi:[1,0]
    v_pk_mul_f32 v[132:133], v[132:133], v[112:113] op_sel_hi:[1,0]
    v_pk_mul_f32 v[134:135], v[134:135], v[112:113] op_sel_hi:[1,0]
    v_cvt_pk_bf16_f32 v128, v128, v129
    v_cvt_pk_bf16_f32 v129, v130, v131
    v_cvt_pk_bf16_f32 v130, v132, v133
    v_cvt_pk_bf16_f32 v131, v134, v135
    v_accvgpr_read_b32 v140, a28
    v_accvgpr_read_b32 v141, a29
    v_permlane16_swap_b32 v128, v130
    v_permlane16_swap_b32 v129, v131
    buffer_store_dwordx4 v[128:131], v7, s[20:23], 0 offen offset:128 sc0 nt sc1
    v_accvgpr_read_b32 v142, a30
    v_accvgpr_read_b32 v143, a31
    v_accvgpr_read_b32 v136, a24
    v_accvgpr_read_b32 v137, a25
    v_accvgpr_read_b32 v138, a26
    v_accvgpr_read_b32 v139, a27
    v_pk_mul_f32 v[136:137], v[136:137], v[112:113] op_sel_hi:[1,0]
    v_pk_mul_f32 v[138:139], v[138:139], v[112:113] op_sel_hi:[1,0]
    v_pk_mul_f32 v[140:141], v[140:141], v[112:113] op_sel_hi:[1,0]
    v_pk_mul_f32 v[142:143], v[142:143], v[112:113] op_sel_hi:[1,0]
    v_cvt_pk_bf16_f32 v136, v136, v137
    v_cvt_pk_bf16_f32 v137, v138, v139
    v_cvt_pk_bf16_f32 v138, v140, v141
    v_cvt_pk_bf16_f32 v139, v142, v143
    s_nop 1
    v_permlane16_swap_b32 v136, v138
    v_permlane16_swap_b32 v137, v139
    buffer_store_dwordx4 v[136:139], v7, s[20:23], 0 offen offset:192 sc0 nt sc1
    v_mfma_f32_16x16x32_bf16 v[40:43], a[204:207], v[188:191], v[40:43]
    v_exp_f32 v31, v31
    v_mfma_f32_16x16x32_bf16 v[44:47], a[220:223], v[188:191], 0
    v_cvt_pk_bf16_f32 v26, v28, v29
    v_add_f32 v113, v113, v30
    v_mfma_f32_16x16x32_bf16 v[44:47], a[216:219], v[184:187], v[44:47]
    ds_read_b128 a[200:203], v1 offset:33792
    ds_read_b128 a[204:207], v1 offset:34304
    v_mfma_f32_16x16x32_bf16 v[44:47], a[212:215], v[180:183], v[44:47]
    v_add_f32 v113, v113, v31
    v_cvt_pk_bf16_f32 v27, v30, v31
    v_mfma_f32_16x16x32_bf16 v[44:47], a[208:211], v[176:179], v[44:47]
    v_exp_f32 v32, v32
    v_mfma_f32_16x16x32_bf16 a[32:35], a[224:227], v[24:27], a[32:35]
    v_exp_f32 v33, v33
    v_mfma_f32_16x16x32_bf16 a[36:39], a[228:231], v[24:27], a[36:39]
    ds_read_b128 a[220:223], v1 offset:38400
    ds_read_b128 a[216:219], v1 offset:37888
    v_mfma_f32_16x16x32_bf16 a[40:43], a[232:235], v[24:27], a[40:43]
    v_add_f32 v114, v114, v32
    v_add_f32 v114, v114, v33
    v_mfma_f32_16x16x32_bf16 a[44:47], a[236:239], v[24:27], a[44:47]
    v_exp_f32 v34, v34
    v_mfma_f32_16x16x32_bf16 a[48:51], a[240:243], v[24:27], a[48:51]
    v_exp_f32 v35, v35
    v_mfma_f32_16x16x32_bf16 a[52:55], a[244:247], v[24:27], a[52:55]
    ds_read_b128 a[212:215], v1 offset:37376
    ds_read_b128 a[208:211], v1 offset:36864
    v_mfma_f32_16x16x32_bf16 a[56:59], a[248:251], v[24:27], a[56:59]
    v_cvt_pk_bf16_f32 v32, v32, v33
    v_add_f32 v114, v114, v34
    v_mfma_f32_16x16x32_bf16 a[60:63], a[252:255], v[24:27], a[60:63]
    s_waitcnt lgkmcnt(7)
    v_exp_f32 v36, v36
    v_mfma_f32_16x16x32_bf16 v[16:19], a[192:195], v[192:195], 0
    s_waitcnt lgkmcnt(6)
    v_add_f32 v114, v114, v35
    v_cvt_pk_bf16_f32 v33, v34, v35
    v_mfma_f32_16x16x32_bf16 v[16:19], a[196:199], v[196:199], v[16:19]
    s_waitcnt lgkmcnt(5)
    v_exp_f32 v37, v37
    v_mov_b32 v8, v113
    v_accvgpr_read_b32 v144, a32
    v_accvgpr_read_b32 v145, a33
    v_permlane16_swap_b32 v8, v113
    v_add_f32 v113, v113, v8
    v_mov_b32 v8, v113
    v_accvgpr_read_b32 v146, a34
    v_accvgpr_read_b32 v147, a35
    v_permlane32_swap_b32 v8, v113
    v_add_f32 v113, v113, v8
    v_subrev_u32 v8, 0x33800000, v113
    v_cmp_lt_u32 vcc, 0x20000000, v8
    v_rcp_f32 v113, v113
    s_cbranch_vccnz L_fallback
    v_accvgpr_read_b32 v148, a36
    v_accvgpr_read_b32 v149, a37
    v_accvgpr_read_b32 v150, a38
    v_accvgpr_read_b32 v151, a39
    v_add_u32 v7, 4096, v6
    v_pk_mul_f32 v[144:145], v[144:145], v[112:113] op_sel:[0,1] op_sel_hi:[1,1]
    v_pk_mul_f32 v[146:147], v[146:147], v[112:113] op_sel:[0,1] op_sel_hi:[1,1]
    v_pk_mul_f32 v[148:149], v[148:149], v[112:113] op_sel:[0,1] op_sel_hi:[1,1]
    v_pk_mul_f32 v[150:151], v[150:151], v[112:113] op_sel:[0,1] op_sel_hi:[1,1]
    v_cvt_pk_bf16_f32 v144, v144, v145
    v_cvt_pk_bf16_f32 v145, v146, v147
    v_cvt_pk_bf16_f32 v146, v148, v149
    v_cvt_pk_bf16_f32 v147, v150, v151
    v_accvgpr_read_b32 v152, a40
    v_accvgpr_read_b32 v153, a41
    v_permlane16_swap_b32 v144, v146
    v_permlane16_swap_b32 v145, v147
    buffer_store_dwordx4 v[144:147], v7, s[20:23], 0 offen sc0 nt sc1
    v_accvgpr_read_b32 v154, a42
    v_accvgpr_read_b32 v155, a43
    v_accvgpr_read_b32 v156, a44
    v_accvgpr_read_b32 v157, a45
    v_accvgpr_read_b32 v158, a46
    v_accvgpr_read_b32 v159, a47
    v_pk_mul_f32 v[152:153], v[152:153], v[112:113] op_sel:[0,1] op_sel_hi:[1,1]
    v_pk_mul_f32 v[154:155], v[154:155], v[112:113] op_sel:[0,1] op_sel_hi:[1,1]
    v_pk_mul_f32 v[156:157], v[156:157], v[112:113] op_sel:[0,1] op_sel_hi:[1,1]
    v_pk_mul_f32 v[158:159], v[158:159], v[112:113] op_sel:[0,1] op_sel_hi:[1,1]
    v_cvt_pk_bf16_f32 v152, v152, v153
    v_cvt_pk_bf16_f32 v153, v154, v155
    v_cvt_pk_bf16_f32 v154, v156, v157
    v_cvt_pk_bf16_f32 v155, v158, v159
    v_accvgpr_read_b32 v148, a52
    v_accvgpr_read_b32 v149, a53
    v_permlane16_swap_b32 v152, v154
    v_permlane16_swap_b32 v153, v155
    buffer_store_dwordx4 v[152:155], v7, s[20:23], 0 offen offset:64 sc0 nt sc1
    v_accvgpr_read_b32 v150, a54
    v_accvgpr_read_b32 v151, a55
    v_accvgpr_read_b32 v144, a48
    v_accvgpr_read_b32 v145, a49
    v_accvgpr_read_b32 v146, a50
    v_accvgpr_read_b32 v147, a51
    v_pk_mul_f32 v[144:145], v[144:145], v[112:113] op_sel:[0,1] op_sel_hi:[1,1]
    v_pk_mul_f32 v[146:147], v[146:147], v[112:113] op_sel:[0,1] op_sel_hi:[1,1]
    v_pk_mul_f32 v[148:149], v[148:149], v[112:113] op_sel:[0,1] op_sel_hi:[1,1]
    v_pk_mul_f32 v[150:151], v[150:151], v[112:113] op_sel:[0,1] op_sel_hi:[1,1]
    v_cvt_pk_bf16_f32 v144, v144, v145
    v_cvt_pk_bf16_f32 v145, v146, v147
    v_cvt_pk_bf16_f32 v146, v148, v149
    v_cvt_pk_bf16_f32 v147, v150, v151
    v_accvgpr_read_b32 v156, a60
    v_accvgpr_read_b32 v157, a61
    v_permlane16_swap_b32 v144, v146
    v_permlane16_swap_b32 v145, v147
    buffer_store_dwordx4 v[144:147], v7, s[20:23], 0 offen offset:128 sc0 nt sc1
    v_accvgpr_read_b32 v158, a62
    v_accvgpr_read_b32 v159, a63
    v_accvgpr_read_b32 v152, a56
    v_accvgpr_read_b32 v153, a57
    v_accvgpr_read_b32 v154, a58
    v_accvgpr_read_b32 v155, a59
    v_pk_mul_f32 v[152:153], v[152:153], v[112:113] op_sel:[0,1] op_sel_hi:[1,1]
    v_pk_mul_f32 v[154:155], v[154:155], v[112:113] op_sel:[0,1] op_sel_hi:[1,1]
    v_pk_mul_f32 v[156:157], v[156:157], v[112:113] op_sel:[0,1] op_sel_hi:[1,1]
    v_pk_mul_f32 v[158:159], v[158:159], v[112:113] op_sel:[0,1] op_sel_hi:[1,1]
    v_cvt_pk_bf16_f32 v152, v152, v153
    v_cvt_pk_bf16_f32 v153, v154, v155
    v_cvt_pk_bf16_f32 v154, v156, v157
    v_cvt_pk_bf16_f32 v155, v158, v159
    s_nop 1
    v_permlane16_swap_b32 v152, v154
    v_permlane16_swap_b32 v153, v155
    buffer_store_dwordx4 v[152:155], v7, s[20:23], 0 offen offset:192 sc0 nt sc1
    v_mfma_f32_16x16x32_bf16 v[16:19], a[200:203], v[200:203], v[16:19]
    s_waitcnt lgkmcnt(4)
    v_add_f32 v114, v114, v36
    v_add_f32 v114, v114, v37
    v_mfma_f32_16x16x32_bf16 v[16:19], a[204:207], v[204:207], v[16:19]
    s_waitcnt lgkmcnt(3)
    v_exp_f32 v38, v38
    v_mfma_f32_16x16x32_bf16 v[20:23], a[220:223], v[204:207], 0
    s_waitcnt lgkmcnt(2)
    v_exp_f32 v39, v39
    v_mfma_f32_16x16x32_bf16 v[20:23], a[216:219], v[200:203], v[20:23]
    s_waitcnt lgkmcnt(1)
    v_cvt_pk_bf16_f32 v34, v36, v37
    v_add_f32 v114, v114, v38
    v_mfma_f32_16x16x32_bf16 v[20:23], a[212:215], v[196:199], v[20:23]
    s_waitcnt lgkmcnt(0)
    v_add_f32 v114, v114, v39
    v_cvt_pk_bf16_f32 v35, v38, v39
    v_mfma_f32_16x16x32_bf16 v[20:23], a[208:211], v[192:195], v[20:23]
    v_exp_f32 v40, v40
    v_mfma_f32_16x16x32_bf16 a[64:67], a[224:227], v[32:35], a[64:67]
    v_exp_f32 v41, v41
    v_mfma_f32_16x16x32_bf16 a[68:71], a[228:231], v[32:35], a[68:71]
    v_add_f32 v115, v115, v40
    v_add_f32 v115, v115, v41
    v_mfma_f32_16x16x32_bf16 a[72:75], a[232:235], v[32:35], a[72:75]
    v_exp_f32 v42, v42
    v_mfma_f32_16x16x32_bf16 a[76:79], a[236:239], v[32:35], a[76:79]
    v_exp_f32 v43, v43
    v_mfma_f32_16x16x32_bf16 a[80:83], a[240:243], v[32:35], a[80:83]
    v_cvt_pk_bf16_f32 v40, v40, v41
    v_add_f32 v115, v115, v42
    v_mfma_f32_16x16x32_bf16 a[84:87], a[244:247], v[32:35], a[84:87]
    v_exp_f32 v44, v44
    v_mfma_f32_16x16x32_bf16 a[88:91], a[248:251], v[32:35], a[88:91]
    v_add_f32 v115, v115, v43
    v_cvt_pk_bf16_f32 v41, v42, v43
    v_mfma_f32_16x16x32_bf16 a[92:95], a[252:255], v[32:35], a[92:95]
    v_exp_f32 v45, v45
    v_mfma_f32_16x16x32_bf16 v[24:27], a[192:195], v[208:211], 0
    v_add_f32 v115, v115, v44
    v_add_f32 v115, v115, v45
    v_mfma_f32_16x16x32_bf16 v[24:27], a[196:199], v[212:215], v[24:27]
    v_exp_f32 v46, v46
    v_mfma_f32_16x16x32_bf16 v[24:27], a[200:203], v[216:219], v[24:27]
    v_exp_f32 v47, v47
    v_mov_b32 v8, v114
    v_accvgpr_read_b32 v160, a64
    v_accvgpr_read_b32 v161, a65
    v_permlane16_swap_b32 v8, v114
    v_add_f32 v114, v114, v8
    v_mov_b32 v8, v114
    v_accvgpr_read_b32 v162, a66
    v_accvgpr_read_b32 v163, a67
    v_permlane32_swap_b32 v8, v114
    v_add_f32 v114, v114, v8
    v_subrev_u32 v8, 0x33800000, v114
    v_cmp_lt_u32 vcc, 0x20000000, v8
    v_rcp_f32 v114, v114
    s_cbranch_vccnz L_fallback
    v_accvgpr_read_b32 v164, a68
    v_accvgpr_read_b32 v165, a69
    v_accvgpr_read_b32 v166, a70
    v_accvgpr_read_b32 v167, a71
    v_add_u32 v7, 8192, v6
    v_pk_mul_f32 v[160:161], v[160:161], v[114:115] op_sel_hi:[1,0]
    v_pk_mul_f32 v[162:163], v[162:163], v[114:115] op_sel_hi:[1,0]
    v_pk_mul_f32 v[164:165], v[164:165], v[114:115] op_sel_hi:[1,0]
    v_pk_mul_f32 v[166:167], v[166:167], v[114:115] op_sel_hi:[1,0]
    v_cvt_pk_bf16_f32 v160, v160, v161
    v_cvt_pk_bf16_f32 v161, v162, v163
    v_cvt_pk_bf16_f32 v162, v164, v165
    v_cvt_pk_bf16_f32 v163, v166, v167
    v_accvgpr_read_b32 v168, a72
    v_accvgpr_read_b32 v169, a73
    v_permlane16_swap_b32 v160, v162
    v_permlane16_swap_b32 v161, v163
    buffer_store_dwordx4 v[160:163], v7, s[20:23], 0 offen sc0 nt sc1
    v_accvgpr_read_b32 v170, a74
    v_accvgpr_read_b32 v171, a75
    v_accvgpr_read_b32 v172, a76
    v_accvgpr_read_b32 v173, a77
    v_accvgpr_read_b32 v174, a78
    v_accvgpr_read_b32 v175, a79
    v_pk_mul_f32 v[168:169], v[168:169], v[114:115] op_sel_hi:[1,0]
    v_pk_mul_f32 v[170:171], v[170:171], v[114:115] op_sel_hi:[1,0]
    v_pk_mul_f32 v[172:173], v[172:173], v[114:115] op_sel_hi:[1,0]
    v_pk_mul_f32 v[174:175], v[174:175], v[114:115] op_sel_hi:[1,0]
    v_cvt_pk_bf16_f32 v168, v168, v169
    v_cvt_pk_bf16_f32 v169, v170, v171
    v_cvt_pk_bf16_f32 v170, v172, v173
    v_cvt_pk_bf16_f32 v171, v174, v175
    v_accvgpr_read_b32 v164, a84
    v_accvgpr_read_b32 v165, a85
    v_permlane16_swap_b32 v168, v170
    v_permlane16_swap_b32 v169, v171
    buffer_store_dwordx4 v[168:171], v7, s[20:23], 0 offen offset:64 sc0 nt sc1
    v_accvgpr_read_b32 v166, a86
    v_accvgpr_read_b32 v167, a87
    v_accvgpr_read_b32 v160, a80
    v_accvgpr_read_b32 v161, a81
    v_accvgpr_read_b32 v162, a82
    v_accvgpr_read_b32 v163, a83
    v_pk_mul_f32 v[160:161], v[160:161], v[114:115] op_sel_hi:[1,0]
    v_pk_mul_f32 v[162:163], v[162:163], v[114:115] op_sel_hi:[1,0]
    v_pk_mul_f32 v[164:165], v[164:165], v[114:115] op_sel_hi:[1,0]
    v_pk_mul_f32 v[166:167], v[166:167], v[114:115] op_sel_hi:[1,0]
    v_cvt_pk_bf16_f32 v160, v160, v161
    v_cvt_pk_bf16_f32 v161, v162, v163
    v_cvt_pk_bf16_f32 v162, v164, v165
    v_cvt_pk_bf16_f32 v163, v166, v167
    v_accvgpr_read_b32 v172, a92
    v_accvgpr_read_b32 v173, a93
    v_permlane16_swap_b32 v160, v162
    v_permlane16_swap_b32 v161, v163
    buffer_store_dwordx4 v[160:163], v7, s[20:23], 0 offen offset:128 sc0 nt sc1
    v_accvgpr_read_b32 v174, a94
    v_accvgpr_read_b32 v175, a95
    v_accvgpr_read_b32 v168, a88
    v_accvgpr_read_b32 v169, a89
    v_accvgpr_read_b32 v170, a90
    v_accvgpr_read_b32 v171, a91
    v_pk_mul_f32 v[168:169], v[168:169], v[114:115] op_sel_hi:[1,0]
    v_pk_mul_f32 v[170:171], v[170:171], v[114:115] op_sel_hi:[1,0]
    v_pk_mul_f32 v[172:173], v[172:173], v[114:115] op_sel_hi:[1,0]
    v_pk_mul_f32 v[174:175], v[174:175], v[114:115] op_sel_hi:[1,0]
    v_cvt_pk_bf16_f32 v168, v168, v169
    v_cvt_pk_bf16_f32 v169, v170, v171
    v_cvt_pk_bf16_f32 v170, v172, v173
    v_cvt_pk_bf16_f32 v171, v174, v175
    s_nop 1
    v_permlane16_swap_b32 v168, v170
    v_permlane16_swap_b32 v169, v171
    buffer_store_dwordx4 v[168:171], v7, s[20:23], 0 offen offset:192 sc0 nt sc1
    v_mfma_f32_16x16x32_bf16 v[24:27], a[204:207], v[220:223], v[24:27]
    v_cvt_pk_bf16_f32 v42, v44, v45
    v_add_f32 v115, v115, v46
    v_mfma_f32_16x16x32_bf16 v[28:31], a[220:223], v[220:223], 0
    v_add_f32 v115, v115, v47
    v_cvt_pk_bf16_f32 v43, v46, v47
    v_mfma_f32_16x16x32_bf16 v[28:31], a[216:219], v[216:219], v[28:31]
    v_exp_f32 v16, v16
    v_exp_f32 v17, v17
    v_mfma_f32_16x16x32_bf16 v[28:31], a[212:215], v[212:215], v[28:31]
    v_add_f32 v116, v116, v16
    v_add_f32 v116, v116, v17
    v_exp_f32 v18, v18
    v_mfma_f32_16x16x32_bf16 v[28:31], a[208:211], v[208:211], v[28:31]
    v_exp_f32 v19, v19
    v_cvt_pk_bf16_f32 v16, v16, v17
    v_add_f32 v116, v116, v18
    v_mfma_f32_16x16x32_bf16 a[96:99], a[224:227], v[40:43], a[96:99]
    ds_read_b64_tr_b16 a[224:225], v2 offset:32768
    ds_read_b64_tr_b16 a[226:227], v2 offset:36864
    v_mfma_f32_16x16x32_bf16 a[100:103], a[228:231], v[40:43], a[100:103]
    v_exp_f32 v20, v20
    v_add_f32 v116, v116, v19
    v_cvt_pk_bf16_f32 v17, v18, v19
    v_mfma_f32_16x16x32_bf16 a[104:107], a[232:235], v[40:43], a[104:107]
    ds_read_b64_tr_b16 a[228:229], v2 offset:33024
    ds_read_b64_tr_b16 a[230:231], v2 offset:37120
    v_mfma_f32_16x16x32_bf16 a[108:111], a[236:239], v[40:43], a[108:111]
    v_exp_f32 v21, v21
    v_add_f32 v116, v116, v20
    v_add_f32 v116, v116, v21
    v_mfma_f32_16x16x32_bf16 a[112:115], a[240:243], v[40:43], a[112:115]
    ds_read_b64_tr_b16 a[232:233], v2 offset:33280
    ds_read_b64_tr_b16 a[234:235], v2 offset:37376
    v_mfma_f32_16x16x32_bf16 a[116:119], a[244:247], v[40:43], a[116:119]
    v_exp_f32 v22, v22
    v_exp_f32 v23, v23
    v_mfma_f32_16x16x32_bf16 a[120:123], a[248:251], v[40:43], a[120:123]
    ds_read_b64_tr_b16 a[236:237], v2 offset:33536
    ds_read_b64_tr_b16 a[238:239], v2 offset:37632
    v_mfma_f32_16x16x32_bf16 a[124:127], a[252:255], v[40:43], a[124:127]
    v_cvt_pk_bf16_f32 v18, v20, v21
    v_add_f32 v116, v116, v22
    v_mfma_f32_16x16x32_bf16 v[32:35], a[192:195], v[224:227], 0
    ds_read_b64_tr_b16 a[240:241], v2 offset:33792
    ds_read_b64_tr_b16 a[242:243], v2 offset:37888
    v_mfma_f32_16x16x32_bf16 v[32:35], a[196:199], v[228:231], v[32:35]
    ds_read_b128 a[192:195], v1 offset:40960
    ds_read_b128 a[196:199], v1 offset:41472
    v_mov_b32 v8, v115
    v_accvgpr_read_b32 v176, a96
    v_accvgpr_read_b32 v177, a97
    v_permlane16_swap_b32 v8, v115
    v_add_f32 v115, v115, v8
    v_mov_b32 v8, v115
    v_accvgpr_read_b32 v178, a98
    v_accvgpr_read_b32 v179, a99
    v_permlane32_swap_b32 v8, v115
    v_add_f32 v115, v115, v8
    v_subrev_u32 v8, 0x33800000, v115
    v_cmp_lt_u32 vcc, 0x20000000, v8
    v_rcp_f32 v115, v115
    s_cbranch_vccnz L_fallback
    v_accvgpr_read_b32 v180, a100
    v_accvgpr_read_b32 v181, a101
    v_accvgpr_read_b32 v182, a102
    v_accvgpr_read_b32 v183, a103
    v_add_u32 v7, 12288, v6
    v_pk_mul_f32 v[176:177], v[176:177], v[114:115] op_sel:[0,1] op_sel_hi:[1,1]
    v_pk_mul_f32 v[178:179], v[178:179], v[114:115] op_sel:[0,1] op_sel_hi:[1,1]
    v_pk_mul_f32 v[180:181], v[180:181], v[114:115] op_sel:[0,1] op_sel_hi:[1,1]
    v_pk_mul_f32 v[182:183], v[182:183], v[114:115] op_sel:[0,1] op_sel_hi:[1,1]
    v_cvt_pk_bf16_f32 v176, v176, v177
    v_cvt_pk_bf16_f32 v177, v178, v179
    v_cvt_pk_bf16_f32 v178, v180, v181
    v_cvt_pk_bf16_f32 v179, v182, v183
    v_accvgpr_read_b32 v184, a104
    v_accvgpr_read_b32 v185, a105
    v_permlane16_swap_b32 v176, v178
    v_permlane16_swap_b32 v177, v179
    buffer_store_dwordx4 v[176:179], v7, s[20:23], 0 offen sc0 nt sc1
    v_accvgpr_read_b32 v186, a106
    v_accvgpr_read_b32 v187, a107
    v_accvgpr_read_b32 v188, a108
    v_accvgpr_read_b32 v189, a109
    v_accvgpr_read_b32 v190, a110
    v_accvgpr_read_b32 v191, a111
    v_pk_mul_f32 v[184:185], v[184:185], v[114:115] op_sel:[0,1] op_sel_hi:[1,1]
    v_pk_mul_f32 v[186:187], v[186:187], v[114:115] op_sel:[0,1] op_sel_hi:[1,1]
    v_pk_mul_f32 v[188:189], v[188:189], v[114:115] op_sel:[0,1] op_sel_hi:[1,1]
    v_pk_mul_f32 v[190:191], v[190:191], v[114:115] op_sel:[0,1] op_sel_hi:[1,1]
    v_cvt_pk_bf16_f32 v184, v184, v185
    v_cvt_pk_bf16_f32 v185, v186, v187
    v_cvt_pk_bf16_f32 v186, v188, v189
    v_cvt_pk_bf16_f32 v187, v190, v191
    v_accvgpr_read_b32 v180, a116
    v_accvgpr_read_b32 v181, a117
    v_permlane16_swap_b32 v184, v186
    v_permlane16_swap_b32 v185, v187
    buffer_store_dwordx4 v[184:187], v7, s[20:23], 0 offen offset:64 sc0 nt sc1
    v_accvgpr_read_b32 v182, a118
    v_accvgpr_read_b32 v183, a119
    v_accvgpr_read_b32 v176, a112
    v_accvgpr_read_b32 v177, a113
    v_accvgpr_read_b32 v178, a114
    v_accvgpr_read_b32 v179, a115
    v_pk_mul_f32 v[176:177], v[176:177], v[114:115] op_sel:[0,1] op_sel_hi:[1,1]
    v_pk_mul_f32 v[178:179], v[178:179], v[114:115] op_sel:[0,1] op_sel_hi:[1,1]
    v_pk_mul_f32 v[180:181], v[180:181], v[114:115] op_sel:[0,1] op_sel_hi:[1,1]
    v_pk_mul_f32 v[182:183], v[182:183], v[114:115] op_sel:[0,1] op_sel_hi:[1,1]
    v_cvt_pk_bf16_f32 v176, v176, v177
    v_cvt_pk_bf16_f32 v177, v178, v179
    v_cvt_pk_bf16_f32 v178, v180, v181
    v_cvt_pk_bf16_f32 v179, v182, v183
    v_accvgpr_read_b32 v188, a124
    v_accvgpr_read_b32 v189, a125
    v_permlane16_swap_b32 v176, v178
    v_permlane16_swap_b32 v177, v179
    buffer_store_dwordx4 v[176:179], v7, s[20:23], 0 offen offset:128 sc0 nt sc1
    v_accvgpr_read_b32 v190, a126
    v_accvgpr_read_b32 v191, a127
    v_accvgpr_read_b32 v184, a120
    v_accvgpr_read_b32 v185, a121
    v_accvgpr_read_b32 v186, a122
    v_accvgpr_read_b32 v187, a123
    v_pk_mul_f32 v[184:185], v[184:185], v[114:115] op_sel:[0,1] op_sel_hi:[1,1]
    v_pk_mul_f32 v[186:187], v[186:187], v[114:115] op_sel:[0,1] op_sel_hi:[1,1]
    v_pk_mul_f32 v[188:189], v[188:189], v[114:115] op_sel:[0,1] op_sel_hi:[1,1]
    v_pk_mul_f32 v[190:191], v[190:191], v[114:115] op_sel:[0,1] op_sel_hi:[1,1]
    v_cvt_pk_bf16_f32 v184, v184, v185
    v_cvt_pk_bf16_f32 v185, v186, v187
    v_cvt_pk_bf16_f32 v186, v188, v189
    v_cvt_pk_bf16_f32 v187, v190, v191
    s_nop 1
    v_permlane16_swap_b32 v184, v186
    v_permlane16_swap_b32 v185, v187
    buffer_store_dwordx4 v[184:187], v7, s[20:23], 0 offen offset:192 sc0 nt sc1
    v_mfma_f32_16x16x32_bf16 v[32:35], a[200:203], v[232:235], v[32:35]
    ds_read_b64_tr_b16 a[244:245], v2 offset:34048
    ds_read_b64_tr_b16 a[246:247], v2 offset:38144
    v_mfma_f32_16x16x32_bf16 v[32:35], a[204:207], v[236:239], v[32:35]
    v_add_f32 v116, v116, v23
    v_cvt_pk_bf16_f32 v19, v22, v23
    v_mfma_f32_16x16x32_bf16 v[36:39], a[220:223], v[236:239], 0
    ds_read_b64_tr_b16 a[248:249], v2 offset:34304
    ds_read_b64_tr_b16 a[250:251], v2 offset:38400
    v_mfma_f32_16x16x32_bf16 v[36:39], a[216:219], v[232:235], v[36:39]
    ds_read_b128 a[200:203], v1 offset:41984
    ds_read_b128 a[204:207], v1 offset:42496
    v_mfma_f32_16x16x32_bf16 v[36:39], a[212:215], v[228:231], v[36:39]
    ds_read_b64_tr_b16 a[252:253], v2 offset:34560
    ds_read_b64_tr_b16 a[254:255], v2 offset:38656
    v_mfma_f32_16x16x32_bf16 v[36:39], a[208:211], v[224:227], v[36:39]
    s_waitcnt lgkmcnt(15)
    v_exp_f32 v24, v24
    v_mfma_f32_16x16x32_bf16 a[128:131], a[224:227], v[16:19], a[128:131]
    v_exp_f32 v25, v25
    v_mfma_f32_16x16x32_bf16 a[132:135], a[228:231], v[16:19], a[132:135]
    s_waitcnt lgkmcnt(14)
    ds_read_b128 a[220:223], v1 offset:46592
    ds_read_b128 a[216:219], v1 offset:46080
    v_mfma_f32_16x16x32_bf16 a[136:139], a[232:235], v[16:19], a[136:139]
    s_waitcnt lgkmcnt(14)
    v_add_f32 v117, v117, v24
    v_add_f32 v117, v117, v25
    v_mfma_f32_16x16x32_bf16 a[140:143], a[236:239], v[16:19], a[140:143]
    s_waitcnt lgkmcnt(12)
    v_exp_f32 v26, v26
    v_mfma_f32_16x16x32_bf16 a[144:147], a[240:243], v[16:19], a[144:147]
    s_waitcnt lgkmcnt(8)
    v_exp_f32 v27, v27
    v_mfma_f32_16x16x32_bf16 a[148:151], a[244:247], v[16:19], a[148:151]
    s_waitcnt lgkmcnt(6)
    ds_read_b128 a[212:215], v1 offset:45568
    ds_read_b128 a[208:211], v1 offset:45056
    v_mfma_f32_16x16x32_bf16 a[152:155], a[248:251], v[16:19], a[152:155]
    s_waitcnt lgkmcnt(4)
    v_cvt_pk_bf16_f32 v24, v24, v25
    v_add_f32 v117, v117, v26
    v_mfma_f32_16x16x32_bf16 a[156:159], a[252:255], v[16:19], a[156:159]
    v_exp_f32 v28, v28
    v_mfma_f32_16x16x32_bf16 v[40:43], a[192:195], v[192:195], 0
    v_add_f32 v117, v117, v27
    v_cvt_pk_bf16_f32 v25, v26, v27
    v_mfma_f32_16x16x32_bf16 v[40:43], a[196:199], v[196:199], v[40:43]
    v_exp_f32 v29, v29
    v_mfma_f32_16x16x32_bf16 v[40:43], a[200:203], v[200:203], v[40:43]
    v_add_f32 v117, v117, v28
    v_add_f32 v117, v117, v29
    v_mfma_f32_16x16x32_bf16 v[40:43], a[204:207], v[204:207], v[40:43]
    s_waitcnt lgkmcnt(3)
    v_exp_f32 v30, v30
    v_mfma_f32_16x16x32_bf16 v[44:47], a[220:223], v[204:207], 0
    s_waitcnt lgkmcnt(2)
    v_exp_f32 v31, v31
    v_mfma_f32_16x16x32_bf16 v[44:47], a[216:219], v[200:203], v[44:47]
    s_waitcnt lgkmcnt(1)
    v_cvt_pk_bf16_f32 v26, v28, v29
    v_add_f32 v117, v117, v30
    v_mfma_f32_16x16x32_bf16 v[44:47], a[212:215], v[196:199], v[44:47]
    s_waitcnt lgkmcnt(0)
    v_add_f32 v117, v117, v31
    v_cvt_pk_bf16_f32 v27, v30, v31
    v_mfma_f32_16x16x32_bf16 v[44:47], a[208:211], v[192:195], v[44:47]
    v_exp_f32 v32, v32
    v_mfma_f32_16x16x32_bf16 a[160:163], a[224:227], v[24:27], a[160:163]
    v_exp_f32 v33, v33
    v_mfma_f32_16x16x32_bf16 a[164:167], a[228:231], v[24:27], a[164:167]
    v_add_f32 v118, v118, v32
    v_add_f32 v118, v118, v33
    v_mfma_f32_16x16x32_bf16 a[168:171], a[232:235], v[24:27], a[168:171]
    v_exp_f32 v34, v34
    v_mfma_f32_16x16x32_bf16 a[172:175], a[236:239], v[24:27], a[172:175]
    v_exp_f32 v35, v35
    v_mfma_f32_16x16x32_bf16 a[176:179], a[240:243], v[24:27], a[176:179]
    v_cvt_pk_bf16_f32 v32, v32, v33
    v_add_f32 v118, v118, v34
    v_mfma_f32_16x16x32_bf16 a[180:183], a[244:247], v[24:27], a[180:183]
    v_exp_f32 v36, v36
    v_mfma_f32_16x16x32_bf16 a[184:187], a[248:251], v[24:27], a[184:187]
    v_add_f32 v118, v118, v35
    v_cvt_pk_bf16_f32 v33, v34, v35
    v_mfma_f32_16x16x32_bf16 a[188:191], a[252:255], v[24:27], a[188:191]
    v_exp_f32 v37, v37
    v_mfma_f32_16x16x32_bf16 v[16:19], a[192:195], v[208:211], 0
    v_add_f32 v118, v118, v36
    v_add_f32 v118, v118, v37
    v_mfma_f32_16x16x32_bf16 v[16:19], a[196:199], v[212:215], v[16:19]
    v_exp_f32 v38, v38
    v_mfma_f32_16x16x32_bf16 v[16:19], a[200:203], v[216:219], v[16:19]
    v_exp_f32 v39, v39
    v_mfma_f32_16x16x32_bf16 v[16:19], a[204:207], v[220:223], v[16:19]
    v_cvt_pk_bf16_f32 v34, v36, v37
    v_add_f32 v118, v118, v38
    v_mfma_f32_16x16x32_bf16 v[20:23], a[220:223], v[220:223], 0
    v_add_f32 v118, v118, v39
    v_cvt_pk_bf16_f32 v35, v38, v39
    v_mfma_f32_16x16x32_bf16 v[20:23], a[216:219], v[216:219], v[20:23]
    v_exp_f32 v40, v40
    v_exp_f32 v41, v41
    v_mfma_f32_16x16x32_bf16 v[20:23], a[212:215], v[212:215], v[20:23]
    v_add_f32 v116, v116, v40
    v_add_f32 v116, v116, v41
    v_exp_f32 v42, v42
    v_mfma_f32_16x16x32_bf16 v[20:23], a[208:211], v[208:211], v[20:23]
    v_exp_f32 v43, v43
    v_cvt_pk_bf16_f32 v40, v40, v41
    v_add_f32 v116, v116, v42
    v_mfma_f32_16x16x32_bf16 v[48:51], a[224:227], v[32:35], v[48:51]
    ds_read_b64_tr_b16 a[224:225], v2 offset:40960
    ds_read_b64_tr_b16 a[226:227], v2 offset:45056
    v_mfma_f32_16x16x32_bf16 v[52:55], a[228:231], v[32:35], v[52:55]
    v_exp_f32 v44, v44
    v_add_f32 v116, v116, v43
    v_cvt_pk_bf16_f32 v41, v42, v43
    v_mfma_f32_16x16x32_bf16 v[56:59], a[232:235], v[32:35], v[56:59]
    ds_read_b64_tr_b16 a[228:229], v2 offset:41216
    ds_read_b64_tr_b16 a[230:231], v2 offset:45312
    v_mfma_f32_16x16x32_bf16 v[60:63], a[236:239], v[32:35], v[60:63]
    v_exp_f32 v45, v45
    v_add_f32 v116, v116, v44
    v_add_f32 v116, v116, v45
    v_mfma_f32_16x16x32_bf16 v[64:67], a[240:243], v[32:35], v[64:67]
    ds_read_b64_tr_b16 a[232:233], v2 offset:41472
    ds_read_b64_tr_b16 a[234:235], v2 offset:45568
    v_mfma_f32_16x16x32_bf16 v[68:71], a[244:247], v[32:35], v[68:71]
    v_exp_f32 v46, v46
    v_exp_f32 v47, v47
    v_mfma_f32_16x16x32_bf16 v[72:75], a[248:251], v[32:35], v[72:75]
    ds_read_b64_tr_b16 a[236:237], v2 offset:41728
    ds_read_b64_tr_b16 a[238:239], v2 offset:45824
    v_mfma_f32_16x16x32_bf16 v[76:79], a[252:255], v[32:35], v[76:79]
    v_cvt_pk_bf16_f32 v42, v44, v45
    v_add_f32 v116, v116, v46
    v_mfma_f32_16x16x32_bf16 v[24:27], a[192:195], v[224:227], 0
    ds_read_b64_tr_b16 a[240:241], v2 offset:41984
    ds_read_b64_tr_b16 a[242:243], v2 offset:46080
    v_mfma_f32_16x16x32_bf16 v[24:27], a[196:199], v[228:231], v[24:27]
    ds_read_b128 a[192:195], v1 offset:49152
    ds_read_b128 a[196:199], v1 offset:49664
    v_mfma_f32_16x16x32_bf16 v[24:27], a[200:203], v[232:235], v[24:27]
    ds_read_b64_tr_b16 a[244:245], v2 offset:42240
    ds_read_b64_tr_b16 a[246:247], v2 offset:46336
    v_mfma_f32_16x16x32_bf16 v[24:27], a[204:207], v[236:239], v[24:27]
    v_add_f32 v116, v116, v47
    v_cvt_pk_bf16_f32 v43, v46, v47
    v_mfma_f32_16x16x32_bf16 v[28:31], a[220:223], v[236:239], 0
    ds_read_b64_tr_b16 a[248:249], v2 offset:42496
    ds_read_b64_tr_b16 a[250:251], v2 offset:46592
    v_mfma_f32_16x16x32_bf16 v[28:31], a[216:219], v[232:235], v[28:31]
    ds_read_b128 a[200:203], v1 offset:50176
    ds_read_b128 a[204:207], v1 offset:50688
    v_mfma_f32_16x16x32_bf16 v[28:31], a[212:215], v[228:231], v[28:31]
    ds_read_b64_tr_b16 a[252:253], v2 offset:42752
    ds_read_b64_tr_b16 a[254:255], v2 offset:46848
    v_mfma_f32_16x16x32_bf16 v[28:31], a[208:211], v[224:227], v[28:31]
    s_waitcnt lgkmcnt(15)
    v_exp_f32 v16, v16
    v_mfma_f32_16x16x32_bf16 a[128:131], a[224:227], v[40:43], a[128:131]
    v_exp_f32 v17, v17
    v_mfma_f32_16x16x32_bf16 a[132:135], a[228:231], v[40:43], a[132:135]
    s_waitcnt lgkmcnt(14)
    ds_read_b128 a[220:223], v1 offset:54784
    ds_read_b128 a[216:219], v1 offset:54272
    v_mfma_f32_16x16x32_bf16 a[136:139], a[232:235], v[40:43], a[136:139]
    s_waitcnt lgkmcnt(14)
    v_add_f32 v117, v117, v16
    v_add_f32 v117, v117, v17
    v_mfma_f32_16x16x32_bf16 a[140:143], a[236:239], v[40:43], a[140:143]
    s_waitcnt lgkmcnt(12)
    v_exp_f32 v18, v18
    v_mfma_f32_16x16x32_bf16 a[144:147], a[240:243], v[40:43], a[144:147]
    s_waitcnt lgkmcnt(8)
    v_exp_f32 v19, v19
    v_mfma_f32_16x16x32_bf16 a[148:151], a[244:247], v[40:43], a[148:151]
    s_waitcnt lgkmcnt(6)
    ds_read_b128 a[212:215], v1 offset:53760
    ds_read_b128 a[208:211], v1 offset:53248
    v_mfma_f32_16x16x32_bf16 a[152:155], a[248:251], v[40:43], a[152:155]
    s_waitcnt lgkmcnt(4)
    v_cvt_pk_bf16_f32 v16, v16, v17
    v_add_f32 v117, v117, v18
    v_mfma_f32_16x16x32_bf16 a[156:159], a[252:255], v[40:43], a[156:159]
    v_exp_f32 v20, v20
    v_mfma_f32_16x16x32_bf16 v[32:35], a[192:195], v[192:195], 0
    v_add_f32 v117, v117, v19
    v_cvt_pk_bf16_f32 v17, v18, v19
    v_mfma_f32_16x16x32_bf16 v[32:35], a[196:199], v[196:199], v[32:35]
    v_exp_f32 v21, v21
    v_mfma_f32_16x16x32_bf16 v[32:35], a[200:203], v[200:203], v[32:35]
    v_add_f32 v117, v117, v20
    v_add_f32 v117, v117, v21
    v_mfma_f32_16x16x32_bf16 v[32:35], a[204:207], v[204:207], v[32:35]
    s_waitcnt lgkmcnt(3)
    v_exp_f32 v22, v22
    v_mfma_f32_16x16x32_bf16 v[36:39], a[220:223], v[204:207], 0
    s_waitcnt lgkmcnt(2)
    v_exp_f32 v23, v23
    v_mfma_f32_16x16x32_bf16 v[36:39], a[216:219], v[200:203], v[36:39]
    s_waitcnt lgkmcnt(1)
    v_cvt_pk_bf16_f32 v18, v20, v21
    v_add_f32 v117, v117, v22
    v_mfma_f32_16x16x32_bf16 v[36:39], a[212:215], v[196:199], v[36:39]
    s_waitcnt lgkmcnt(0)
    v_add_f32 v117, v117, v23
    v_cvt_pk_bf16_f32 v19, v22, v23
    v_mfma_f32_16x16x32_bf16 v[36:39], a[208:211], v[192:195], v[36:39]
    v_exp_f32 v24, v24
    v_mfma_f32_16x16x32_bf16 a[160:163], a[224:227], v[16:19], a[160:163]
    v_exp_f32 v25, v25
    v_mfma_f32_16x16x32_bf16 a[164:167], a[228:231], v[16:19], a[164:167]
    v_add_f32 v118, v118, v24
    v_add_f32 v118, v118, v25
    v_mfma_f32_16x16x32_bf16 a[168:171], a[232:235], v[16:19], a[168:171]
    v_exp_f32 v26, v26
    v_mfma_f32_16x16x32_bf16 a[172:175], a[236:239], v[16:19], a[172:175]
    v_exp_f32 v27, v27
    v_mfma_f32_16x16x32_bf16 a[176:179], a[240:243], v[16:19], a[176:179]
    v_cvt_pk_bf16_f32 v24, v24, v25
    v_add_f32 v118, v118, v26
    v_mfma_f32_16x16x32_bf16 a[180:183], a[244:247], v[16:19], a[180:183]
    v_exp_f32 v28, v28
    v_mfma_f32_16x16x32_bf16 a[184:187], a[248:251], v[16:19], a[184:187]
    v_add_f32 v118, v118, v27
    v_cvt_pk_bf16_f32 v25, v26, v27
    v_mfma_f32_16x16x32_bf16 a[188:191], a[252:255], v[16:19], a[188:191]
    v_exp_f32 v29, v29
    v_mfma_f32_16x16x32_bf16 v[40:43], a[192:195], v[208:211], 0
    v_add_f32 v118, v118, v28
    v_add_f32 v118, v118, v29
    v_mfma_f32_16x16x32_bf16 v[40:43], a[196:199], v[212:215], v[40:43]
    v_exp_f32 v30, v30
    v_mfma_f32_16x16x32_bf16 v[40:43], a[200:203], v[216:219], v[40:43]
    v_exp_f32 v31, v31
    v_mfma_f32_16x16x32_bf16 v[40:43], a[204:207], v[220:223], v[40:43]
    v_cvt_pk_bf16_f32 v26, v28, v29
    v_add_f32 v118, v118, v30
    v_mfma_f32_16x16x32_bf16 v[44:47], a[220:223], v[220:223], 0
    v_add_f32 v118, v118, v31
    v_cvt_pk_bf16_f32 v27, v30, v31
    v_mfma_f32_16x16x32_bf16 v[44:47], a[216:219], v[216:219], v[44:47]
    v_exp_f32 v32, v32
    v_exp_f32 v33, v33
    v_mfma_f32_16x16x32_bf16 v[44:47], a[212:215], v[212:215], v[44:47]
    v_add_f32 v116, v116, v32
    v_add_f32 v116, v116, v33
    v_exp_f32 v34, v34
    v_mfma_f32_16x16x32_bf16 v[44:47], a[208:211], v[208:211], v[44:47]
    v_exp_f32 v35, v35
    v_cvt_pk_bf16_f32 v32, v32, v33
    v_add_f32 v116, v116, v34
    v_mfma_f32_16x16x32_bf16 v[48:51], a[224:227], v[24:27], v[48:51]
    ds_read_b64_tr_b16 a[224:225], v2 offset:49152
    ds_read_b64_tr_b16 a[226:227], v2 offset:53248
    v_mfma_f32_16x16x32_bf16 v[52:55], a[228:231], v[24:27], v[52:55]
    v_exp_f32 v36, v36
    v_add_f32 v116, v116, v35
    v_cvt_pk_bf16_f32 v33, v34, v35
    v_mfma_f32_16x16x32_bf16 v[56:59], a[232:235], v[24:27], v[56:59]
    ds_read_b64_tr_b16 a[228:229], v2 offset:49408
    ds_read_b64_tr_b16 a[230:231], v2 offset:53504
    v_mfma_f32_16x16x32_bf16 v[60:63], a[236:239], v[24:27], v[60:63]
    v_exp_f32 v37, v37
    v_add_f32 v116, v116, v36
    v_add_f32 v116, v116, v37
    v_mfma_f32_16x16x32_bf16 v[64:67], a[240:243], v[24:27], v[64:67]
    ds_read_b64_tr_b16 a[232:233], v2 offset:49664
    ds_read_b64_tr_b16 a[234:235], v2 offset:53760
    v_mfma_f32_16x16x32_bf16 v[68:71], a[244:247], v[24:27], v[68:71]
    v_exp_f32 v38, v38
    v_exp_f32 v39, v39
    v_mfma_f32_16x16x32_bf16 v[72:75], a[248:251], v[24:27], v[72:75]
    ds_read_b64_tr_b16 a[236:237], v2 offset:49920
    ds_read_b64_tr_b16 a[238:239], v2 offset:54016
    v_mfma_f32_16x16x32_bf16 v[76:79], a[252:255], v[24:27], v[76:79]
    v_cvt_pk_bf16_f32 v34, v36, v37
    v_add_f32 v116, v116, v38
    v_mfma_f32_16x16x32_bf16 v[16:19], a[192:195], v[224:227], 0
    ds_read_b64_tr_b16 a[240:241], v2 offset:50176
    ds_read_b64_tr_b16 a[242:243], v2 offset:54272
    v_mfma_f32_16x16x32_bf16 v[16:19], a[196:199], v[228:231], v[16:19]
    ds_read_b128 a[192:195], v1 offset:57344
    ds_read_b128 a[196:199], v1 offset:57856
    v_mfma_f32_16x16x32_bf16 v[16:19], a[200:203], v[232:235], v[16:19]
    ds_read_b64_tr_b16 a[244:245], v2 offset:50432
    ds_read_b64_tr_b16 a[246:247], v2 offset:54528
    v_mfma_f32_16x16x32_bf16 v[16:19], a[204:207], v[236:239], v[16:19]
    v_add_f32 v116, v116, v39
    v_cvt_pk_bf16_f32 v35, v38, v39
    v_mfma_f32_16x16x32_bf16 v[20:23], a[220:223], v[236:239], 0
    ds_read_b64_tr_b16 a[248:249], v2 offset:50688
    ds_read_b64_tr_b16 a[250:251], v2 offset:54784
    v_mfma_f32_16x16x32_bf16 v[20:23], a[216:219], v[232:235], v[20:23]
    ds_read_b128 a[200:203], v1 offset:58368
    ds_read_b128 a[204:207], v1 offset:58880
    v_mfma_f32_16x16x32_bf16 v[20:23], a[212:215], v[228:231], v[20:23]
    ds_read_b64_tr_b16 a[252:253], v2 offset:50944
    ds_read_b64_tr_b16 a[254:255], v2 offset:55040
    v_mfma_f32_16x16x32_bf16 v[20:23], a[208:211], v[224:227], v[20:23]
    s_waitcnt lgkmcnt(15)
    v_exp_f32 v40, v40
    v_mfma_f32_16x16x32_bf16 a[128:131], a[224:227], v[32:35], a[128:131]
    v_exp_f32 v41, v41
    v_mfma_f32_16x16x32_bf16 a[132:135], a[228:231], v[32:35], a[132:135]
    s_waitcnt lgkmcnt(14)
    ds_read_b128 a[220:223], v1 offset:62976
    ds_read_b128 a[216:219], v1 offset:62464
    v_mfma_f32_16x16x32_bf16 a[136:139], a[232:235], v[32:35], a[136:139]
    s_waitcnt lgkmcnt(14)
    v_add_f32 v117, v117, v40
    v_add_f32 v117, v117, v41
    v_mfma_f32_16x16x32_bf16 a[140:143], a[236:239], v[32:35], a[140:143]
    s_waitcnt lgkmcnt(12)
    v_exp_f32 v42, v42
    v_mfma_f32_16x16x32_bf16 a[144:147], a[240:243], v[32:35], a[144:147]
    s_waitcnt lgkmcnt(8)
    v_exp_f32 v43, v43
    v_mfma_f32_16x16x32_bf16 a[148:151], a[244:247], v[32:35], a[148:151]
    s_waitcnt lgkmcnt(6)
    ds_read_b128 a[212:215], v1 offset:61952
    ds_read_b128 a[208:211], v1 offset:61440
    v_mfma_f32_16x16x32_bf16 a[152:155], a[248:251], v[32:35], a[152:155]
    s_waitcnt lgkmcnt(4)
    v_cvt_pk_bf16_f32 v40, v40, v41
    v_add_f32 v117, v117, v42
    v_mfma_f32_16x16x32_bf16 a[156:159], a[252:255], v[32:35], a[156:159]
    v_exp_f32 v44, v44
    v_mfma_f32_16x16x32_bf16 v[24:27], a[192:195], v[192:195], 0
    v_add_f32 v117, v117, v43
    v_cvt_pk_bf16_f32 v41, v42, v43
    v_mfma_f32_16x16x32_bf16 v[24:27], a[196:199], v[196:199], v[24:27]
    v_exp_f32 v45, v45
    v_mfma_f32_16x16x32_bf16 v[24:27], a[200:203], v[200:203], v[24:27]
    v_add_f32 v117, v117, v44
    v_add_f32 v117, v117, v45
    v_mfma_f32_16x16x32_bf16 v[24:27], a[204:207], v[204:207], v[24:27]
    s_waitcnt lgkmcnt(3)
    v_exp_f32 v46, v46
    v_mfma_f32_16x16x32_bf16 v[28:31], a[220:223], v[204:207], 0
    s_waitcnt lgkmcnt(2)
    v_exp_f32 v47, v47
    v_mfma_f32_16x16x32_bf16 v[28:31], a[216:219], v[200:203], v[28:31]
    s_waitcnt lgkmcnt(1)
    v_cvt_pk_bf16_f32 v42, v44, v45
    v_add_f32 v117, v117, v46
    v_mfma_f32_16x16x32_bf16 v[28:31], a[212:215], v[196:199], v[28:31]
    s_waitcnt lgkmcnt(0)
    v_add_f32 v117, v117, v47
    v_cvt_pk_bf16_f32 v43, v46, v47
    v_mfma_f32_16x16x32_bf16 v[28:31], a[208:211], v[192:195], v[28:31]
    v_exp_f32 v16, v16
    v_mfma_f32_16x16x32_bf16 a[160:163], a[224:227], v[40:43], a[160:163]
    v_exp_f32 v17, v17
    v_mfma_f32_16x16x32_bf16 a[164:167], a[228:231], v[40:43], a[164:167]
    v_add_f32 v118, v118, v16
    v_add_f32 v118, v118, v17
    v_mfma_f32_16x16x32_bf16 a[168:171], a[232:235], v[40:43], a[168:171]
    v_exp_f32 v18, v18
    v_mfma_f32_16x16x32_bf16 a[172:175], a[236:239], v[40:43], a[172:175]
    v_exp_f32 v19, v19
    v_mfma_f32_16x16x32_bf16 a[176:179], a[240:243], v[40:43], a[176:179]
    v_cvt_pk_bf16_f32 v16, v16, v17
    v_add_f32 v118, v118, v18
    v_mfma_f32_16x16x32_bf16 a[180:183], a[244:247], v[40:43], a[180:183]
    v_exp_f32 v20, v20
    v_mfma_f32_16x16x32_bf16 a[184:187], a[248:251], v[40:43], a[184:187]
    v_add_f32 v118, v118, v19
    v_cvt_pk_bf16_f32 v17, v18, v19
    v_mfma_f32_16x16x32_bf16 a[188:191], a[252:255], v[40:43], a[188:191]
    v_exp_f32 v21, v21
    v_mfma_f32_16x16x32_bf16 v[32:35], a[192:195], v[208:211], 0
    v_add_f32 v118, v118, v20
    v_add_f32 v118, v118, v21
    v_mfma_f32_16x16x32_bf16 v[32:35], a[196:199], v[212:215], v[32:35]
    v_exp_f32 v22, v22
    v_mfma_f32_16x16x32_bf16 v[32:35], a[200:203], v[216:219], v[32:35]
    v_exp_f32 v23, v23
    v_mfma_f32_16x16x32_bf16 v[32:35], a[204:207], v[220:223], v[32:35]
    v_cvt_pk_bf16_f32 v18, v20, v21
    v_add_f32 v118, v118, v22
    v_mfma_f32_16x16x32_bf16 v[36:39], a[220:223], v[220:223], 0
    v_add_f32 v118, v118, v23
    v_cvt_pk_bf16_f32 v19, v22, v23
    v_mfma_f32_16x16x32_bf16 v[36:39], a[216:219], v[216:219], v[36:39]
    v_exp_f32 v24, v24
    v_exp_f32 v25, v25
    v_mfma_f32_16x16x32_bf16 v[36:39], a[212:215], v[212:215], v[36:39]
    v_add_f32 v116, v116, v24
    v_add_f32 v116, v116, v25
    v_exp_f32 v26, v26
    v_mfma_f32_16x16x32_bf16 v[36:39], a[208:211], v[208:211], v[36:39]
    v_exp_f32 v27, v27
    v_cvt_pk_bf16_f32 v24, v24, v25
    v_add_f32 v116, v116, v26
    v_mfma_f32_16x16x32_bf16 v[48:51], a[224:227], v[16:19], v[48:51]
    ds_read_b64_tr_b16 a[224:225], v2 offset:57344
    ds_read_b64_tr_b16 a[226:227], v2 offset:61440
    v_mfma_f32_16x16x32_bf16 v[52:55], a[228:231], v[16:19], v[52:55]
    v_exp_f32 v28, v28
    v_add_f32 v116, v116, v27
    v_cvt_pk_bf16_f32 v25, v26, v27
    v_mfma_f32_16x16x32_bf16 v[56:59], a[232:235], v[16:19], v[56:59]
    ds_read_b64_tr_b16 a[228:229], v2 offset:57600
    ds_read_b64_tr_b16 a[230:231], v2 offset:61696
    v_mfma_f32_16x16x32_bf16 v[60:63], a[236:239], v[16:19], v[60:63]
    v_exp_f32 v29, v29
    v_add_f32 v116, v116, v28
    v_add_f32 v116, v116, v29
    v_mfma_f32_16x16x32_bf16 v[64:67], a[240:243], v[16:19], v[64:67]
    ds_read_b64_tr_b16 a[232:233], v2 offset:57856
    ds_read_b64_tr_b16 a[234:235], v2 offset:61952
    v_mfma_f32_16x16x32_bf16 v[68:71], a[244:247], v[16:19], v[68:71]
    v_exp_f32 v30, v30
    v_exp_f32 v31, v31
    v_mfma_f32_16x16x32_bf16 v[72:75], a[248:251], v[16:19], v[72:75]
    ds_read_b64_tr_b16 a[236:237], v2 offset:58112
    ds_read_b64_tr_b16 a[238:239], v2 offset:62208
    v_mfma_f32_16x16x32_bf16 v[76:79], a[252:255], v[16:19], v[76:79]
    v_cvt_pk_bf16_f32 v26, v28, v29
    v_add_f32 v116, v116, v30
    v_mfma_f32_16x16x32_bf16 v[40:43], a[192:195], v[224:227], 0
    ds_read_b64_tr_b16 a[240:241], v2 offset:58368
    ds_read_b64_tr_b16 a[242:243], v2 offset:62464
    v_mfma_f32_16x16x32_bf16 v[40:43], a[196:199], v[228:231], v[40:43]
    ds_read_b128 a[192:195], v1 offset:32768
    ds_read_b128 a[196:199], v1 offset:33280
    v_mfma_f32_16x16x32_bf16 v[40:43], a[200:203], v[232:235], v[40:43]
    ds_read_b64_tr_b16 a[244:245], v2 offset:58624
    ds_read_b64_tr_b16 a[246:247], v2 offset:62720
    v_mfma_f32_16x16x32_bf16 v[40:43], a[204:207], v[236:239], v[40:43]
    v_add_f32 v116, v116, v31
    v_cvt_pk_bf16_f32 v27, v30, v31
    v_mfma_f32_16x16x32_bf16 v[44:47], a[220:223], v[236:239], 0
    ds_read_b64_tr_b16 a[248:249], v2 offset:58880
    ds_read_b64_tr_b16 a[250:251], v2 offset:62976
    v_mfma_f32_16x16x32_bf16 v[44:47], a[216:219], v[232:235], v[44:47]
    ds_read_b128 a[200:203], v1 offset:33792
    ds_read_b128 a[204:207], v1 offset:34304
    v_mfma_f32_16x16x32_bf16 v[44:47], a[212:215], v[228:231], v[44:47]
    ds_read_b64_tr_b16 a[252:253], v2 offset:59136
    ds_read_b64_tr_b16 a[254:255], v2 offset:63232
    v_mfma_f32_16x16x32_bf16 v[44:47], a[208:211], v[224:227], v[44:47]
    s_waitcnt lgkmcnt(15)
    v_exp_f32 v32, v32
    v_exp_f32 v33, v33
    v_mfma_f32_16x16x32_bf16 a[128:131], a[224:227], v[24:27], a[128:131]
    v_add_f32 v117, v117, v32
    v_add_f32 v117, v117, v33
    v_exp_f32 v34, v34
    v_mfma_f32_16x16x32_bf16 a[132:135], a[228:231], v[24:27], a[132:135]
    s_waitcnt lgkmcnt(14)
    ds_read_b128 a[220:223], v1 offset:38400
    ds_read_b128 a[216:219], v1 offset:37888
    v_mfma_f32_16x16x32_bf16 a[136:139], a[232:235], v[24:27], a[136:139]
    s_waitcnt lgkmcnt(14)
    v_exp_f32 v35, v35
    v_mfma_f32_16x16x32_bf16 a[140:143], a[236:239], v[24:27], a[140:143]
    s_waitcnt lgkmcnt(12)
    v_cvt_pk_bf16_f32 v32, v32, v33
    v_add_f32 v117, v117, v34
    v_mfma_f32_16x16x32_bf16 a[144:147], a[240:243], v[24:27], a[144:147]
    s_waitcnt lgkmcnt(8)
    v_exp_f32 v36, v36
    v_mfma_f32_16x16x32_bf16 a[148:151], a[244:247], v[24:27], a[148:151]
    s_waitcnt lgkmcnt(6)
    ds_read_b128 a[212:215], v1 offset:37376
    ds_read_b128 a[208:211], v1 offset:36864
    v_mfma_f32_16x16x32_bf16 a[152:155], a[248:251], v[24:27], a[152:155]
    s_waitcnt lgkmcnt(4)
    v_add_f32 v117, v117, v35
    v_cvt_pk_bf16_f32 v33, v34, v35
    v_mfma_f32_16x16x32_bf16 a[156:159], a[252:255], v[24:27], a[156:159]
    v_exp_f32 v37, v37
    v_mfma_f32_16x16x32_bf16 v[16:19], a[192:195], v[240:243], v[124:127]
    v_add_f32 v117, v117, v36
    v_add_f32 v117, v117, v37
    v_mfma_f32_16x16x32_bf16 v[16:19], a[196:199], v[244:247], v[16:19]
    ds_read_b128 a[192:195], v1 offset:40960
    ds_read_b128 a[196:199], v1 offset:41472
    v_mfma_f32_16x16x32_bf16 v[16:19], a[200:203], v[248:251], v[16:19]
    v_exp_f32 v38, v38
    v_mov_b32 v8, v116
    v_accvgpr_read_b32 v192, a128
    v_accvgpr_read_b32 v193, a129
    v_permlane16_swap_b32 v8, v116
    v_add_f32 v116, v116, v8
    v_mov_b32 v8, v116
    v_accvgpr_read_b32 v194, a130
    v_accvgpr_read_b32 v195, a131
    v_permlane32_swap_b32 v8, v116
    v_add_f32 v116, v116, v8
    v_subrev_u32 v8, 0x33800000, v116
    v_cmp_lt_u32 vcc, 0x20000000, v8
    v_rcp_f32 v116, v116
    s_cbranch_vccnz L_fallback
    v_accvgpr_read_b32 v196, a132
    v_accvgpr_read_b32 v197, a133
    v_accvgpr_read_b32 v198, a134
    v_accvgpr_read_b32 v199, a135
    v_add_u32 v7, 16384, v6
    v_pk_mul_f32 v[192:193], v[192:193], v[116:117] op_sel_hi:[1,0]
    v_pk_mul_f32 v[194:195], v[194:195], v[116:117] op_sel_hi:[1,0]
    v_pk_mul_f32 v[196:197], v[196:197], v[116:117] op_sel_hi:[1,0]
    v_pk_mul_f32 v[198:199], v[198:199], v[116:117] op_sel_hi:[1,0]
    v_cvt_pk_bf16_f32 v192, v192, v193
    v_cvt_pk_bf16_f32 v193, v194, v195
    v_cvt_pk_bf16_f32 v194, v196, v197
    v_cvt_pk_bf16_f32 v195, v198, v199
    v_accvgpr_read_b32 v200, a136
    v_accvgpr_read_b32 v201, a137
    v_permlane16_swap_b32 v192, v194
    v_permlane16_swap_b32 v193, v195
    buffer_store_dwordx4 v[192:195], v7, s[20:23], 0 offen sc0 nt sc1
    v_accvgpr_read_b32 v202, a138
    v_accvgpr_read_b32 v203, a139
    v_accvgpr_read_b32 v204, a140
    v_accvgpr_read_b32 v205, a141
    v_accvgpr_read_b32 v206, a142
    v_accvgpr_read_b32 v207, a143
    v_pk_mul_f32 v[200:201], v[200:201], v[116:117] op_sel_hi:[1,0]
    v_pk_mul_f32 v[202:203], v[202:203], v[116:117] op_sel_hi:[1,0]
    v_pk_mul_f32 v[204:205], v[204:205], v[116:117] op_sel_hi:[1,0]
    v_pk_mul_f32 v[206:207], v[206:207], v[116:117] op_sel_hi:[1,0]
    v_cvt_pk_bf16_f32 v200, v200, v201
    v_cvt_pk_bf16_f32 v201, v202, v203
    v_cvt_pk_bf16_f32 v202, v204, v205
    v_cvt_pk_bf16_f32 v203, v206, v207
    v_accvgpr_read_b32 v196, a148
    v_accvgpr_read_b32 v197, a149
    v_permlane16_swap_b32 v200, v202
    v_permlane16_swap_b32 v201, v203
    buffer_store_dwordx4 v[200:203], v7, s[20:23], 0 offen offset:64 sc0 nt sc1
    v_accvgpr_read_b32 v198, a150
    v_accvgpr_read_b32 v199, a151
    v_accvgpr_read_b32 v192, a144
    v_accvgpr_read_b32 v193, a145
    v_accvgpr_read_b32 v194, a146
    v_accvgpr_read_b32 v195, a147
    v_pk_mul_f32 v[192:193], v[192:193], v[116:117] op_sel_hi:[1,0]
    v_pk_mul_f32 v[194:195], v[194:195], v[116:117] op_sel_hi:[1,0]
    v_pk_mul_f32 v[196:197], v[196:197], v[116:117] op_sel_hi:[1,0]
    v_pk_mul_f32 v[198:199], v[198:199], v[116:117] op_sel_hi:[1,0]
    v_cvt_pk_bf16_f32 v192, v192, v193
    v_cvt_pk_bf16_f32 v193, v194, v195
    v_cvt_pk_bf16_f32 v194, v196, v197
    v_cvt_pk_bf16_f32 v195, v198, v199
    v_accvgpr_read_b32 v204, a156
    v_accvgpr_read_b32 v205, a157
    v_permlane16_swap_b32 v192, v194
    v_permlane16_swap_b32 v193, v195
    buffer_store_dwordx4 v[192:195], v7, s[20:23], 0 offen offset:128 sc0 nt sc1
    v_accvgpr_read_b32 v206, a158
    v_accvgpr_read_b32 v207, a159
    v_accvgpr_read_b32 v200, a152
    v_accvgpr_read_b32 v201, a153
    v_accvgpr_read_b32 v202, a154
    v_accvgpr_read_b32 v203, a155
    v_pk_mul_f32 v[200:201], v[200:201], v[116:117] op_sel_hi:[1,0]
    v_pk_mul_f32 v[202:203], v[202:203], v[116:117] op_sel_hi:[1,0]
    v_pk_mul_f32 v[204:205], v[204:205], v[116:117] op_sel_hi:[1,0]
    v_pk_mul_f32 v[206:207], v[206:207], v[116:117] op_sel_hi:[1,0]
    v_cvt_pk_bf16_f32 v200, v200, v201
    v_cvt_pk_bf16_f32 v201, v202, v203
    v_cvt_pk_bf16_f32 v202, v204, v205
    v_cvt_pk_bf16_f32 v203, v206, v207
    s_nop 1
    v_permlane16_swap_b32 v200, v202
    v_permlane16_swap_b32 v201, v203
    buffer_store_dwordx4 v[200:203], v7, s[20:23], 0 offen offset:192 sc0 nt sc1
    v_mfma_f32_16x16x32_bf16 v[16:19], a[204:207], v[252:255], v[16:19]
    s_waitcnt lgkmcnt(5)
    v_exp_f32 v39, v39
    v_mfma_f32_16x16x32_bf16 v[20:23], a[220:223], v[252:255], v[124:127]
    s_waitcnt lgkmcnt(4)
    v_cvt_pk_bf16_f32 v34, v36, v37
    v_add_f32 v117, v117, v38
    v_mfma_f32_16x16x32_bf16 v[20:23], a[216:219], v[248:251], v[20:23]
    s_waitcnt lgkmcnt(3)
    ds_read_b128 a[200:203], v1 offset:41984
    ds_read_b128 a[204:207], v1 offset:42496
    v_mfma_f32_16x16x32_bf16 v[20:23], a[212:215], v[244:247], v[20:23]
    s_waitcnt lgkmcnt(4)
    v_add_f32 v117, v117, v39
    v_cvt_pk_bf16_f32 v35, v38, v39
    v_mfma_f32_16x16x32_bf16 v[20:23], a[208:211], v[240:243], v[20:23]
    v_exp_f32 v40, v40
    v_exp_f32 v41, v41
    v_mfma_f32_16x16x32_bf16 a[160:163], a[224:227], v[32:35], a[160:163]
    v_add_f32 v118, v118, v40
    v_add_f32 v118, v118, v41
    v_exp_f32 v42, v42
    v_mfma_f32_16x16x32_bf16 a[164:167], a[228:231], v[32:35], a[164:167]
    ds_read_b128 a[220:223], v1 offset:46592
    ds_read_b128 a[216:219], v1 offset:46080
    v_mfma_f32_16x16x32_bf16 a[168:171], a[232:235], v[32:35], a[168:171]
    v_exp_f32 v43, v43
    v_mfma_f32_16x16x32_bf16 a[172:175], a[236:239], v[32:35], a[172:175]
    v_cvt_pk_bf16_f32 v40, v40, v41
    v_add_f32 v118, v118, v42
    v_mfma_f32_16x16x32_bf16 a[176:179], a[240:243], v[32:35], a[176:179]
    v_exp_f32 v44, v44
    v_mfma_f32_16x16x32_bf16 a[180:183], a[244:247], v[32:35], a[180:183]
    ds_read_b128 a[212:215], v1 offset:45568
    ds_read_b128 a[208:211], v1 offset:45056
    v_mfma_f32_16x16x32_bf16 a[184:187], a[248:251], v[32:35], a[184:187]
    v_add_f32 v118, v118, v43
    v_cvt_pk_bf16_f32 v41, v42, v43
    v_mfma_f32_16x16x32_bf16 a[188:191], a[252:255], v[32:35], a[188:191]
    s_waitcnt lgkmcnt(7)
    v_exp_f32 v45, v45
    v_mfma_f32_16x16x32_bf16 v[24:27], a[192:195], v[240:243], v[124:127]
    s_waitcnt lgkmcnt(6)
    v_add_f32 v118, v118, v44
    v_add_f32 v118, v118, v45
    v_mfma_f32_16x16x32_bf16 v[24:27], a[196:199], v[244:247], v[24:27]
    s_waitcnt lgkmcnt(5)
    ds_read_b128 a[192:195], v1 offset:49152
    ds_read_b128 a[196:199], v1 offset:49664
    v_mov_b32 v8, v117
    v_accvgpr_read_b32 v208, a160
    v_accvgpr_read_b32 v209, a161
    v_permlane16_swap_b32 v8, v117
    v_add_f32 v117, v117, v8
    v_mov_b32 v8, v117
    v_accvgpr_read_b32 v210, a162
    v_accvgpr_read_b32 v211, a163
    v_permlane32_swap_b32 v8, v117
    v_add_f32 v117, v117, v8
    v_subrev_u32 v8, 0x33800000, v117
    v_cmp_lt_u32 vcc, 0x20000000, v8
    v_rcp_f32 v117, v117
    s_cbranch_vccnz L_fallback
    v_accvgpr_read_b32 v212, a164
    v_accvgpr_read_b32 v213, a165
    v_accvgpr_read_b32 v214, a166
    v_accvgpr_read_b32 v215, a167
    v_add_u32 v7, 20480, v6
    v_pk_mul_f32 v[208:209], v[208:209], v[116:117] op_sel:[0,1] op_sel_hi:[1,1]
    v_pk_mul_f32 v[210:211], v[210:211], v[116:117] op_sel:[0,1] op_sel_hi:[1,1]
    v_pk_mul_f32 v[212:213], v[212:213], v[116:117] op_sel:[0,1] op_sel_hi:[1,1]
    v_pk_mul_f32 v[214:215], v[214:215], v[116:117] op_sel:[0,1] op_sel_hi:[1,1]
    v_cvt_pk_bf16_f32 v208, v208, v209
    v_cvt_pk_bf16_f32 v209, v210, v211
    v_cvt_pk_bf16_f32 v210, v212, v213
    v_cvt_pk_bf16_f32 v211, v214, v215
    v_accvgpr_read_b32 v216, a168
    v_accvgpr_read_b32 v217, a169
    v_permlane16_swap_b32 v208, v210
    v_permlane16_swap_b32 v209, v211
    buffer_store_dwordx4 v[208:211], v7, s[20:23], 0 offen sc0 nt sc1
    v_accvgpr_read_b32 v218, a170
    v_accvgpr_read_b32 v219, a171
    v_accvgpr_read_b32 v220, a172
    v_accvgpr_read_b32 v221, a173
    v_accvgpr_read_b32 v222, a174
    v_accvgpr_read_b32 v223, a175
    v_pk_mul_f32 v[216:217], v[216:217], v[116:117] op_sel:[0,1] op_sel_hi:[1,1]
    v_pk_mul_f32 v[218:219], v[218:219], v[116:117] op_sel:[0,1] op_sel_hi:[1,1]
    v_pk_mul_f32 v[220:221], v[220:221], v[116:117] op_sel:[0,1] op_sel_hi:[1,1]
    v_pk_mul_f32 v[222:223], v[222:223], v[116:117] op_sel:[0,1] op_sel_hi:[1,1]
    v_cvt_pk_bf16_f32 v216, v216, v217
    v_cvt_pk_bf16_f32 v217, v218, v219
    v_cvt_pk_bf16_f32 v218, v220, v221
    v_cvt_pk_bf16_f32 v219, v222, v223
    v_accvgpr_read_b32 v212, a180
    v_accvgpr_read_b32 v213, a181
    v_permlane16_swap_b32 v216, v218
    v_permlane16_swap_b32 v217, v219
    buffer_store_dwordx4 v[216:219], v7, s[20:23], 0 offen offset:64 sc0 nt sc1
    v_accvgpr_read_b32 v214, a182
    v_accvgpr_read_b32 v215, a183
    v_accvgpr_read_b32 v208, a176
    v_accvgpr_read_b32 v209, a177
    v_accvgpr_read_b32 v210, a178
    v_accvgpr_read_b32 v211, a179
    v_pk_mul_f32 v[208:209], v[208:209], v[116:117] op_sel:[0,1] op_sel_hi:[1,1]
    v_pk_mul_f32 v[210:211], v[210:211], v[116:117] op_sel:[0,1] op_sel_hi:[1,1]
    v_pk_mul_f32 v[212:213], v[212:213], v[116:117] op_sel:[0,1] op_sel_hi:[1,1]
    v_pk_mul_f32 v[214:215], v[214:215], v[116:117] op_sel:[0,1] op_sel_hi:[1,1]
    v_cvt_pk_bf16_f32 v208, v208, v209
    v_cvt_pk_bf16_f32 v209, v210, v211
    v_cvt_pk_bf16_f32 v210, v212, v213
    v_cvt_pk_bf16_f32 v211, v214, v215
    v_accvgpr_read_b32 v220, a188
    v_accvgpr_read_b32 v221, a189
    v_permlane16_swap_b32 v208, v210
    v_permlane16_swap_b32 v209, v211
    buffer_store_dwordx4 v[208:211], v7, s[20:23], 0 offen offset:128 sc0 nt sc1
    v_accvgpr_read_b32 v222, a190
    v_accvgpr_read_b32 v223, a191
    v_accvgpr_read_b32 v216, a184
    v_accvgpr_read_b32 v217, a185
    v_accvgpr_read_b32 v218, a186
    v_accvgpr_read_b32 v219, a187
    v_pk_mul_f32 v[216:217], v[216:217], v[116:117] op_sel:[0,1] op_sel_hi:[1,1]
    v_pk_mul_f32 v[218:219], v[218:219], v[116:117] op_sel:[0,1] op_sel_hi:[1,1]
    v_pk_mul_f32 v[220:221], v[220:221], v[116:117] op_sel:[0,1] op_sel_hi:[1,1]
    v_pk_mul_f32 v[222:223], v[222:223], v[116:117] op_sel:[0,1] op_sel_hi:[1,1]
    v_cvt_pk_bf16_f32 v216, v216, v217
    v_cvt_pk_bf16_f32 v217, v218, v219
    v_cvt_pk_bf16_f32 v218, v220, v221
    v_cvt_pk_bf16_f32 v219, v222, v223
    s_nop 1
    v_permlane16_swap_b32 v216, v218
    v_permlane16_swap_b32 v217, v219
    buffer_store_dwordx4 v[216:219], v7, s[20:23], 0 offen offset:192 sc0 nt sc1
    v_mfma_f32_16x16x32_bf16 v[24:27], a[200:203], v[248:251], v[24:27]
    s_waitcnt lgkmcnt(6)
    v_exp_f32 v46, v46
    v_mfma_f32_16x16x32_bf16 v[24:27], a[204:207], v[252:255], v[24:27]
    s_waitcnt lgkmcnt(5)
    v_exp_f32 v47, v47
    v_mfma_f32_16x16x32_bf16 v[28:31], a[220:223], v[252:255], v[124:127]
    s_waitcnt lgkmcnt(4)
    v_cvt_pk_bf16_f32 v42, v44, v45
    v_add_f32 v118, v118, v46
    v_mfma_f32_16x16x32_bf16 v[28:31], a[216:219], v[248:251], v[28:31]
    s_waitcnt lgkmcnt(3)
    ds_read_b128 a[200:203], v1 offset:50176
    ds_read_b128 a[204:207], v1 offset:50688
    v_mfma_f32_16x16x32_bf16 v[28:31], a[212:215], v[244:247], v[28:31]
    s_waitcnt lgkmcnt(4)
    v_add_f32 v118, v118, v47
    v_cvt_pk_bf16_f32 v43, v46, v47
    v_mfma_f32_16x16x32_bf16 v[28:31], a[208:211], v[240:243], v[28:31]
    v_exp_f32 v16, v16
    v_exp_f32 v17, v17
    v_mfma_f32_16x16x32_bf16 v[48:51], a[224:227], v[40:43], v[48:51]
    ds_read_b64_tr_b16 a[224:225], v2 offset:32768
    ds_read_b64_tr_b16 a[226:227], v2 offset:36864
    v_mfma_f32_16x16x32_bf16 v[52:55], a[228:231], v[40:43], v[52:55]
    ds_read_b128 a[220:223], v1 offset:54784
    ds_read_b128 a[216:219], v1 offset:54272
    v_mfma_f32_16x16x32_bf16 v[56:59], a[232:235], v[40:43], v[56:59]
    ds_read_b64_tr_b16 a[228:229], v2 offset:33024
    ds_read_b64_tr_b16 a[230:231], v2 offset:37120
    v_mfma_f32_16x16x32_bf16 v[60:63], a[236:239], v[40:43], v[60:63]
    v_add_f32 v119, v119, v16
    v_add_f32 v119, v119, v17
    v_exp_f32 v18, v18
    v_mfma_f32_16x16x32_bf16 v[64:67], a[240:243], v[40:43], v[64:67]
    ds_read_b64_tr_b16 a[232:233], v2 offset:33280
    ds_read_b64_tr_b16 a[234:235], v2 offset:37376
    v_mfma_f32_16x16x32_bf16 v[68:71], a[244:247], v[40:43], v[68:71]
    ds_read_b128 a[212:215], v1 offset:53760
    ds_read_b128 a[208:211], v1 offset:53248
    v_mfma_f32_16x16x32_bf16 v[72:75], a[248:251], v[40:43], v[72:75]
    ds_read_b64_tr_b16 a[236:237], v2 offset:33536
    ds_read_b64_tr_b16 a[238:239], v2 offset:37632
    v_mfma_f32_16x16x32_bf16 v[76:79], a[252:255], v[40:43], v[76:79]
    s_waitcnt lgkmcnt(15)
    v_exp_f32 v19, v19
    v_cvt_pk_bf16_f32 v16, v16, v17
    v_add_f32 v119, v119, v18
    v_mfma_f32_16x16x32_bf16 v[32:35], a[192:195], v[240:243], v[124:127]
    s_waitcnt lgkmcnt(14)
    ds_read_b64_tr_b16 a[240:241], v2 offset:33792
    ds_read_b64_tr_b16 a[242:243], v2 offset:37888
    v_mov_b32 v8, v118
    s_nop 1
    v_permlane16_swap_b32 v8, v118
    v_add_f32 v118, v118, v8
    v_mov_b32 v8, v118
    s_nop 1
    v_permlane32_swap_b32 v8, v118
    v_add_f32 v118, v118, v8
    v_subrev_u32 v8, 0x33800000, v118
    v_cmp_lt_u32 vcc, 0x20000000, v8
    v_rcp_f32 v118, v118
    s_cbranch_vccnz L_fallback
    v_add_u32 v7, 24576, v6
    v_pk_mul_f32 v[48:49], v[48:49], v[118:119] op_sel_hi:[1,0]
    v_pk_mul_f32 v[50:51], v[50:51], v[118:119] op_sel_hi:[1,0]
    v_pk_mul_f32 v[52:53], v[52:53], v[118:119] op_sel_hi:[1,0]
    v_pk_mul_f32 v[54:55], v[54:55], v[118:119] op_sel_hi:[1,0]
    v_cvt_pk_bf16_f32 v48, v48, v49
    v_cvt_pk_bf16_f32 v49, v50, v51
    v_cvt_pk_bf16_f32 v50, v52, v53
    v_cvt_pk_bf16_f32 v51, v54, v55
    v_pk_mul_f32 v[56:57], v[56:57], v[118:119] op_sel_hi:[1,0]
    v_pk_mul_f32 v[58:59], v[58:59], v[118:119] op_sel_hi:[1,0]
    v_permlane16_swap_b32 v48, v50
    v_permlane16_swap_b32 v49, v51
    buffer_store_dwordx4 v[48:51], v7, s[20:23], 0 offen sc0 nt sc1
    v_pk_mul_f32 v[60:61], v[60:61], v[118:119] op_sel_hi:[1,0]
    v_pk_mul_f32 v[62:63], v[62:63], v[118:119] op_sel_hi:[1,0]
    v_cvt_pk_bf16_f32 v56, v56, v57
    v_cvt_pk_bf16_f32 v57, v58, v59
    v_cvt_pk_bf16_f32 v58, v60, v61
    v_cvt_pk_bf16_f32 v59, v62, v63
    v_pk_mul_f32 v[64:65], v[64:65], v[118:119] op_sel_hi:[1,0]
    v_pk_mul_f32 v[66:67], v[66:67], v[118:119] op_sel_hi:[1,0]
    v_permlane16_swap_b32 v56, v58
    v_permlane16_swap_b32 v57, v59
    buffer_store_dwordx4 v[56:59], v7, s[20:23], 0 offen offset:64 sc0 nt sc1
    v_pk_mul_f32 v[68:69], v[68:69], v[118:119] op_sel_hi:[1,0]
    v_pk_mul_f32 v[70:71], v[70:71], v[118:119] op_sel_hi:[1,0]
    v_cvt_pk_bf16_f32 v64, v64, v65
    v_cvt_pk_bf16_f32 v65, v66, v67
    v_cvt_pk_bf16_f32 v66, v68, v69
    v_cvt_pk_bf16_f32 v67, v70, v71
    v_pk_mul_f32 v[72:73], v[72:73], v[118:119] op_sel_hi:[1,0]
    v_pk_mul_f32 v[74:75], v[74:75], v[118:119] op_sel_hi:[1,0]
    v_permlane16_swap_b32 v64, v66
    v_permlane16_swap_b32 v65, v67
    buffer_store_dwordx4 v[64:67], v7, s[20:23], 0 offen offset:128 sc0 nt sc1
    v_pk_mul_f32 v[76:77], v[76:77], v[118:119] op_sel_hi:[1,0]
    v_pk_mul_f32 v[78:79], v[78:79], v[118:119] op_sel_hi:[1,0]
    v_cvt_pk_bf16_f32 v72, v72, v73
    v_cvt_pk_bf16_f32 v73, v74, v75
    v_cvt_pk_bf16_f32 v74, v76, v77
    v_cvt_pk_bf16_f32 v75, v78, v79
    s_nop 1
    v_permlane16_swap_b32 v72, v74
    v_permlane16_swap_b32 v73, v75
    buffer_store_dwordx4 v[72:75], v7, s[20:23], 0 offen offset:192 sc0 nt sc1
    v_mfma_f32_16x16x32_bf16 v[32:35], a[196:199], v[244:247], v[32:35]
    s_waitcnt lgkmcnt(15)
    ds_read_b128 a[192:195], v1 offset:57344
    ds_read_b128 a[196:199], v1 offset:57856
    v_mfma_f32_16x16x32_bf16 v[32:35], a[200:203], v[248:251], v[32:35]
    s_waitcnt lgkmcnt(15)
    ds_read_b64_tr_b16 a[244:245], v2 offset:34048
    ds_read_b64_tr_b16 a[246:247], v2 offset:38144
    v_mfma_f32_16x16x32_bf16 v[32:35], a[204:207], v[252:255], v[32:35]
    s_waitcnt lgkmcnt(15)
    v_exp_f32 v20, v20
    v_add_f32 v119, v119, v19
    v_cvt_pk_bf16_f32 v17, v18, v19
    v_mfma_f32_16x16x32_bf16 v[36:39], a[220:223], v[252:255], v[124:127]
    s_waitcnt lgkmcnt(14)
    ds_read_b64_tr_b16 a[248:249], v2 offset:34304
    ds_read_b64_tr_b16 a[250:251], v2 offset:38400
    v_mfma_f32_16x16x32_bf16 v[36:39], a[216:219], v[248:251], v[36:39]
    s_waitcnt lgkmcnt(11)
    ds_read_b128 a[200:203], v1 offset:58368
    ds_read_b128 a[204:207], v1 offset:58880
    v_mfma_f32_16x16x32_bf16 v[36:39], a[212:215], v[244:247], v[36:39]
    s_waitcnt lgkmcnt(12)
    ds_read_b64_tr_b16 a[252:253], v2 offset:34560
    ds_read_b64_tr_b16 a[254:255], v2 offset:38656
    v_mfma_f32_16x16x32_bf16 v[36:39], a[208:211], v[240:243], v[36:39]
    v_exp_f32 v21, v21
    v_add_f32 v119, v119, v20
    v_add_f32 v119, v119, v21
    v_exp_f32 v22, v22
    v_exp_f32 v23, v23
    v_cvt_pk_bf16_f32 v18, v20, v21
    v_add_f32 v119, v119, v22
    v_add_f32 v119, v119, v23
    v_cvt_pk_bf16_f32 v19, v22, v23
    s_nop 0
    s_nop 0
    v_mfma_f32_16x16x32_bf16 v[80:83], a[224:227], v[16:19], v[80:83]
    ds_read_b64_tr_b16 a[224:225], v2 offset:40960
    ds_read_b64_tr_b16 a[226:227], v2 offset:45056
    v_mfma_f32_16x16x32_bf16 v[84:87], a[228:231], v[16:19], v[84:87]
    ds_read_b128 a[220:223], v1 offset:62976
    ds_read_b128 a[216:219], v1 offset:62464
    v_mfma_f32_16x16x32_bf16 v[88:91], a[232:235], v[16:19], v[88:91]
    s_waitcnt lgkmcnt(15)
    ds_read_b64_tr_b16 a[228:229], v2 offset:41216
    ds_read_b64_tr_b16 a[230:231], v2 offset:45312
    v_mfma_f32_16x16x32_bf16 v[92:95], a[236:239], v[16:19], v[92:95]
    s_waitcnt lgkmcnt(15)
    v_exp_f32 v24, v24
    v_exp_f32 v25, v25
    v_mfma_f32_16x16x32_bf16 v[96:99], a[240:243], v[16:19], v[96:99]
    s_waitcnt lgkmcnt(12)
    ds_read_b64_tr_b16 a[232:233], v2 offset:41472
    ds_read_b64_tr_b16 a[234:235], v2 offset:45568
    v_mfma_f32_16x16x32_bf16 v[100:103], a[244:247], v[16:19], v[100:103]
    s_waitcnt lgkmcnt(12)
    ds_read_b128 a[212:215], v1 offset:61952
    ds_read_b128 a[208:211], v1 offset:61440
    v_mfma_f32_16x16x32_bf16 v[104:107], a[248:251], v[16:19], v[104:107]
    s_waitcnt lgkmcnt(10)
    ds_read_b64_tr_b16 a[236:237], v2 offset:41728
    ds_read_b64_tr_b16 a[238:239], v2 offset:45824
    v_mfma_f32_16x16x32_bf16 v[108:111], a[252:255], v[16:19], v[108:111]
    v_add_f32 v119, v119, v24
    v_add_f32 v119, v119, v25
    v_exp_f32 v26, v26
    v_mfma_f32_16x16x32_bf16 v[40:43], a[192:195], v[240:243], v[124:127]
    ds_read_b64_tr_b16 a[240:241], v2 offset:41984
    ds_read_b64_tr_b16 a[242:243], v2 offset:46080
    v_mfma_f32_16x16x32_bf16 v[40:43], a[196:199], v[244:247], v[40:43]
    v_exp_f32 v27, v27
    v_cvt_pk_bf16_f32 v24, v24, v25
    v_add_f32 v119, v119, v26
    v_mfma_f32_16x16x32_bf16 v[40:43], a[200:203], v[248:251], v[40:43]
    ds_read_b64_tr_b16 a[244:245], v2 offset:42240
    ds_read_b64_tr_b16 a[246:247], v2 offset:46336
    v_mfma_f32_16x16x32_bf16 v[40:43], a[204:207], v[252:255], v[40:43]
    s_waitcnt lgkmcnt(13)
    v_exp_f32 v28, v28
    v_add_f32 v119, v119, v27
    v_cvt_pk_bf16_f32 v25, v26, v27
    v_mfma_f32_16x16x32_bf16 v[44:47], a[220:223], v[252:255], v[124:127]
    s_waitcnt lgkmcnt(12)
    ds_read_b64_tr_b16 a[248:249], v2 offset:42496
    ds_read_b64_tr_b16 a[250:251], v2 offset:46592
    v_mfma_f32_16x16x32_bf16 v[44:47], a[216:219], v[248:251], v[44:47]
    s_waitcnt lgkmcnt(9)
    v_exp_f32 v29, v29
    v_add_f32 v119, v119, v28
    v_add_f32 v119, v119, v29
    v_mfma_f32_16x16x32_bf16 v[44:47], a[212:215], v[244:247], v[44:47]
    s_waitcnt lgkmcnt(8)
    ds_read_b64_tr_b16 a[252:253], v2 offset:42752
    ds_read_b64_tr_b16 a[254:255], v2 offset:46848
    v_mfma_f32_16x16x32_bf16 v[44:47], a[208:211], v[240:243], v[44:47]
    v_exp_f32 v30, v30
    v_exp_f32 v31, v31
    v_cvt_pk_bf16_f32 v26, v28, v29
    v_add_f32 v119, v119, v30
    v_add_f32 v119, v119, v31
    v_cvt_pk_bf16_f32 v27, v30, v31
    s_nop 0
    s_nop 0
    v_mfma_f32_16x16x32_bf16 v[80:83], a[224:227], v[24:27], v[80:83]
    ds_read_b64_tr_b16 a[224:225], v2 offset:49152
    ds_read_b64_tr_b16 a[226:227], v2 offset:53248
    v_mfma_f32_16x16x32_bf16 v[84:87], a[228:231], v[24:27], v[84:87]
    ds_read_b64_tr_b16 a[228:229], v2 offset:49408
    ds_read_b64_tr_b16 a[230:231], v2 offset:53504
    v_mfma_f32_16x16x32_bf16 v[88:91], a[232:235], v[24:27], v[88:91]
    s_waitcnt lgkmcnt(12)
    ds_read_b64_tr_b16 a[232:233], v2 offset:49664
    ds_read_b64_tr_b16 a[234:235], v2 offset:53760
    v_mfma_f32_16x16x32_bf16 v[92:95], a[236:239], v[24:27], v[92:95]
    s_waitcnt lgkmcnt(12)
    ds_read_b64_tr_b16 a[236:237], v2 offset:49920
    ds_read_b64_tr_b16 a[238:239], v2 offset:54016
    v_mfma_f32_16x16x32_bf16 v[96:99], a[240:243], v[24:27], v[96:99]
    s_waitcnt lgkmcnt(12)
    ds_read_b64_tr_b16 a[240:241], v2 offset:50176
    ds_read_b64_tr_b16 a[242:243], v2 offset:54272
    v_mfma_f32_16x16x32_bf16 v[100:103], a[244:247], v[24:27], v[100:103]
    s_waitcnt lgkmcnt(12)
    ds_read_b64_tr_b16 a[244:245], v2 offset:50432
    ds_read_b64_tr_b16 a[246:247], v2 offset:54528
    v_mfma_f32_16x16x32_bf16 v[104:107], a[248:251], v[24:27], v[104:107]
    s_waitcnt lgkmcnt(12)
    ds_read_b64_tr_b16 a[248:249], v2 offset:50688
    ds_read_b64_tr_b16 a[250:251], v2 offset:54784
    v_mfma_f32_16x16x32_bf16 v[108:111], a[252:255], v[24:27], v[108:111]
    s_waitcnt lgkmcnt(12)
    ds_read_b64_tr_b16 a[252:253], v2 offset:50944
    ds_read_b64_tr_b16 a[254:255], v2 offset:55040
    v_exp_f32 v32, v32
    v_exp_f32 v33, v33
    v_add_f32 v119, v119, v32
    v_add_f32 v119, v119, v33
    v_exp_f32 v34, v34
    v_exp_f32 v35, v35
    v_cvt_pk_bf16_f32 v32, v32, v33
    v_add_f32 v119, v119, v34
    v_exp_f32 v36, v36
    v_add_f32 v119, v119, v35
    v_cvt_pk_bf16_f32 v33, v34, v35
    v_exp_f32 v37, v37
    v_add_f32 v119, v119, v36
    v_add_f32 v119, v119, v37
    v_exp_f32 v38, v38
    v_exp_f32 v39, v39
    v_cvt_pk_bf16_f32 v34, v36, v37
    v_add_f32 v119, v119, v38
    v_add_f32 v119, v119, v39
    v_cvt_pk_bf16_f32 v35, v38, v39
    s_nop 0
    s_nop 0
    v_mfma_f32_16x16x32_bf16 v[80:83], a[224:227], v[32:35], v[80:83]
    s_waitcnt lgkmcnt(12)
    ds_read_b64_tr_b16 a[224:225], v2 offset:57344
    ds_read_b64_tr_b16 a[226:227], v2 offset:61440
    v_mfma_f32_16x16x32_bf16 v[84:87], a[228:231], v[32:35], v[84:87]
    s_waitcnt lgkmcnt(12)
    ds_read_b64_tr_b16 a[228:229], v2 offset:57600
    ds_read_b64_tr_b16 a[230:231], v2 offset:61696
    v_mfma_f32_16x16x32_bf16 v[88:91], a[232:235], v[32:35], v[88:91]
    s_waitcnt lgkmcnt(12)
    ds_read_b64_tr_b16 a[232:233], v2 offset:57856
    ds_read_b64_tr_b16 a[234:235], v2 offset:61952
    v_mfma_f32_16x16x32_bf16 v[92:95], a[236:239], v[32:35], v[92:95]
    s_waitcnt lgkmcnt(12)
    ds_read_b64_tr_b16 a[236:237], v2 offset:58112
    ds_read_b64_tr_b16 a[238:239], v2 offset:62208
    v_mfma_f32_16x16x32_bf16 v[96:99], a[240:243], v[32:35], v[96:99]
    s_waitcnt lgkmcnt(12)
    ds_read_b64_tr_b16 a[240:241], v2 offset:58368
    ds_read_b64_tr_b16 a[242:243], v2 offset:62464
    v_mfma_f32_16x16x32_bf16 v[100:103], a[244:247], v[32:35], v[100:103]
    s_waitcnt lgkmcnt(12)
    ds_read_b64_tr_b16 a[244:245], v2 offset:58624
    ds_read_b64_tr_b16 a[246:247], v2 offset:62720
    v_mfma_f32_16x16x32_bf16 v[104:107], a[248:251], v[32:35], v[104:107]
    s_waitcnt lgkmcnt(12)
    ds_read_b64_tr_b16 a[248:249], v2 offset:58880
    ds_read_b64_tr_b16 a[250:251], v2 offset:62976
    v_mfma_f32_16x16x32_bf16 v[108:111], a[252:255], v[32:35], v[108:111]
    s_waitcnt lgkmcnt(12)
    ds_read_b64_tr_b16 a[252:253], v2 offset:59136
    ds_read_b64_tr_b16 a[254:255], v2 offset:63232
    v_exp_f32 v40, v40
    v_exp_f32 v41, v41
    v_add_f32 v119, v119, v40
    v_add_f32 v119, v119, v41
    v_exp_f32 v42, v42
    v_exp_f32 v43, v43
    v_cvt_pk_bf16_f32 v40, v40, v41
    v_add_f32 v119, v119, v42
    v_exp_f32 v44, v44
    v_add_f32 v119, v119, v43
    v_cvt_pk_bf16_f32 v41, v42, v43
    v_exp_f32 v45, v45
    v_add_f32 v119, v119, v44
    v_add_f32 v119, v119, v45
    v_exp_f32 v46, v46
    v_exp_f32 v47, v47
    v_cvt_pk_bf16_f32 v42, v44, v45
    v_add_f32 v119, v119, v46
    v_add_f32 v119, v119, v47
    v_cvt_pk_bf16_f32 v43, v46, v47
    s_nop 0
    s_nop 0
    v_mfma_f32_16x16x32_bf16 v[80:83], a[224:227], v[40:43], v[80:83]
    s_waitcnt lgkmcnt(12)
    v_mfma_f32_16x16x32_bf16 v[84:87], a[228:231], v[40:43], v[84:87]
    s_waitcnt lgkmcnt(10)
    v_mfma_f32_16x16x32_bf16 v[88:91], a[232:235], v[40:43], v[88:91]
    s_waitcnt lgkmcnt(8)
    v_mfma_f32_16x16x32_bf16 v[92:95], a[236:239], v[40:43], v[92:95]
    s_waitcnt lgkmcnt(6)
    v_mfma_f32_16x16x32_bf16 v[96:99], a[240:243], v[40:43], v[96:99]
    s_waitcnt lgkmcnt(4)
    v_mfma_f32_16x16x32_bf16 v[100:103], a[244:247], v[40:43], v[100:103]
    s_waitcnt lgkmcnt(2)
    v_mfma_f32_16x16x32_bf16 v[104:107], a[248:251], v[40:43], v[104:107]
    s_waitcnt lgkmcnt(0)
    v_mfma_f32_16x16x32_bf16 v[108:111], a[252:255], v[40:43], v[108:111]
    s_nop 0
    s_nop 0
    s_nop 0
    s_nop 0
    s_nop 0
    s_nop 0
    s_nop 0
    s_nop 0
    v_mov_b32 v8, v119
    s_nop 1
    v_permlane16_swap_b32 v8, v119
    v_add_f32 v119, v119, v8
    v_mov_b32 v8, v119
    s_nop 1
    v_permlane32_swap_b32 v8, v119
    v_add_f32 v119, v119, v8
    v_subrev_u32 v8, 0x33800000, v119
    v_cmp_lt_u32 vcc, 0x20000000, v8
    v_rcp_f32 v119, v119
    s_cbranch_vccnz L_fallback
    v_add_u32 v7, 28672, v6
    v_pk_mul_f32 v[80:81], v[80:81], v[118:119] op_sel:[0,1] op_sel_hi:[1,1]
    v_pk_mul_f32 v[82:83], v[82:83], v[118:119] op_sel:[0,1] op_sel_hi:[1,1]
    v_pk_mul_f32 v[84:85], v[84:85], v[118:119] op_sel:[0,1] op_sel_hi:[1,1]
    v_pk_mul_f32 v[86:87], v[86:87], v[118:119] op_sel:[0,1] op_sel_hi:[1,1]
    v_cvt_pk_bf16_f32 v80, v80, v81
    v_cvt_pk_bf16_f32 v81, v82, v83
    v_cvt_pk_bf16_f32 v82, v84, v85
    v_cvt_pk_bf16_f32 v83, v86, v87
    v_pk_mul_f32 v[88:89], v[88:89], v[118:119] op_sel:[0,1] op_sel_hi:[1,1]
    v_pk_mul_f32 v[90:91], v[90:91], v[118:119] op_sel:[0,1] op_sel_hi:[1,1]
    v_permlane16_swap_b32 v80, v82
    v_permlane16_swap_b32 v81, v83
    buffer_store_dwordx4 v[80:83], v7, s[20:23], 0 offen sc0 nt sc1
    v_pk_mul_f32 v[92:93], v[92:93], v[118:119] op_sel:[0,1] op_sel_hi:[1,1]
    v_pk_mul_f32 v[94:95], v[94:95], v[118:119] op_sel:[0,1] op_sel_hi:[1,1]
    v_cvt_pk_bf16_f32 v88, v88, v89
    v_cvt_pk_bf16_f32 v89, v90, v91
    v_cvt_pk_bf16_f32 v90, v92, v93
    v_cvt_pk_bf16_f32 v91, v94, v95
    v_pk_mul_f32 v[96:97], v[96:97], v[118:119] op_sel:[0,1] op_sel_hi:[1,1]
    v_pk_mul_f32 v[98:99], v[98:99], v[118:119] op_sel:[0,1] op_sel_hi:[1,1]
    v_permlane16_swap_b32 v88, v90
    v_permlane16_swap_b32 v89, v91
    buffer_store_dwordx4 v[88:91], v7, s[20:23], 0 offen offset:64 sc0 nt sc1
    v_pk_mul_f32 v[100:101], v[100:101], v[118:119] op_sel:[0,1] op_sel_hi:[1,1]
    v_pk_mul_f32 v[102:103], v[102:103], v[118:119] op_sel:[0,1] op_sel_hi:[1,1]
    v_cvt_pk_bf16_f32 v96, v96, v97
    v_cvt_pk_bf16_f32 v97, v98, v99
    v_cvt_pk_bf16_f32 v98, v100, v101
    v_cvt_pk_bf16_f32 v99, v102, v103
    v_pk_mul_f32 v[104:105], v[104:105], v[118:119] op_sel:[0,1] op_sel_hi:[1,1]
    v_pk_mul_f32 v[106:107], v[106:107], v[118:119] op_sel:[0,1] op_sel_hi:[1,1]
    v_permlane16_swap_b32 v96, v98
    v_permlane16_swap_b32 v97, v99
    buffer_store_dwordx4 v[96:99], v7, s[20:23], 0 offen offset:128 sc0 nt sc1
    v_pk_mul_f32 v[108:109], v[108:109], v[118:119] op_sel:[0,1] op_sel_hi:[1,1]
    v_pk_mul_f32 v[110:111], v[110:111], v[118:119] op_sel:[0,1] op_sel_hi:[1,1]
    v_cvt_pk_bf16_f32 v104, v104, v105
    v_cvt_pk_bf16_f32 v105, v106, v107
    v_cvt_pk_bf16_f32 v106, v108, v109
    v_cvt_pk_bf16_f32 v107, v110, v111
    s_nop 1
    v_permlane16_swap_b32 v104, v106
    v_permlane16_swap_b32 v105, v107
    buffer_store_dwordx4 v[104:107], v7, s[20:23], 0 offen offset:192 sc0 nt sc1
L_done:
    s_endpgm
L_fallback:
    s_waitcnt vmcnt(0) lgkmcnt(0)
    v_mbcnt_lo_u32_b32 v8, -1, 0
    v_mbcnt_hi_u32_b32 v8, -1, v8
    v_and_b32 v9, 15, v8
    v_lshrrev_b32 v10, 4, v8
    s_lshl_b32 s28, s24, 15
    v_lshlrev_b32 v9, 8, v9
    v_lshl_add_u32 v9, v10, 4, v9
    v_add_u32 v5, s28, v9
    buffer_load_dwordx4 v[128:131], v5, s[8:11], 0 offen
    buffer_load_dwordx4 v[132:135], v5, s[8:11], 0 offen offset:64
    buffer_load_dwordx4 v[136:139], v5, s[8:11], 0 offen offset:128
    buffer_load_dwordx4 v[140:143], v5, s[8:11], 0 offen offset:192
    v_add_u32 v5, 0x1000, v5
    buffer_load_dwordx4 v[144:147], v5, s[8:11], 0 offen
    buffer_load_dwordx4 v[148:151], v5, s[8:11], 0 offen offset:64
    buffer_load_dwordx4 v[152:155], v5, s[8:11], 0 offen offset:128
    buffer_load_dwordx4 v[156:159], v5, s[8:11], 0 offen offset:192
    v_add_u32 v5, 0x1000, v5
    buffer_load_dwordx4 v[160:163], v5, s[8:11], 0 offen
    buffer_load_dwordx4 v[164:167], v5, s[8:11], 0 offen offset:64
    buffer_load_dwordx4 v[168:171], v5, s[8:11], 0 offen offset:128
    buffer_load_dwordx4 v[172:175], v5, s[8:11], 0 offen offset:192
    v_add_u32 v5, 0x1000, v5
    buffer_load_dwordx4 v[176:179], v5, s[8:11], 0 offen
    buffer_load_dwordx4 v[180:183], v5, s[8:11], 0 offen offset:64
    buffer_load_dwordx4 v[184:187], v5, s[8:11], 0 offen offset:128
    buffer_load_dwordx4 v[188:191], v5, s[8:11], 0 offen offset:192
    v_add_u32 v5, 0x1000, v5
    buffer_load_dwordx4 v[192:195], v5, s[8:11], 0 offen
    buffer_load_dwordx4 v[196:199], v5, s[8:11], 0 offen offset:64
    buffer_load_dwordx4 v[200:203], v5, s[8:11], 0 offen offset:128
    buffer_load_dwordx4 v[204:207], v5, s[8:11], 0 offen offset:192
    v_add_u32 v5, 0x1000, v5
    buffer_load_dwordx4 v[208:211], v5, s[8:11], 0 offen
    buffer_load_dwordx4 v[212:215], v5, s[8:11], 0 offen offset:64
    buffer_load_dwordx4 v[216:219], v5, s[8:11], 0 offen offset:128
    buffer_load_dwordx4 v[220:223], v5, s[8:11], 0 offen offset:192
    v_add_u32 v5, 0x1000, v5
    buffer_load_dwordx4 v[224:227], v5, s[8:11], 0 offen
    buffer_load_dwordx4 v[228:231], v5, s[8:11], 0 offen offset:64
    buffer_load_dwordx4 v[232:235], v5, s[8:11], 0 offen offset:128
    buffer_load_dwordx4 v[236:239], v5, s[8:11], 0 offen offset:192
    v_add_u32 v5, 0x1000, v5
    buffer_load_dwordx4 v[240:243], v5, s[8:11], 0 offen
    buffer_load_dwordx4 v[244:247], v5, s[8:11], 0 offen offset:64
    buffer_load_dwordx4 v[248:251], v5, s[8:11], 0 offen offset:128
    buffer_load_dwordx4 v[252:255], v5, s[8:11], 0 offen offset:192
    s_lshl_b32 s28, s24, 13
    s_add_u32 s28, s28, 131072
    v_add_u32 v1, s28, v1
    v_add_u32 v2, s28, v2
    v_subrev_u32 v2, 65536, v2
    v_mov_b32 v112, 0
    v_mov_b32 v120, 0xff7fffff
    v_mov_b32 v113, 0
    v_mov_b32 v121, 0xff7fffff
    v_mov_b32 v114, 0
    v_mov_b32 v122, 0xff7fffff
    v_mov_b32 v115, 0
    v_mov_b32 v123, 0xff7fffff
    v_mov_b32 v116, 0
    v_mov_b32 v124, 0xff7fffff
    v_mov_b32 v117, 0
    v_mov_b32 v125, 0xff7fffff
    v_mov_b32 v118, 0
    v_mov_b32 v126, 0xff7fffff
    v_mov_b32 v119, 0
    v_mov_b32 v127, 0xff7fffff
    v_accvgpr_write_b32 a0, 0
    v_accvgpr_write_b32 a1, 0
    v_accvgpr_write_b32 a2, 0
    v_accvgpr_write_b32 a3, 0
    v_accvgpr_write_b32 a4, 0
    v_accvgpr_write_b32 a5, 0
    v_accvgpr_write_b32 a6, 0
    v_accvgpr_write_b32 a7, 0
    v_accvgpr_write_b32 a8, 0
    v_accvgpr_write_b32 a9, 0
    v_accvgpr_write_b32 a10, 0
    v_accvgpr_write_b32 a11, 0
    v_accvgpr_write_b32 a12, 0
    v_accvgpr_write_b32 a13, 0
    v_accvgpr_write_b32 a14, 0
    v_accvgpr_write_b32 a15, 0
    v_accvgpr_write_b32 a16, 0
    v_accvgpr_write_b32 a17, 0
    v_accvgpr_write_b32 a18, 0
    v_accvgpr_write_b32 a19, 0
    v_accvgpr_write_b32 a20, 0
    v_accvgpr_write_b32 a21, 0
    v_accvgpr_write_b32 a22, 0
    v_accvgpr_write_b32 a23, 0
    v_accvgpr_write_b32 a24, 0
    v_accvgpr_write_b32 a25, 0
    v_accvgpr_write_b32 a26, 0
    v_accvgpr_write_b32 a27, 0
    v_accvgpr_write_b32 a28, 0
    v_accvgpr_write_b32 a29, 0
    v_accvgpr_write_b32 a30, 0
    v_accvgpr_write_b32 a31, 0
    v_accvgpr_write_b32 a32, 0
    v_accvgpr_write_b32 a33, 0
    v_accvgpr_write_b32 a34, 0
    v_accvgpr_write_b32 a35, 0
    v_accvgpr_write_b32 a36, 0
    v_accvgpr_write_b32 a37, 0
    v_accvgpr_write_b32 a38, 0
    v_accvgpr_write_b32 a39, 0
    v_accvgpr_write_b32 a40, 0
    v_accvgpr_write_b32 a41, 0
    v_accvgpr_write_b32 a42, 0
    v_accvgpr_write_b32 a43, 0
    v_accvgpr_write_b32 a44, 0
    v_accvgpr_write_b32 a45, 0
    v_accvgpr_write_b32 a46, 0
    v_accvgpr_write_b32 a47, 0
    v_accvgpr_write_b32 a48, 0
    v_accvgpr_write_b32 a49, 0
    v_accvgpr_write_b32 a50, 0
    v_accvgpr_write_b32 a51, 0
    v_accvgpr_write_b32 a52, 0
    v_accvgpr_write_b32 a53, 0
    v_accvgpr_write_b32 a54, 0
    v_accvgpr_write_b32 a55, 0
    v_accvgpr_write_b32 a56, 0
    v_accvgpr_write_b32 a57, 0
    v_accvgpr_write_b32 a58, 0
    v_accvgpr_write_b32 a59, 0
    v_accvgpr_write_b32 a60, 0
    v_accvgpr_write_b32 a61, 0
    v_accvgpr_write_b32 a62, 0
    v_accvgpr_write_b32 a63, 0
    v_accvgpr_write_b32 a64, 0
    v_accvgpr_write_b32 a65, 0
    v_accvgpr_write_b32 a66, 0
    v_accvgpr_write_b32 a67, 0
    v_accvgpr_write_b32 a68, 0
    v_accvgpr_write_b32 a69, 0
    v_accvgpr_write_b32 a70, 0
    v_accvgpr_write_b32 a71, 0
    v_accvgpr_write_b32 a72, 0
    v_accvgpr_write_b32 a73, 0
    v_accvgpr_write_b32 a74, 0
    v_accvgpr_write_b32 a75, 0
    v_accvgpr_write_b32 a76, 0
    v_accvgpr_write_b32 a77, 0
    v_accvgpr_write_b32 a78, 0
    v_accvgpr_write_b32 a79, 0
    v_accvgpr_write_b32 a80, 0
    v_accvgpr_write_b32 a81, 0
    v_accvgpr_write_b32 a82, 0
    v_accvgpr_write_b32 a83, 0
    v_accvgpr_write_b32 a84, 0
    v_accvgpr_write_b32 a85, 0
    v_accvgpr_write_b32 a86, 0
    v_accvgpr_write_b32 a87, 0
    v_accvgpr_write_b32 a88, 0
    v_accvgpr_write_b32 a89, 0
    v_accvgpr_write_b32 a90, 0
    v_accvgpr_write_b32 a91, 0
    v_accvgpr_write_b32 a92, 0
    v_accvgpr_write_b32 a93, 0
    v_accvgpr_write_b32 a94, 0
    v_accvgpr_write_b32 a95, 0
    v_accvgpr_write_b32 a96, 0
    v_accvgpr_write_b32 a97, 0
    v_accvgpr_write_b32 a98, 0
    v_accvgpr_write_b32 a99, 0
    v_accvgpr_write_b32 a100, 0
    v_accvgpr_write_b32 a101, 0
    v_accvgpr_write_b32 a102, 0
    v_accvgpr_write_b32 a103, 0
    v_accvgpr_write_b32 a104, 0
    v_accvgpr_write_b32 a105, 0
    v_accvgpr_write_b32 a106, 0
    v_accvgpr_write_b32 a107, 0
    v_accvgpr_write_b32 a108, 0
    v_accvgpr_write_b32 a109, 0
    v_accvgpr_write_b32 a110, 0
    v_accvgpr_write_b32 a111, 0
    v_accvgpr_write_b32 a112, 0
    v_accvgpr_write_b32 a113, 0
    v_accvgpr_write_b32 a114, 0
    v_accvgpr_write_b32 a115, 0
    v_accvgpr_write_b32 a116, 0
    v_accvgpr_write_b32 a117, 0
    v_accvgpr_write_b32 a118, 0
    v_accvgpr_write_b32 a119, 0
    v_accvgpr_write_b32 a120, 0
    v_accvgpr_write_b32 a121, 0
    v_accvgpr_write_b32 a122, 0
    v_accvgpr_write_b32 a123, 0
    v_accvgpr_write_b32 a124, 0
    v_accvgpr_write_b32 a125, 0
    v_accvgpr_write_b32 a126, 0
    v_accvgpr_write_b32 a127, 0
    v_accvgpr_write_b32 a128, 0
    v_accvgpr_write_b32 a129, 0
    v_accvgpr_write_b32 a130, 0
    v_accvgpr_write_b32 a131, 0
    v_accvgpr_write_b32 a132, 0
    v_accvgpr_write_b32 a133, 0
    v_accvgpr_write_b32 a134, 0
    v_accvgpr_write_b32 a135, 0
    v_accvgpr_write_b32 a136, 0
    v_accvgpr_write_b32 a137, 0
    v_accvgpr_write_b32 a138, 0
    v_accvgpr_write_b32 a139, 0
    v_accvgpr_write_b32 a140, 0
    v_accvgpr_write_b32 a141, 0
    v_accvgpr_write_b32 a142, 0
    v_accvgpr_write_b32 a143, 0
    v_accvgpr_write_b32 a144, 0
    v_accvgpr_write_b32 a145, 0
    v_accvgpr_write_b32 a146, 0
    v_accvgpr_write_b32 a147, 0
    v_accvgpr_write_b32 a148, 0
    v_accvgpr_write_b32 a149, 0
    v_accvgpr_write_b32 a150, 0
    v_accvgpr_write_b32 a151, 0
    v_accvgpr_write_b32 a152, 0
    v_accvgpr_write_b32 a153, 0
    v_accvgpr_write_b32 a154, 0
    v_accvgpr_write_b32 a155, 0
    v_accvgpr_write_b32 a156, 0
    v_accvgpr_write_b32 a157, 0
    v_accvgpr_write_b32 a158, 0
    v_accvgpr_write_b32 a159, 0
    v_accvgpr_write_b32 a160, 0
    v_accvgpr_write_b32 a161, 0
    v_accvgpr_write_b32 a162, 0
    v_accvgpr_write_b32 a163, 0
    v_accvgpr_write_b32 a164, 0
    v_accvgpr_write_b32 a165, 0
    v_accvgpr_write_b32 a166, 0
    v_accvgpr_write_b32 a167, 0
    v_accvgpr_write_b32 a168, 0
    v_accvgpr_write_b32 a169, 0
    v_accvgpr_write_b32 a170, 0
    v_accvgpr_write_b32 a171, 0
    v_accvgpr_write_b32 a172, 0
    v_accvgpr_write_b32 a173, 0
    v_accvgpr_write_b32 a174, 0
    v_accvgpr_write_b32 a175, 0
    v_accvgpr_write_b32 a176, 0
    v_accvgpr_write_b32 a177, 0
    v_accvgpr_write_b32 a178, 0
    v_accvgpr_write_b32 a179, 0
    v_accvgpr_write_b32 a180, 0
    v_accvgpr_write_b32 a181, 0
    v_accvgpr_write_b32 a182, 0
    v_accvgpr_write_b32 a183, 0
    v_accvgpr_write_b32 a184, 0
    v_accvgpr_write_b32 a185, 0
    v_accvgpr_write_b32 a186, 0
    v_accvgpr_write_b32 a187, 0
    v_accvgpr_write_b32 a188, 0
    v_accvgpr_write_b32 a189, 0
    v_accvgpr_write_b32 a190, 0
    v_accvgpr_write_b32 a191, 0
    v_mov_b32 v48, 0
    v_mov_b32 v49, 0
    v_mov_b32 v50, 0
    v_mov_b32 v51, 0
    v_mov_b32 v52, 0
    v_mov_b32 v53, 0
    v_mov_b32 v54, 0
    v_mov_b32 v55, 0
    v_mov_b32 v56, 0
    v_mov_b32 v57, 0
    v_mov_b32 v58, 0
    v_mov_b32 v59, 0
    v_mov_b32 v60, 0
    v_mov_b32 v61, 0
    v_mov_b32 v62, 0
    v_mov_b32 v63, 0
    v_mov_b32 v64, 0
    v_mov_b32 v65, 0
    v_mov_b32 v66, 0
    v_mov_b32 v67, 0
    v_mov_b32 v68, 0
    v_mov_b32 v69, 0
    v_mov_b32 v70, 0
    v_mov_b32 v71, 0
    v_mov_b32 v72, 0
    v_mov_b32 v73, 0
    v_mov_b32 v74, 0
    v_mov_b32 v75, 0
    v_mov_b32 v76, 0
    v_mov_b32 v77, 0
    v_mov_b32 v78, 0
    v_mov_b32 v79, 0
    v_mov_b32 v80, 0
    v_mov_b32 v81, 0
    v_mov_b32 v82, 0
    v_mov_b32 v83, 0
    v_mov_b32 v84, 0
    v_mov_b32 v85, 0
    v_mov_b32 v86, 0
    v_mov_b32 v87, 0
    v_mov_b32 v88, 0
    v_mov_b32 v89, 0
    v_mov_b32 v90, 0
    v_mov_b32 v91, 0
    v_mov_b32 v92, 0
    v_mov_b32 v93, 0
    v_mov_b32 v94, 0
    v_mov_b32 v95, 0
    v_mov_b32 v96, 0
    v_mov_b32 v97, 0
    v_mov_b32 v98, 0
    v_mov_b32 v99, 0
    v_mov_b32 v100, 0
    v_mov_b32 v101, 0
    v_mov_b32 v102, 0
    v_mov_b32 v103, 0
    v_mov_b32 v104, 0
    v_mov_b32 v105, 0
    v_mov_b32 v106, 0
    v_mov_b32 v107, 0
    v_mov_b32 v108, 0
    v_mov_b32 v109, 0
    v_mov_b32 v110, 0
    v_mov_b32 v111, 0
    s_mov_b32 s25, 0
L_fb_loop:
    s_add_u32 m0, s28, 0
    s_add_u32 s29, s25, 0
    buffer_load_dwordx4 v3, s[12:15], s29 offen lds
    s_add_u32 m0, s28, 1024
    s_add_u32 s29, s25, 128
    buffer_load_dwordx4 v3, s[12:15], s29 offen lds
    s_add_u32 m0, s28, 2048
    s_add_u32 s29, s25, 2048
    buffer_load_dwordx4 v3, s[12:15], s29 offen lds
    s_add_u32 m0, s28, 3072
    s_add_u32 s29, s25, 2176
    buffer_load_dwordx4 v3, s[12:15], s29 offen lds
    s_add_u32 m0, s28, 4096
    s_add_u32 s29, s25, 4096
    buffer_load_dwordx4 v3, s[12:15], s29 offen lds
    s_add_u32 m0, s28, 5120
    s_add_u32 s29, s25, 4224
    buffer_load_dwordx4 v3, s[12:15], s29 offen lds
    s_add_u32 m0, s28, 6144
    s_add_u32 s29, s25, 6144
    buffer_load_dwordx4 v3, s[12:15], s29 offen lds
    s_add_u32 m0, s28, 7168
    s_add_u32 s29, s25, 6272
    buffer_load_dwordx4 v3, s[12:15], s29 offen lds
    s_waitcnt vmcnt(0)
    ds_read_b128 a[192:195], v1 offset:0
    ds_read_b128 a[196:199], v1 offset:512
    ds_read_b128 a[200:203], v1 offset:1024
    ds_read_b128 a[204:207], v1 offset:1536
    ds_read_b128 a[208:211], v1 offset:4096
    ds_read_b128 a[212:215], v1 offset:4608
    ds_read_b128 a[216:219], v1 offset:5120
    ds_read_b128 a[220:223], v1 offset:5632
    s_waitcnt lgkmcnt(0)
    s_add_u32 m0, s28, 0
    s_add_u32 s29, s25, 0
    buffer_load_dwordx4 v4, s[16:19], s29 offen lds
    s_add_u32 m0, s28, 1024
    s_add_u32 s29, s25, 128
    buffer_load_dwordx4 v4, s[16:19], s29 offen lds
    s_add_u32 m0, s28, 2048
    s_add_u32 s29, s25, 2048
    buffer_load_dwordx4 v4, s[16:19], s29 offen lds
    s_add_u32 m0, s28, 3072
    s_add_u32 s29, s25, 2176
    buffer_load_dwordx4 v4, s[16:19], s29 offen lds
    s_add_u32 m0, s28, 4096
    s_add_u32 s29, s25, 4096
    buffer_load_dwordx4 v4, s[16:19], s29 offen lds
    s_add_u32 m0, s28, 5120
    s_add_u32 s29, s25, 4224
    buffer_load_dwordx4 v4, s[16:19], s29 offen lds
    s_add_u32 m0, s28, 6144
    s_add_u32 s29, s25, 6144
    buffer_load_dwordx4 v4, s[16:19], s29 offen lds
    s_add_u32 m0, s28, 7168
    s_add_u32 s29, s25, 6272
    buffer_load_dwordx4 v4, s[16:19], s29 offen lds
    s_waitcnt vmcnt(0)
    ds_read_b64_tr_b16 a[224:225], v2 offset:0
    ds_read_b64_tr_b16 a[226:227], v2 offset:4096
    ds_read_b64_tr_b16 a[228:229], v2 offset:256
    ds_read_b64_tr_b16 a[230:231], v2 offset:4352
    ds_read_b64_tr_b16 a[232:233], v2 offset:512
    ds_read_b64_tr_b16 a[234:235], v2 offset:4608
    ds_read_b64_tr_b16 a[236:237], v2 offset:768
    ds_read_b64_tr_b16 a[238:239], v2 offset:4864
    s_waitcnt lgkmcnt(0)
    ds_read_b64_tr_b16 a[240:241], v2 offset:1024
    ds_read_b64_tr_b16 a[242:243], v2 offset:5120
    ds_read_b64_tr_b16 a[244:245], v2 offset:1280
    ds_read_b64_tr_b16 a[246:247], v2 offset:5376
    ds_read_b64_tr_b16 a[248:249], v2 offset:1536
    ds_read_b64_tr_b16 a[250:251], v2 offset:5632
    ds_read_b64_tr_b16 a[252:253], v2 offset:1792
    ds_read_b64_tr_b16 a[254:255], v2 offset:5888
    s_waitcnt lgkmcnt(0)
    v_mfma_f32_16x16x32_bf16 v[16:19], a[192:195], v[128:131], 0
    v_mfma_f32_16x16x32_bf16 v[16:19], a[196:199], v[132:135], v[16:19]
    v_mfma_f32_16x16x32_bf16 v[16:19], a[200:203], v[136:139], v[16:19]
    v_mfma_f32_16x16x32_bf16 v[16:19], a[204:207], v[140:143], v[16:19]
    v_mfma_f32_16x16x32_bf16 v[20:23], a[208:211], v[128:131], 0
    v_mfma_f32_16x16x32_bf16 v[20:23], a[212:215], v[132:135], v[20:23]
    v_mfma_f32_16x16x32_bf16 v[20:23], a[216:219], v[136:139], v[20:23]
    v_mfma_f32_16x16x32_bf16 v[20:23], a[220:223], v[140:143], v[20:23]
    s_nop 7
    v_mul_f32 v16, s30, v16
    v_mul_f32 v17, s30, v17
    v_mul_f32 v18, s30, v18
    v_mul_f32 v19, s30, v19
    v_mul_f32 v20, s30, v20
    v_mul_f32 v21, s30, v21
    v_mul_f32 v22, s30, v22
    v_mul_f32 v23, s30, v23
    v_max3_f32 v8, v16, v17, v18
    v_max3_f32 v8, v8, v19, v20
    v_max3_f32 v8, v8, v21, v22
    v_max3_f32 v8, v8, v23, v120
    v_mov_b32 v9, v8
    s_nop 1
    v_permlane16_swap_b32 v9, v8
    v_max_f32 v8, v8, v9
    v_mov_b32 v9, v8
    s_nop 1
    v_permlane32_swap_b32 v9, v8
    v_max_f32 v8, v8, v9
    v_sub_f32 v9, v120, v8
    v_exp_f32 v9, v9
    v_mov_b32 v120, v8
    v_sub_f32 v16, v16, v8
    v_sub_f32 v17, v17, v8
    v_sub_f32 v18, v18, v8
    v_sub_f32 v19, v19, v8
    v_sub_f32 v20, v20, v8
    v_sub_f32 v21, v21, v8
    v_sub_f32 v22, v22, v8
    v_sub_f32 v23, v23, v8
    v_exp_f32 v16, v16
    v_exp_f32 v17, v17
    v_exp_f32 v18, v18
    v_exp_f32 v19, v19
    v_exp_f32 v20, v20
    v_exp_f32 v21, v21
    v_exp_f32 v22, v22
    v_exp_f32 v23, v23
    v_mul_f32 v112, v112, v9
    v_add_f32 v112, v112, v16
    v_add_f32 v112, v112, v17
    v_add_f32 v112, v112, v18
    v_add_f32 v112, v112, v19
    v_add_f32 v112, v112, v20
    v_add_f32 v112, v112, v21
    v_add_f32 v112, v112, v22
    v_add_f32 v112, v112, v23
    v_cvt_pk_bf16_f32 v16, v16, v17
    v_cvt_pk_bf16_f32 v17, v18, v19
    v_cvt_pk_bf16_f32 v18, v20, v21
    v_cvt_pk_bf16_f32 v19, v22, v23
    v_accvgpr_read_b32 v24, a0
    v_accvgpr_read_b32 v25, a1
    v_accvgpr_read_b32 v26, a2
    v_accvgpr_read_b32 v27, a3
    v_mul_f32 v24, v24, v9
    v_mul_f32 v25, v25, v9
    v_mul_f32 v26, v26, v9
    v_mul_f32 v27, v27, v9
    v_accvgpr_write_b32 a0, v24
    v_accvgpr_write_b32 a1, v25
    v_accvgpr_write_b32 a2, v26
    v_accvgpr_write_b32 a3, v27
    v_accvgpr_read_b32 v24, a4
    v_accvgpr_read_b32 v25, a5
    v_accvgpr_read_b32 v26, a6
    v_accvgpr_read_b32 v27, a7
    v_mul_f32 v24, v24, v9
    v_mul_f32 v25, v25, v9
    v_mul_f32 v26, v26, v9
    v_mul_f32 v27, v27, v9
    v_accvgpr_write_b32 a4, v24
    v_accvgpr_write_b32 a5, v25
    v_accvgpr_write_b32 a6, v26
    v_accvgpr_write_b32 a7, v27
    v_accvgpr_read_b32 v24, a8
    v_accvgpr_read_b32 v25, a9
    v_accvgpr_read_b32 v26, a10
    v_accvgpr_read_b32 v27, a11
    v_mul_f32 v24, v24, v9
    v_mul_f32 v25, v25, v9
    v_mul_f32 v26, v26, v9
    v_mul_f32 v27, v27, v9
    v_accvgpr_write_b32 a8, v24
    v_accvgpr_write_b32 a9, v25
    v_accvgpr_write_b32 a10, v26
    v_accvgpr_write_b32 a11, v27
    v_accvgpr_read_b32 v24, a12
    v_accvgpr_read_b32 v25, a13
    v_accvgpr_read_b32 v26, a14
    v_accvgpr_read_b32 v27, a15
    v_mul_f32 v24, v24, v9
    v_mul_f32 v25, v25, v9
    v_mul_f32 v26, v26, v9
    v_mul_f32 v27, v27, v9
    v_accvgpr_write_b32 a12, v24
    v_accvgpr_write_b32 a13, v25
    v_accvgpr_write_b32 a14, v26
    v_accvgpr_write_b32 a15, v27
    v_accvgpr_read_b32 v24, a16
    v_accvgpr_read_b32 v25, a17
    v_accvgpr_read_b32 v26, a18
    v_accvgpr_read_b32 v27, a19
    v_mul_f32 v24, v24, v9
    v_mul_f32 v25, v25, v9
    v_mul_f32 v26, v26, v9
    v_mul_f32 v27, v27, v9
    v_accvgpr_write_b32 a16, v24
    v_accvgpr_write_b32 a17, v25
    v_accvgpr_write_b32 a18, v26
    v_accvgpr_write_b32 a19, v27
    v_accvgpr_read_b32 v24, a20
    v_accvgpr_read_b32 v25, a21
    v_accvgpr_read_b32 v26, a22
    v_accvgpr_read_b32 v27, a23
    v_mul_f32 v24, v24, v9
    v_mul_f32 v25, v25, v9
    v_mul_f32 v26, v26, v9
    v_mul_f32 v27, v27, v9
    v_accvgpr_write_b32 a20, v24
    v_accvgpr_write_b32 a21, v25
    v_accvgpr_write_b32 a22, v26
    v_accvgpr_write_b32 a23, v27
    v_accvgpr_read_b32 v24, a24
    v_accvgpr_read_b32 v25, a25
    v_accvgpr_read_b32 v26, a26
    v_accvgpr_read_b32 v27, a27
    v_mul_f32 v24, v24, v9
    v_mul_f32 v25, v25, v9
    v_mul_f32 v26, v26, v9
    v_mul_f32 v27, v27, v9
    v_accvgpr_write_b32 a24, v24
    v_accvgpr_write_b32 a25, v25
    v_accvgpr_write_b32 a26, v26
    v_accvgpr_write_b32 a27, v27
    v_accvgpr_read_b32 v24, a28
    v_accvgpr_read_b32 v25, a29
    v_accvgpr_read_b32 v26, a30
    v_accvgpr_read_b32 v27, a31
    v_mul_f32 v24, v24, v9
    v_mul_f32 v25, v25, v9
    v_mul_f32 v26, v26, v9
    v_mul_f32 v27, v27, v9
    v_accvgpr_write_b32 a28, v24
    v_accvgpr_write_b32 a29, v25
    v_accvgpr_write_b32 a30, v26
    v_accvgpr_write_b32 a31, v27
    s_nop 1
    v_mfma_f32_16x16x32_bf16 a[0:3], a[224:227], v[16:19], a[0:3]
    v_mfma_f32_16x16x32_bf16 a[4:7], a[228:231], v[16:19], a[4:7]
    v_mfma_f32_16x16x32_bf16 a[8:11], a[232:235], v[16:19], a[8:11]
    v_mfma_f32_16x16x32_bf16 a[12:15], a[236:239], v[16:19], a[12:15]
    v_mfma_f32_16x16x32_bf16 a[16:19], a[240:243], v[16:19], a[16:19]
    v_mfma_f32_16x16x32_bf16 a[20:23], a[244:247], v[16:19], a[20:23]
    v_mfma_f32_16x16x32_bf16 a[24:27], a[248:251], v[16:19], a[24:27]
    v_mfma_f32_16x16x32_bf16 a[28:31], a[252:255], v[16:19], a[28:31]
    v_mfma_f32_16x16x32_bf16 v[16:19], a[192:195], v[144:147], 0
    v_mfma_f32_16x16x32_bf16 v[16:19], a[196:199], v[148:151], v[16:19]
    v_mfma_f32_16x16x32_bf16 v[16:19], a[200:203], v[152:155], v[16:19]
    v_mfma_f32_16x16x32_bf16 v[16:19], a[204:207], v[156:159], v[16:19]
    v_mfma_f32_16x16x32_bf16 v[20:23], a[208:211], v[144:147], 0
    v_mfma_f32_16x16x32_bf16 v[20:23], a[212:215], v[148:151], v[20:23]
    v_mfma_f32_16x16x32_bf16 v[20:23], a[216:219], v[152:155], v[20:23]
    v_mfma_f32_16x16x32_bf16 v[20:23], a[220:223], v[156:159], v[20:23]
    s_nop 7
    v_mul_f32 v16, s30, v16
    v_mul_f32 v17, s30, v17
    v_mul_f32 v18, s30, v18
    v_mul_f32 v19, s30, v19
    v_mul_f32 v20, s30, v20
    v_mul_f32 v21, s30, v21
    v_mul_f32 v22, s30, v22
    v_mul_f32 v23, s30, v23
    v_max3_f32 v8, v16, v17, v18
    v_max3_f32 v8, v8, v19, v20
    v_max3_f32 v8, v8, v21, v22
    v_max3_f32 v8, v8, v23, v121
    v_mov_b32 v9, v8
    s_nop 1
    v_permlane16_swap_b32 v9, v8
    v_max_f32 v8, v8, v9
    v_mov_b32 v9, v8
    s_nop 1
    v_permlane32_swap_b32 v9, v8
    v_max_f32 v8, v8, v9
    v_sub_f32 v9, v121, v8
    v_exp_f32 v9, v9
    v_mov_b32 v121, v8
    v_sub_f32 v16, v16, v8
    v_sub_f32 v17, v17, v8
    v_sub_f32 v18, v18, v8
    v_sub_f32 v19, v19, v8
    v_sub_f32 v20, v20, v8
    v_sub_f32 v21, v21, v8
    v_sub_f32 v22, v22, v8
    v_sub_f32 v23, v23, v8
    v_exp_f32 v16, v16
    v_exp_f32 v17, v17
    v_exp_f32 v18, v18
    v_exp_f32 v19, v19
    v_exp_f32 v20, v20
    v_exp_f32 v21, v21
    v_exp_f32 v22, v22
    v_exp_f32 v23, v23
    v_mul_f32 v113, v113, v9
    v_add_f32 v113, v113, v16
    v_add_f32 v113, v113, v17
    v_add_f32 v113, v113, v18
    v_add_f32 v113, v113, v19
    v_add_f32 v113, v113, v20
    v_add_f32 v113, v113, v21
    v_add_f32 v113, v113, v22
    v_add_f32 v113, v113, v23
    v_cvt_pk_bf16_f32 v16, v16, v17
    v_cvt_pk_bf16_f32 v17, v18, v19
    v_cvt_pk_bf16_f32 v18, v20, v21
    v_cvt_pk_bf16_f32 v19, v22, v23
    v_accvgpr_read_b32 v24, a32
    v_accvgpr_read_b32 v25, a33
    v_accvgpr_read_b32 v26, a34
    v_accvgpr_read_b32 v27, a35
    v_mul_f32 v24, v24, v9
    v_mul_f32 v25, v25, v9
    v_mul_f32 v26, v26, v9
    v_mul_f32 v27, v27, v9
    v_accvgpr_write_b32 a32, v24
    v_accvgpr_write_b32 a33, v25
    v_accvgpr_write_b32 a34, v26
    v_accvgpr_write_b32 a35, v27
    v_accvgpr_read_b32 v24, a36
    v_accvgpr_read_b32 v25, a37
    v_accvgpr_read_b32 v26, a38
    v_accvgpr_read_b32 v27, a39
    v_mul_f32 v24, v24, v9
    v_mul_f32 v25, v25, v9
    v_mul_f32 v26, v26, v9
    v_mul_f32 v27, v27, v9
    v_accvgpr_write_b32 a36, v24
    v_accvgpr_write_b32 a37, v25
    v_accvgpr_write_b32 a38, v26
    v_accvgpr_write_b32 a39, v27
    v_accvgpr_read_b32 v24, a40
    v_accvgpr_read_b32 v25, a41
    v_accvgpr_read_b32 v26, a42
    v_accvgpr_read_b32 v27, a43
    v_mul_f32 v24, v24, v9
    v_mul_f32 v25, v25, v9
    v_mul_f32 v26, v26, v9
    v_mul_f32 v27, v27, v9
    v_accvgpr_write_b32 a40, v24
    v_accvgpr_write_b32 a41, v25
    v_accvgpr_write_b32 a42, v26
    v_accvgpr_write_b32 a43, v27
    v_accvgpr_read_b32 v24, a44
    v_accvgpr_read_b32 v25, a45
    v_accvgpr_read_b32 v26, a46
    v_accvgpr_read_b32 v27, a47
    v_mul_f32 v24, v24, v9
    v_mul_f32 v25, v25, v9
    v_mul_f32 v26, v26, v9
    v_mul_f32 v27, v27, v9
    v_accvgpr_write_b32 a44, v24
    v_accvgpr_write_b32 a45, v25
    v_accvgpr_write_b32 a46, v26
    v_accvgpr_write_b32 a47, v27
    v_accvgpr_read_b32 v24, a48
    v_accvgpr_read_b32 v25, a49
    v_accvgpr_read_b32 v26, a50
    v_accvgpr_read_b32 v27, a51
    v_mul_f32 v24, v24, v9
    v_mul_f32 v25, v25, v9
    v_mul_f32 v26, v26, v9
    v_mul_f32 v27, v27, v9
    v_accvgpr_write_b32 a48, v24
    v_accvgpr_write_b32 a49, v25
    v_accvgpr_write_b32 a50, v26
    v_accvgpr_write_b32 a51, v27
    v_accvgpr_read_b32 v24, a52
    v_accvgpr_read_b32 v25, a53
    v_accvgpr_read_b32 v26, a54
    v_accvgpr_read_b32 v27, a55
    v_mul_f32 v24, v24, v9
    v_mul_f32 v25, v25, v9
    v_mul_f32 v26, v26, v9
    v_mul_f32 v27, v27, v9
    v_accvgpr_write_b32 a52, v24
    v_accvgpr_write_b32 a53, v25
    v_accvgpr_write_b32 a54, v26
    v_accvgpr_write_b32 a55, v27
    v_accvgpr_read_b32 v24, a56
    v_accvgpr_read_b32 v25, a57
    v_accvgpr_read_b32 v26, a58
    v_accvgpr_read_b32 v27, a59
    v_mul_f32 v24, v24, v9
    v_mul_f32 v25, v25, v9
    v_mul_f32 v26, v26, v9
    v_mul_f32 v27, v27, v9
    v_accvgpr_write_b32 a56, v24
    v_accvgpr_write_b32 a57, v25
    v_accvgpr_write_b32 a58, v26
    v_accvgpr_write_b32 a59, v27
    v_accvgpr_read_b32 v24, a60
    v_accvgpr_read_b32 v25, a61
    v_accvgpr_read_b32 v26, a62
    v_accvgpr_read_b32 v27, a63
    v_mul_f32 v24, v24, v9
    v_mul_f32 v25, v25, v9
    v_mul_f32 v26, v26, v9
    v_mul_f32 v27, v27, v9
    v_accvgpr_write_b32 a60, v24
    v_accvgpr_write_b32 a61, v25
    v_accvgpr_write_b32 a62, v26
    v_accvgpr_write_b32 a63, v27
    s_nop 1
    v_mfma_f32_16x16x32_bf16 a[32:35], a[224:227], v[16:19], a[32:35]
    v_mfma_f32_16x16x32_bf16 a[36:39], a[228:231], v[16:19], a[36:39]
    v_mfma_f32_16x16x32_bf16 a[40:43], a[232:235], v[16:19], a[40:43]
    v_mfma_f32_16x16x32_bf16 a[44:47], a[236:239], v[16:19], a[44:47]
    v_mfma_f32_16x16x32_bf16 a[48:51], a[240:243], v[16:19], a[48:51]
    v_mfma_f32_16x16x32_bf16 a[52:55], a[244:247], v[16:19], a[52:55]
    v_mfma_f32_16x16x32_bf16 a[56:59], a[248:251], v[16:19], a[56:59]
    v_mfma_f32_16x16x32_bf16 a[60:63], a[252:255], v[16:19], a[60:63]
    v_mfma_f32_16x16x32_bf16 v[16:19], a[192:195], v[160:163], 0
    v_mfma_f32_16x16x32_bf16 v[16:19], a[196:199], v[164:167], v[16:19]
    v_mfma_f32_16x16x32_bf16 v[16:19], a[200:203], v[168:171], v[16:19]
    v_mfma_f32_16x16x32_bf16 v[16:19], a[204:207], v[172:175], v[16:19]
    v_mfma_f32_16x16x32_bf16 v[20:23], a[208:211], v[160:163], 0
    v_mfma_f32_16x16x32_bf16 v[20:23], a[212:215], v[164:167], v[20:23]
    v_mfma_f32_16x16x32_bf16 v[20:23], a[216:219], v[168:171], v[20:23]
    v_mfma_f32_16x16x32_bf16 v[20:23], a[220:223], v[172:175], v[20:23]
    s_nop 7
    v_mul_f32 v16, s30, v16
    v_mul_f32 v17, s30, v17
    v_mul_f32 v18, s30, v18
    v_mul_f32 v19, s30, v19
    v_mul_f32 v20, s30, v20
    v_mul_f32 v21, s30, v21
    v_mul_f32 v22, s30, v22
    v_mul_f32 v23, s30, v23
    v_max3_f32 v8, v16, v17, v18
    v_max3_f32 v8, v8, v19, v20
    v_max3_f32 v8, v8, v21, v22
    v_max3_f32 v8, v8, v23, v122
    v_mov_b32 v9, v8
    s_nop 1
    v_permlane16_swap_b32 v9, v8
    v_max_f32 v8, v8, v9
    v_mov_b32 v9, v8
    s_nop 1
    v_permlane32_swap_b32 v9, v8
    v_max_f32 v8, v8, v9
    v_sub_f32 v9, v122, v8
    v_exp_f32 v9, v9
    v_mov_b32 v122, v8
    v_sub_f32 v16, v16, v8
    v_sub_f32 v17, v17, v8
    v_sub_f32 v18, v18, v8
    v_sub_f32 v19, v19, v8
    v_sub_f32 v20, v20, v8
    v_sub_f32 v21, v21, v8
    v_sub_f32 v22, v22, v8
    v_sub_f32 v23, v23, v8
    v_exp_f32 v16, v16
    v_exp_f32 v17, v17
    v_exp_f32 v18, v18
    v_exp_f32 v19, v19
    v_exp_f32 v20, v20
    v_exp_f32 v21, v21
    v_exp_f32 v22, v22
    v_exp_f32 v23, v23
    v_mul_f32 v114, v114, v9
    v_add_f32 v114, v114, v16
    v_add_f32 v114, v114, v17
    v_add_f32 v114, v114, v18
    v_add_f32 v114, v114, v19
    v_add_f32 v114, v114, v20
    v_add_f32 v114, v114, v21
    v_add_f32 v114, v114, v22
    v_add_f32 v114, v114, v23
    v_cvt_pk_bf16_f32 v16, v16, v17
    v_cvt_pk_bf16_f32 v17, v18, v19
    v_cvt_pk_bf16_f32 v18, v20, v21
    v_cvt_pk_bf16_f32 v19, v22, v23
    v_accvgpr_read_b32 v24, a64
    v_accvgpr_read_b32 v25, a65
    v_accvgpr_read_b32 v26, a66
    v_accvgpr_read_b32 v27, a67
    v_mul_f32 v24, v24, v9
    v_mul_f32 v25, v25, v9
    v_mul_f32 v26, v26, v9
    v_mul_f32 v27, v27, v9
    v_accvgpr_write_b32 a64, v24
    v_accvgpr_write_b32 a65, v25
    v_accvgpr_write_b32 a66, v26
    v_accvgpr_write_b32 a67, v27
    v_accvgpr_read_b32 v24, a68
    v_accvgpr_read_b32 v25, a69
    v_accvgpr_read_b32 v26, a70
    v_accvgpr_read_b32 v27, a71
    v_mul_f32 v24, v24, v9
    v_mul_f32 v25, v25, v9
    v_mul_f32 v26, v26, v9
    v_mul_f32 v27, v27, v9
    v_accvgpr_write_b32 a68, v24
    v_accvgpr_write_b32 a69, v25
    v_accvgpr_write_b32 a70, v26
    v_accvgpr_write_b32 a71, v27
    v_accvgpr_read_b32 v24, a72
    v_accvgpr_read_b32 v25, a73
    v_accvgpr_read_b32 v26, a74
    v_accvgpr_read_b32 v27, a75
    v_mul_f32 v24, v24, v9
    v_mul_f32 v25, v25, v9
    v_mul_f32 v26, v26, v9
    v_mul_f32 v27, v27, v9
    v_accvgpr_write_b32 a72, v24
    v_accvgpr_write_b32 a73, v25
    v_accvgpr_write_b32 a74, v26
    v_accvgpr_write_b32 a75, v27
    v_accvgpr_read_b32 v24, a76
    v_accvgpr_read_b32 v25, a77
    v_accvgpr_read_b32 v26, a78
    v_accvgpr_read_b32 v27, a79
    v_mul_f32 v24, v24, v9
    v_mul_f32 v25, v25, v9
    v_mul_f32 v26, v26, v9
    v_mul_f32 v27, v27, v9
    v_accvgpr_write_b32 a76, v24
    v_accvgpr_write_b32 a77, v25
    v_accvgpr_write_b32 a78, v26
    v_accvgpr_write_b32 a79, v27
    v_accvgpr_read_b32 v24, a80
    v_accvgpr_read_b32 v25, a81
    v_accvgpr_read_b32 v26, a82
    v_accvgpr_read_b32 v27, a83
    v_mul_f32 v24, v24, v9
    v_mul_f32 v25, v25, v9
    v_mul_f32 v26, v26, v9
    v_mul_f32 v27, v27, v9
    v_accvgpr_write_b32 a80, v24
    v_accvgpr_write_b32 a81, v25
    v_accvgpr_write_b32 a82, v26
    v_accvgpr_write_b32 a83, v27
    v_accvgpr_read_b32 v24, a84
    v_accvgpr_read_b32 v25, a85
    v_accvgpr_read_b32 v26, a86
    v_accvgpr_read_b32 v27, a87
    v_mul_f32 v24, v24, v9
    v_mul_f32 v25, v25, v9
    v_mul_f32 v26, v26, v9
    v_mul_f32 v27, v27, v9
    v_accvgpr_write_b32 a84, v24
    v_accvgpr_write_b32 a85, v25
    v_accvgpr_write_b32 a86, v26
    v_accvgpr_write_b32 a87, v27
    v_accvgpr_read_b32 v24, a88
    v_accvgpr_read_b32 v25, a89
    v_accvgpr_read_b32 v26, a90
    v_accvgpr_read_b32 v27, a91
    v_mul_f32 v24, v24, v9
    v_mul_f32 v25, v25, v9
    v_mul_f32 v26, v26, v9
    v_mul_f32 v27, v27, v9
    v_accvgpr_write_b32 a88, v24
    v_accvgpr_write_b32 a89, v25
    v_accvgpr_write_b32 a90, v26
    v_accvgpr_write_b32 a91, v27
    v_accvgpr_read_b32 v24, a92
    v_accvgpr_read_b32 v25, a93
    v_accvgpr_read_b32 v26, a94
    v_accvgpr_read_b32 v27, a95
    v_mul_f32 v24, v24, v9
    v_mul_f32 v25, v25, v9
    v_mul_f32 v26, v26, v9
    v_mul_f32 v27, v27, v9
    v_accvgpr_write_b32 a92, v24
    v_accvgpr_write_b32 a93, v25
    v_accvgpr_write_b32 a94, v26
    v_accvgpr_write_b32 a95, v27
    s_nop 1
    v_mfma_f32_16x16x32_bf16 a[64:67], a[224:227], v[16:19], a[64:67]
    v_mfma_f32_16x16x32_bf16 a[68:71], a[228:231], v[16:19], a[68:71]
    v_mfma_f32_16x16x32_bf16 a[72:75], a[232:235], v[16:19], a[72:75]
    v_mfma_f32_16x16x32_bf16 a[76:79], a[236:239], v[16:19], a[76:79]
    v_mfma_f32_16x16x32_bf16 a[80:83], a[240:243], v[16:19], a[80:83]
    v_mfma_f32_16x16x32_bf16 a[84:87], a[244:247], v[16:19], a[84:87]
    v_mfma_f32_16x16x32_bf16 a[88:91], a[248:251], v[16:19], a[88:91]
    v_mfma_f32_16x16x32_bf16 a[92:95], a[252:255], v[16:19], a[92:95]
    v_mfma_f32_16x16x32_bf16 v[16:19], a[192:195], v[176:179], 0
    v_mfma_f32_16x16x32_bf16 v[16:19], a[196:199], v[180:183], v[16:19]
    v_mfma_f32_16x16x32_bf16 v[16:19], a[200:203], v[184:187], v[16:19]
    v_mfma_f32_16x16x32_bf16 v[16:19], a[204:207], v[188:191], v[16:19]
    v_mfma_f32_16x16x32_bf16 v[20:23], a[208:211], v[176:179], 0
    v_mfma_f32_16x16x32_bf16 v[20:23], a[212:215], v[180:183], v[20:23]
    v_mfma_f32_16x16x32_bf16 v[20:23], a[216:219], v[184:187], v[20:23]
    v_mfma_f32_16x16x32_bf16 v[20:23], a[220:223], v[188:191], v[20:23]
    s_nop 7
    v_mul_f32 v16, s30, v16
    v_mul_f32 v17, s30, v17
    v_mul_f32 v18, s30, v18
    v_mul_f32 v19, s30, v19
    v_mul_f32 v20, s30, v20
    v_mul_f32 v21, s30, v21
    v_mul_f32 v22, s30, v22
    v_mul_f32 v23, s30, v23
    v_max3_f32 v8, v16, v17, v18
    v_max3_f32 v8, v8, v19, v20
    v_max3_f32 v8, v8, v21, v22
    v_max3_f32 v8, v8, v23, v123
    v_mov_b32 v9, v8
    s_nop 1
    v_permlane16_swap_b32 v9, v8
    v_max_f32 v8, v8, v9
    v_mov_b32 v9, v8
    s_nop 1
    v_permlane32_swap_b32 v9, v8
    v_max_f32 v8, v8, v9
    v_sub_f32 v9, v123, v8
    v_exp_f32 v9, v9
    v_mov_b32 v123, v8
    v_sub_f32 v16, v16, v8
    v_sub_f32 v17, v17, v8
    v_sub_f32 v18, v18, v8
    v_sub_f32 v19, v19, v8
    v_sub_f32 v20, v20, v8
    v_sub_f32 v21, v21, v8
    v_sub_f32 v22, v22, v8
    v_sub_f32 v23, v23, v8
    v_exp_f32 v16, v16
    v_exp_f32 v17, v17
    v_exp_f32 v18, v18
    v_exp_f32 v19, v19
    v_exp_f32 v20, v20
    v_exp_f32 v21, v21
    v_exp_f32 v22, v22
    v_exp_f32 v23, v23
    v_mul_f32 v115, v115, v9
    v_add_f32 v115, v115, v16
    v_add_f32 v115, v115, v17
    v_add_f32 v115, v115, v18
    v_add_f32 v115, v115, v19
    v_add_f32 v115, v115, v20
    v_add_f32 v115, v115, v21
    v_add_f32 v115, v115, v22
    v_add_f32 v115, v115, v23
    v_cvt_pk_bf16_f32 v16, v16, v17
    v_cvt_pk_bf16_f32 v17, v18, v19
    v_cvt_pk_bf16_f32 v18, v20, v21
    v_cvt_pk_bf16_f32 v19, v22, v23
    v_accvgpr_read_b32 v24, a96
    v_accvgpr_read_b32 v25, a97
    v_accvgpr_read_b32 v26, a98
    v_accvgpr_read_b32 v27, a99
    v_mul_f32 v24, v24, v9
    v_mul_f32 v25, v25, v9
    v_mul_f32 v26, v26, v9
    v_mul_f32 v27, v27, v9
    v_accvgpr_write_b32 a96, v24
    v_accvgpr_write_b32 a97, v25
    v_accvgpr_write_b32 a98, v26
    v_accvgpr_write_b32 a99, v27
    v_accvgpr_read_b32 v24, a100
    v_accvgpr_read_b32 v25, a101
    v_accvgpr_read_b32 v26, a102
    v_accvgpr_read_b32 v27, a103
    v_mul_f32 v24, v24, v9
    v_mul_f32 v25, v25, v9
    v_mul_f32 v26, v26, v9
    v_mul_f32 v27, v27, v9
    v_accvgpr_write_b32 a100, v24
    v_accvgpr_write_b32 a101, v25
    v_accvgpr_write_b32 a102, v26
    v_accvgpr_write_b32 a103, v27
    v_accvgpr_read_b32 v24, a104
    v_accvgpr_read_b32 v25, a105
    v_accvgpr_read_b32 v26, a106
    v_accvgpr_read_b32 v27, a107
    v_mul_f32 v24, v24, v9
    v_mul_f32 v25, v25, v9
    v_mul_f32 v26, v26, v9
    v_mul_f32 v27, v27, v9
    v_accvgpr_write_b32 a104, v24
    v_accvgpr_write_b32 a105, v25
    v_accvgpr_write_b32 a106, v26
    v_accvgpr_write_b32 a107, v27
    v_accvgpr_read_b32 v24, a108
    v_accvgpr_read_b32 v25, a109
    v_accvgpr_read_b32 v26, a110
    v_accvgpr_read_b32 v27, a111
    v_mul_f32 v24, v24, v9
    v_mul_f32 v25, v25, v9
    v_mul_f32 v26, v26, v9
    v_mul_f32 v27, v27, v9
    v_accvgpr_write_b32 a108, v24
    v_accvgpr_write_b32 a109, v25
    v_accvgpr_write_b32 a110, v26
    v_accvgpr_write_b32 a111, v27
    v_accvgpr_read_b32 v24, a112
    v_accvgpr_read_b32 v25, a113
    v_accvgpr_read_b32 v26, a114
    v_accvgpr_read_b32 v27, a115
    v_mul_f32 v24, v24, v9
    v_mul_f32 v25, v25, v9
    v_mul_f32 v26, v26, v9
    v_mul_f32 v27, v27, v9
    v_accvgpr_write_b32 a112, v24
    v_accvgpr_write_b32 a113, v25
    v_accvgpr_write_b32 a114, v26
    v_accvgpr_write_b32 a115, v27
    v_accvgpr_read_b32 v24, a116
    v_accvgpr_read_b32 v25, a117
    v_accvgpr_read_b32 v26, a118
    v_accvgpr_read_b32 v27, a119
    v_mul_f32 v24, v24, v9
    v_mul_f32 v25, v25, v9
    v_mul_f32 v26, v26, v9
    v_mul_f32 v27, v27, v9
    v_accvgpr_write_b32 a116, v24
    v_accvgpr_write_b32 a117, v25
    v_accvgpr_write_b32 a118, v26
    v_accvgpr_write_b32 a119, v27
    v_accvgpr_read_b32 v24, a120
    v_accvgpr_read_b32 v25, a121
    v_accvgpr_read_b32 v26, a122
    v_accvgpr_read_b32 v27, a123
    v_mul_f32 v24, v24, v9
    v_mul_f32 v25, v25, v9
    v_mul_f32 v26, v26, v9
    v_mul_f32 v27, v27, v9
    v_accvgpr_write_b32 a120, v24
    v_accvgpr_write_b32 a121, v25
    v_accvgpr_write_b32 a122, v26
    v_accvgpr_write_b32 a123, v27
    v_accvgpr_read_b32 v24, a124
    v_accvgpr_read_b32 v25, a125
    v_accvgpr_read_b32 v26, a126
    v_accvgpr_read_b32 v27, a127
    v_mul_f32 v24, v24, v9
    v_mul_f32 v25, v25, v9
    v_mul_f32 v26, v26, v9
    v_mul_f32 v27, v27, v9
    v_accvgpr_write_b32 a124, v24
    v_accvgpr_write_b32 a125, v25
    v_accvgpr_write_b32 a126, v26
    v_accvgpr_write_b32 a127, v27
    s_nop 1
    v_mfma_f32_16x16x32_bf16 a[96:99], a[224:227], v[16:19], a[96:99]
    v_mfma_f32_16x16x32_bf16 a[100:103], a[228:231], v[16:19], a[100:103]
    v_mfma_f32_16x16x32_bf16 a[104:107], a[232:235], v[16:19], a[104:107]
    v_mfma_f32_16x16x32_bf16 a[108:111], a[236:239], v[16:19], a[108:111]
    v_mfma_f32_16x16x32_bf16 a[112:115], a[240:243], v[16:19], a[112:115]
    v_mfma_f32_16x16x32_bf16 a[116:119], a[244:247], v[16:19], a[116:119]
    v_mfma_f32_16x16x32_bf16 a[120:123], a[248:251], v[16:19], a[120:123]
    v_mfma_f32_16x16x32_bf16 a[124:127], a[252:255], v[16:19], a[124:127]
    v_mfma_f32_16x16x32_bf16 v[16:19], a[192:195], v[192:195], 0
    v_mfma_f32_16x16x32_bf16 v[16:19], a[196:199], v[196:199], v[16:19]
    v_mfma_f32_16x16x32_bf16 v[16:19], a[200:203], v[200:203], v[16:19]
    v_mfma_f32_16x16x32_bf16 v[16:19], a[204:207], v[204:207], v[16:19]
    v_mfma_f32_16x16x32_bf16 v[20:23], a[208:211], v[192:195], 0
    v_mfma_f32_16x16x32_bf16 v[20:23], a[212:215], v[196:199], v[20:23]
    v_mfma_f32_16x16x32_bf16 v[20:23], a[216:219], v[200:203], v[20:23]
    v_mfma_f32_16x16x32_bf16 v[20:23], a[220:223], v[204:207], v[20:23]
    s_nop 7
    v_mul_f32 v16, s30, v16
    v_mul_f32 v17, s30, v17
    v_mul_f32 v18, s30, v18
    v_mul_f32 v19, s30, v19
    v_mul_f32 v20, s30, v20
    v_mul_f32 v21, s30, v21
    v_mul_f32 v22, s30, v22
    v_mul_f32 v23, s30, v23
    v_max3_f32 v8, v16, v17, v18
    v_max3_f32 v8, v8, v19, v20
    v_max3_f32 v8, v8, v21, v22
    v_max3_f32 v8, v8, v23, v124
    v_mov_b32 v9, v8
    s_nop 1
    v_permlane16_swap_b32 v9, v8
    v_max_f32 v8, v8, v9
    v_mov_b32 v9, v8
    s_nop 1
    v_permlane32_swap_b32 v9, v8
    v_max_f32 v8, v8, v9
    v_sub_f32 v9, v124, v8
    v_exp_f32 v9, v9
    v_mov_b32 v124, v8
    v_sub_f32 v16, v16, v8
    v_sub_f32 v17, v17, v8
    v_sub_f32 v18, v18, v8
    v_sub_f32 v19, v19, v8
    v_sub_f32 v20, v20, v8
    v_sub_f32 v21, v21, v8
    v_sub_f32 v22, v22, v8
    v_sub_f32 v23, v23, v8
    v_exp_f32 v16, v16
    v_exp_f32 v17, v17
    v_exp_f32 v18, v18
    v_exp_f32 v19, v19
    v_exp_f32 v20, v20
    v_exp_f32 v21, v21
    v_exp_f32 v22, v22
    v_exp_f32 v23, v23
    v_mul_f32 v116, v116, v9
    v_add_f32 v116, v116, v16
    v_add_f32 v116, v116, v17
    v_add_f32 v116, v116, v18
    v_add_f32 v116, v116, v19
    v_add_f32 v116, v116, v20
    v_add_f32 v116, v116, v21
    v_add_f32 v116, v116, v22
    v_add_f32 v116, v116, v23
    v_cvt_pk_bf16_f32 v16, v16, v17
    v_cvt_pk_bf16_f32 v17, v18, v19
    v_cvt_pk_bf16_f32 v18, v20, v21
    v_cvt_pk_bf16_f32 v19, v22, v23
    v_accvgpr_read_b32 v24, a128
    v_accvgpr_read_b32 v25, a129
    v_accvgpr_read_b32 v26, a130
    v_accvgpr_read_b32 v27, a131
    v_mul_f32 v24, v24, v9
    v_mul_f32 v25, v25, v9
    v_mul_f32 v26, v26, v9
    v_mul_f32 v27, v27, v9
    v_accvgpr_write_b32 a128, v24
    v_accvgpr_write_b32 a129, v25
    v_accvgpr_write_b32 a130, v26
    v_accvgpr_write_b32 a131, v27
    v_accvgpr_read_b32 v24, a132
    v_accvgpr_read_b32 v25, a133
    v_accvgpr_read_b32 v26, a134
    v_accvgpr_read_b32 v27, a135
    v_mul_f32 v24, v24, v9
    v_mul_f32 v25, v25, v9
    v_mul_f32 v26, v26, v9
    v_mul_f32 v27, v27, v9
    v_accvgpr_write_b32 a132, v24
    v_accvgpr_write_b32 a133, v25
    v_accvgpr_write_b32 a134, v26
    v_accvgpr_write_b32 a135, v27
    v_accvgpr_read_b32 v24, a136
    v_accvgpr_read_b32 v25, a137
    v_accvgpr_read_b32 v26, a138
    v_accvgpr_read_b32 v27, a139
    v_mul_f32 v24, v24, v9
    v_mul_f32 v25, v25, v9
    v_mul_f32 v26, v26, v9
    v_mul_f32 v27, v27, v9
    v_accvgpr_write_b32 a136, v24
    v_accvgpr_write_b32 a137, v25
    v_accvgpr_write_b32 a138, v26
    v_accvgpr_write_b32 a139, v27
    v_accvgpr_read_b32 v24, a140
    v_accvgpr_read_b32 v25, a141
    v_accvgpr_read_b32 v26, a142
    v_accvgpr_read_b32 v27, a143
    v_mul_f32 v24, v24, v9
    v_mul_f32 v25, v25, v9
    v_mul_f32 v26, v26, v9
    v_mul_f32 v27, v27, v9
    v_accvgpr_write_b32 a140, v24
    v_accvgpr_write_b32 a141, v25
    v_accvgpr_write_b32 a142, v26
    v_accvgpr_write_b32 a143, v27
    v_accvgpr_read_b32 v24, a144
    v_accvgpr_read_b32 v25, a145
    v_accvgpr_read_b32 v26, a146
    v_accvgpr_read_b32 v27, a147
    v_mul_f32 v24, v24, v9
    v_mul_f32 v25, v25, v9
    v_mul_f32 v26, v26, v9
    v_mul_f32 v27, v27, v9
    v_accvgpr_write_b32 a144, v24
    v_accvgpr_write_b32 a145, v25
    v_accvgpr_write_b32 a146, v26
    v_accvgpr_write_b32 a147, v27
    v_accvgpr_read_b32 v24, a148
    v_accvgpr_read_b32 v25, a149
    v_accvgpr_read_b32 v26, a150
    v_accvgpr_read_b32 v27, a151
    v_mul_f32 v24, v24, v9
    v_mul_f32 v25, v25, v9
    v_mul_f32 v26, v26, v9
    v_mul_f32 v27, v27, v9
    v_accvgpr_write_b32 a148, v24
    v_accvgpr_write_b32 a149, v25
    v_accvgpr_write_b32 a150, v26
    v_accvgpr_write_b32 a151, v27
    v_accvgpr_read_b32 v24, a152
    v_accvgpr_read_b32 v25, a153
    v_accvgpr_read_b32 v26, a154
    v_accvgpr_read_b32 v27, a155
    v_mul_f32 v24, v24, v9
    v_mul_f32 v25, v25, v9
    v_mul_f32 v26, v26, v9
    v_mul_f32 v27, v27, v9
    v_accvgpr_write_b32 a152, v24
    v_accvgpr_write_b32 a153, v25
    v_accvgpr_write_b32 a154, v26
    v_accvgpr_write_b32 a155, v27
    v_accvgpr_read_b32 v24, a156
    v_accvgpr_read_b32 v25, a157
    v_accvgpr_read_b32 v26, a158
    v_accvgpr_read_b32 v27, a159
    v_mul_f32 v24, v24, v9
    v_mul_f32 v25, v25, v9
    v_mul_f32 v26, v26, v9
    v_mul_f32 v27, v27, v9
    v_accvgpr_write_b32 a156, v24
    v_accvgpr_write_b32 a157, v25
    v_accvgpr_write_b32 a158, v26
    v_accvgpr_write_b32 a159, v27
    s_nop 1
    v_mfma_f32_16x16x32_bf16 a[128:131], a[224:227], v[16:19], a[128:131]
    v_mfma_f32_16x16x32_bf16 a[132:135], a[228:231], v[16:19], a[132:135]
    v_mfma_f32_16x16x32_bf16 a[136:139], a[232:235], v[16:19], a[136:139]
    v_mfma_f32_16x16x32_bf16 a[140:143], a[236:239], v[16:19], a[140:143]
    v_mfma_f32_16x16x32_bf16 a[144:147], a[240:243], v[16:19], a[144:147]
    v_mfma_f32_16x16x32_bf16 a[148:151], a[244:247], v[16:19], a[148:151]
    v_mfma_f32_16x16x32_bf16 a[152:155], a[248:251], v[16:19], a[152:155]
    v_mfma_f32_16x16x32_bf16 a[156:159], a[252:255], v[16:19], a[156:159]
    v_mfma_f32_16x16x32_bf16 v[16:19], a[192:195], v[208:211], 0
    v_mfma_f32_16x16x32_bf16 v[16:19], a[196:199], v[212:215], v[16:19]
    v_mfma_f32_16x16x32_bf16 v[16:19], a[200:203], v[216:219], v[16:19]
    v_mfma_f32_16x16x32_bf16 v[16:19], a[204:207], v[220:223], v[16:19]
    v_mfma_f32_16x16x32_bf16 v[20:23], a[208:211], v[208:211], 0
    v_mfma_f32_16x16x32_bf16 v[20:23], a[212:215], v[212:215], v[20:23]
    v_mfma_f32_16x16x32_bf16 v[20:23], a[216:219], v[216:219], v[20:23]
    v_mfma_f32_16x16x32_bf16 v[20:23], a[220:223], v[220:223], v[20:23]
    s_nop 7
    v_mul_f32 v16, s30, v16
    v_mul_f32 v17, s30, v17
    v_mul_f32 v18, s30, v18
    v_mul_f32 v19, s30, v19
    v_mul_f32 v20, s30, v20
    v_mul_f32 v21, s30, v21
    v_mul_f32 v22, s30, v22
    v_mul_f32 v23, s30, v23
    v_max3_f32 v8, v16, v17, v18
    v_max3_f32 v8, v8, v19, v20
    v_max3_f32 v8, v8, v21, v22
    v_max3_f32 v8, v8, v23, v125
    v_mov_b32 v9, v8
    s_nop 1
    v_permlane16_swap_b32 v9, v8
    v_max_f32 v8, v8, v9
    v_mov_b32 v9, v8
    s_nop 1
    v_permlane32_swap_b32 v9, v8
    v_max_f32 v8, v8, v9
    v_sub_f32 v9, v125, v8
    v_exp_f32 v9, v9
    v_mov_b32 v125, v8
    v_sub_f32 v16, v16, v8
    v_sub_f32 v17, v17, v8
    v_sub_f32 v18, v18, v8
    v_sub_f32 v19, v19, v8
    v_sub_f32 v20, v20, v8
    v_sub_f32 v21, v21, v8
    v_sub_f32 v22, v22, v8
    v_sub_f32 v23, v23, v8
    v_exp_f32 v16, v16
    v_exp_f32 v17, v17
    v_exp_f32 v18, v18
    v_exp_f32 v19, v19
    v_exp_f32 v20, v20
    v_exp_f32 v21, v21
    v_exp_f32 v22, v22
    v_exp_f32 v23, v23
    v_mul_f32 v117, v117, v9
    v_add_f32 v117, v117, v16
    v_add_f32 v117, v117, v17
    v_add_f32 v117, v117, v18
    v_add_f32 v117, v117, v19
    v_add_f32 v117, v117, v20
    v_add_f32 v117, v117, v21
    v_add_f32 v117, v117, v22
    v_add_f32 v117, v117, v23
    v_cvt_pk_bf16_f32 v16, v16, v17
    v_cvt_pk_bf16_f32 v17, v18, v19
    v_cvt_pk_bf16_f32 v18, v20, v21
    v_cvt_pk_bf16_f32 v19, v22, v23
    v_accvgpr_read_b32 v24, a160
    v_accvgpr_read_b32 v25, a161
    v_accvgpr_read_b32 v26, a162
    v_accvgpr_read_b32 v27, a163
    v_mul_f32 v24, v24, v9
    v_mul_f32 v25, v25, v9
    v_mul_f32 v26, v26, v9
    v_mul_f32 v27, v27, v9
    v_accvgpr_write_b32 a160, v24
    v_accvgpr_write_b32 a161, v25
    v_accvgpr_write_b32 a162, v26
    v_accvgpr_write_b32 a163, v27
    v_accvgpr_read_b32 v24, a164
    v_accvgpr_read_b32 v25, a165
    v_accvgpr_read_b32 v26, a166
    v_accvgpr_read_b32 v27, a167
    v_mul_f32 v24, v24, v9
    v_mul_f32 v25, v25, v9
    v_mul_f32 v26, v26, v9
    v_mul_f32 v27, v27, v9
    v_accvgpr_write_b32 a164, v24
    v_accvgpr_write_b32 a165, v25
    v_accvgpr_write_b32 a166, v26
    v_accvgpr_write_b32 a167, v27
    v_accvgpr_read_b32 v24, a168
    v_accvgpr_read_b32 v25, a169
    v_accvgpr_read_b32 v26, a170
    v_accvgpr_read_b32 v27, a171
    v_mul_f32 v24, v24, v9
    v_mul_f32 v25, v25, v9
    v_mul_f32 v26, v26, v9
    v_mul_f32 v27, v27, v9
    v_accvgpr_write_b32 a168, v24
    v_accvgpr_write_b32 a169, v25
    v_accvgpr_write_b32 a170, v26
    v_accvgpr_write_b32 a171, v27
    v_accvgpr_read_b32 v24, a172
    v_accvgpr_read_b32 v25, a173
    v_accvgpr_read_b32 v26, a174
    v_accvgpr_read_b32 v27, a175
    v_mul_f32 v24, v24, v9
    v_mul_f32 v25, v25, v9
    v_mul_f32 v26, v26, v9
    v_mul_f32 v27, v27, v9
    v_accvgpr_write_b32 a172, v24
    v_accvgpr_write_b32 a173, v25
    v_accvgpr_write_b32 a174, v26
    v_accvgpr_write_b32 a175, v27
    v_accvgpr_read_b32 v24, a176
    v_accvgpr_read_b32 v25, a177
    v_accvgpr_read_b32 v26, a178
    v_accvgpr_read_b32 v27, a179
    v_mul_f32 v24, v24, v9
    v_mul_f32 v25, v25, v9
    v_mul_f32 v26, v26, v9
    v_mul_f32 v27, v27, v9
    v_accvgpr_write_b32 a176, v24
    v_accvgpr_write_b32 a177, v25
    v_accvgpr_write_b32 a178, v26
    v_accvgpr_write_b32 a179, v27
    v_accvgpr_read_b32 v24, a180
    v_accvgpr_read_b32 v25, a181
    v_accvgpr_read_b32 v26, a182
    v_accvgpr_read_b32 v27, a183
    v_mul_f32 v24, v24, v9
    v_mul_f32 v25, v25, v9
    v_mul_f32 v26, v26, v9
    v_mul_f32 v27, v27, v9
    v_accvgpr_write_b32 a180, v24
    v_accvgpr_write_b32 a181, v25
    v_accvgpr_write_b32 a182, v26
    v_accvgpr_write_b32 a183, v27
    v_accvgpr_read_b32 v24, a184
    v_accvgpr_read_b32 v25, a185
    v_accvgpr_read_b32 v26, a186
    v_accvgpr_read_b32 v27, a187
    v_mul_f32 v24, v24, v9
    v_mul_f32 v25, v25, v9
    v_mul_f32 v26, v26, v9
    v_mul_f32 v27, v27, v9
    v_accvgpr_write_b32 a184, v24
    v_accvgpr_write_b32 a185, v25
    v_accvgpr_write_b32 a186, v26
    v_accvgpr_write_b32 a187, v27
    v_accvgpr_read_b32 v24, a188
    v_accvgpr_read_b32 v25, a189
    v_accvgpr_read_b32 v26, a190
    v_accvgpr_read_b32 v27, a191
    v_mul_f32 v24, v24, v9
    v_mul_f32 v25, v25, v9
    v_mul_f32 v26, v26, v9
    v_mul_f32 v27, v27, v9
    v_accvgpr_write_b32 a188, v24
    v_accvgpr_write_b32 a189, v25
    v_accvgpr_write_b32 a190, v26
    v_accvgpr_write_b32 a191, v27
    s_nop 1
    v_mfma_f32_16x16x32_bf16 a[160:163], a[224:227], v[16:19], a[160:163]
    v_mfma_f32_16x16x32_bf16 a[164:167], a[228:231], v[16:19], a[164:167]
    v_mfma_f32_16x16x32_bf16 a[168:171], a[232:235], v[16:19], a[168:171]
    v_mfma_f32_16x16x32_bf16 a[172:175], a[236:239], v[16:19], a[172:175]
    v_mfma_f32_16x16x32_bf16 a[176:179], a[240:243], v[16:19], a[176:179]
    v_mfma_f32_16x16x32_bf16 a[180:183], a[244:247], v[16:19], a[180:183]
    v_mfma_f32_16x16x32_bf16 a[184:187], a[248:251], v[16:19], a[184:187]
    v_mfma_f32_16x16x32_bf16 a[188:191], a[252:255], v[16:19], a[188:191]
    v_mfma_f32_16x16x32_bf16 v[16:19], a[192:195], v[224:227], 0
    v_mfma_f32_16x16x32_bf16 v[16:19], a[196:199], v[228:231], v[16:19]
    v_mfma_f32_16x16x32_bf16 v[16:19], a[200:203], v[232:235], v[16:19]
    v_mfma_f32_16x16x32_bf16 v[16:19], a[204:207], v[236:239], v[16:19]
    v_mfma_f32_16x16x32_bf16 v[20:23], a[208:211], v[224:227], 0
    v_mfma_f32_16x16x32_bf16 v[20:23], a[212:215], v[228:231], v[20:23]
    v_mfma_f32_16x16x32_bf16 v[20:23], a[216:219], v[232:235], v[20:23]
    v_mfma_f32_16x16x32_bf16 v[20:23], a[220:223], v[236:239], v[20:23]
    s_nop 7
    v_mul_f32 v16, s30, v16
    v_mul_f32 v17, s30, v17
    v_mul_f32 v18, s30, v18
    v_mul_f32 v19, s30, v19
    v_mul_f32 v20, s30, v20
    v_mul_f32 v21, s30, v21
    v_mul_f32 v22, s30, v22
    v_mul_f32 v23, s30, v23
    v_max3_f32 v8, v16, v17, v18
    v_max3_f32 v8, v8, v19, v20
    v_max3_f32 v8, v8, v21, v22
    v_max3_f32 v8, v8, v23, v126
    v_mov_b32 v9, v8
    s_nop 1
    v_permlane16_swap_b32 v9, v8
    v_max_f32 v8, v8, v9
    v_mov_b32 v9, v8
    s_nop 1
    v_permlane32_swap_b32 v9, v8
    v_max_f32 v8, v8, v9
    v_sub_f32 v9, v126, v8
    v_exp_f32 v9, v9
    v_mov_b32 v126, v8
    v_sub_f32 v16, v16, v8
    v_sub_f32 v17, v17, v8
    v_sub_f32 v18, v18, v8
    v_sub_f32 v19, v19, v8
    v_sub_f32 v20, v20, v8
    v_sub_f32 v21, v21, v8
    v_sub_f32 v22, v22, v8
    v_sub_f32 v23, v23, v8
    v_exp_f32 v16, v16
    v_exp_f32 v17, v17
    v_exp_f32 v18, v18
    v_exp_f32 v19, v19
    v_exp_f32 v20, v20
    v_exp_f32 v21, v21
    v_exp_f32 v22, v22
    v_exp_f32 v23, v23
    v_mul_f32 v118, v118, v9
    v_add_f32 v118, v118, v16
    v_add_f32 v118, v118, v17
    v_add_f32 v118, v118, v18
    v_add_f32 v118, v118, v19
    v_add_f32 v118, v118, v20
    v_add_f32 v118, v118, v21
    v_add_f32 v118, v118, v22
    v_add_f32 v118, v118, v23
    v_cvt_pk_bf16_f32 v16, v16, v17
    v_cvt_pk_bf16_f32 v17, v18, v19
    v_cvt_pk_bf16_f32 v18, v20, v21
    v_cvt_pk_bf16_f32 v19, v22, v23
    v_mul_f32 v48, v48, v9
    v_mul_f32 v49, v49, v9
    v_mul_f32 v50, v50, v9
    v_mul_f32 v51, v51, v9
    v_mul_f32 v52, v52, v9
    v_mul_f32 v53, v53, v9
    v_mul_f32 v54, v54, v9
    v_mul_f32 v55, v55, v9
    v_mul_f32 v56, v56, v9
    v_mul_f32 v57, v57, v9
    v_mul_f32 v58, v58, v9
    v_mul_f32 v59, v59, v9
    v_mul_f32 v60, v60, v9
    v_mul_f32 v61, v61, v9
    v_mul_f32 v62, v62, v9
    v_mul_f32 v63, v63, v9
    v_mul_f32 v64, v64, v9
    v_mul_f32 v65, v65, v9
    v_mul_f32 v66, v66, v9
    v_mul_f32 v67, v67, v9
    v_mul_f32 v68, v68, v9
    v_mul_f32 v69, v69, v9
    v_mul_f32 v70, v70, v9
    v_mul_f32 v71, v71, v9
    v_mul_f32 v72, v72, v9
    v_mul_f32 v73, v73, v9
    v_mul_f32 v74, v74, v9
    v_mul_f32 v75, v75, v9
    v_mul_f32 v76, v76, v9
    v_mul_f32 v77, v77, v9
    v_mul_f32 v78, v78, v9
    v_mul_f32 v79, v79, v9
    s_nop 1
    v_mfma_f32_16x16x32_bf16 v[48:51], a[224:227], v[16:19], v[48:51]
    v_mfma_f32_16x16x32_bf16 v[52:55], a[228:231], v[16:19], v[52:55]
    v_mfma_f32_16x16x32_bf16 v[56:59], a[232:235], v[16:19], v[56:59]
    v_mfma_f32_16x16x32_bf16 v[60:63], a[236:239], v[16:19], v[60:63]
    v_mfma_f32_16x16x32_bf16 v[64:67], a[240:243], v[16:19], v[64:67]
    v_mfma_f32_16x16x32_bf16 v[68:71], a[244:247], v[16:19], v[68:71]
    v_mfma_f32_16x16x32_bf16 v[72:75], a[248:251], v[16:19], v[72:75]
    v_mfma_f32_16x16x32_bf16 v[76:79], a[252:255], v[16:19], v[76:79]
    v_mfma_f32_16x16x32_bf16 v[16:19], a[192:195], v[240:243], 0
    v_mfma_f32_16x16x32_bf16 v[16:19], a[196:199], v[244:247], v[16:19]
    v_mfma_f32_16x16x32_bf16 v[16:19], a[200:203], v[248:251], v[16:19]
    v_mfma_f32_16x16x32_bf16 v[16:19], a[204:207], v[252:255], v[16:19]
    v_mfma_f32_16x16x32_bf16 v[20:23], a[208:211], v[240:243], 0
    v_mfma_f32_16x16x32_bf16 v[20:23], a[212:215], v[244:247], v[20:23]
    v_mfma_f32_16x16x32_bf16 v[20:23], a[216:219], v[248:251], v[20:23]
    v_mfma_f32_16x16x32_bf16 v[20:23], a[220:223], v[252:255], v[20:23]
    s_nop 7
    v_mul_f32 v16, s30, v16
    v_mul_f32 v17, s30, v17
    v_mul_f32 v18, s30, v18
    v_mul_f32 v19, s30, v19
    v_mul_f32 v20, s30, v20
    v_mul_f32 v21, s30, v21
    v_mul_f32 v22, s30, v22
    v_mul_f32 v23, s30, v23
    v_max3_f32 v8, v16, v17, v18
    v_max3_f32 v8, v8, v19, v20
    v_max3_f32 v8, v8, v21, v22
    v_max3_f32 v8, v8, v23, v127
    v_mov_b32 v9, v8
    s_nop 1
    v_permlane16_swap_b32 v9, v8
    v_max_f32 v8, v8, v9
    v_mov_b32 v9, v8
    s_nop 1
    v_permlane32_swap_b32 v9, v8
    v_max_f32 v8, v8, v9
    v_sub_f32 v9, v127, v8
    v_exp_f32 v9, v9
    v_mov_b32 v127, v8
    v_sub_f32 v16, v16, v8
    v_sub_f32 v17, v17, v8
    v_sub_f32 v18, v18, v8
    v_sub_f32 v19, v19, v8
    v_sub_f32 v20, v20, v8
    v_sub_f32 v21, v21, v8
    v_sub_f32 v22, v22, v8
    v_sub_f32 v23, v23, v8
    v_exp_f32 v16, v16
    v_exp_f32 v17, v17
    v_exp_f32 v18, v18
    v_exp_f32 v19, v19
    v_exp_f32 v20, v20
    v_exp_f32 v21, v21
    v_exp_f32 v22, v22
    v_exp_f32 v23, v23
    v_mul_f32 v119, v119, v9
    v_add_f32 v119, v119, v16
    v_add_f32 v119, v119, v17
    v_add_f32 v119, v119, v18
    v_add_f32 v119, v119, v19
    v_add_f32 v119, v119, v20
    v_add_f32 v119, v119, v21
    v_add_f32 v119, v119, v22
    v_add_f32 v119, v119, v23
    v_cvt_pk_bf16_f32 v16, v16, v17
    v_cvt_pk_bf16_f32 v17, v18, v19
    v_cvt_pk_bf16_f32 v18, v20, v21
    v_cvt_pk_bf16_f32 v19, v22, v23
    v_mul_f32 v80, v80, v9
    v_mul_f32 v81, v81, v9
    v_mul_f32 v82, v82, v9
    v_mul_f32 v83, v83, v9
    v_mul_f32 v84, v84, v9
    v_mul_f32 v85, v85, v9
    v_mul_f32 v86, v86, v9
    v_mul_f32 v87, v87, v9
    v_mul_f32 v88, v88, v9
    v_mul_f32 v89, v89, v9
    v_mul_f32 v90, v90, v9
    v_mul_f32 v91, v91, v9
    v_mul_f32 v92, v92, v9
    v_mul_f32 v93, v93, v9
    v_mul_f32 v94, v94, v9
    v_mul_f32 v95, v95, v9
    v_mul_f32 v96, v96, v9
    v_mul_f32 v97, v97, v9
    v_mul_f32 v98, v98, v9
    v_mul_f32 v99, v99, v9
    v_mul_f32 v100, v100, v9
    v_mul_f32 v101, v101, v9
    v_mul_f32 v102, v102, v9
    v_mul_f32 v103, v103, v9
    v_mul_f32 v104, v104, v9
    v_mul_f32 v105, v105, v9
    v_mul_f32 v106, v106, v9
    v_mul_f32 v107, v107, v9
    v_mul_f32 v108, v108, v9
    v_mul_f32 v109, v109, v9
    v_mul_f32 v110, v110, v9
    v_mul_f32 v111, v111, v9
    s_nop 1
    v_mfma_f32_16x16x32_bf16 v[80:83], a[224:227], v[16:19], v[80:83]
    v_mfma_f32_16x16x32_bf16 v[84:87], a[228:231], v[16:19], v[84:87]
    v_mfma_f32_16x16x32_bf16 v[88:91], a[232:235], v[16:19], v[88:91]
    v_mfma_f32_16x16x32_bf16 v[92:95], a[236:239], v[16:19], v[92:95]
    v_mfma_f32_16x16x32_bf16 v[96:99], a[240:243], v[16:19], v[96:99]
    v_mfma_f32_16x16x32_bf16 v[100:103], a[244:247], v[16:19], v[100:103]
    v_mfma_f32_16x16x32_bf16 v[104:107], a[248:251], v[16:19], v[104:107]
    v_mfma_f32_16x16x32_bf16 v[108:111], a[252:255], v[16:19], v[108:111]
    s_add_u32 s25, s25, 8192
    s_cmp_lt_u32 s25, 262144
    s_cbranch_scc1 L_fb_loop
    s_nop 7
    v_mov_b32 v8, v112
    v_mov_b32 v9, v113
    v_mov_b32 v10, v114
    v_mov_b32 v11, v115
    v_mov_b32 v12, v116
    v_mov_b32 v13, v117
    v_mov_b32 v14, v118
    v_mov_b32 v15, v119
    s_nop 1
    v_permlane16_swap_b32 v8, v112
    v_permlane16_swap_b32 v9, v113
    v_permlane16_swap_b32 v10, v114
    v_permlane16_swap_b32 v11, v115
    v_permlane16_swap_b32 v12, v116
    v_permlane16_swap_b32 v13, v117
    v_permlane16_swap_b32 v14, v118
    v_permlane16_swap_b32 v15, v119
    v_add_f32 v112, v112, v8
    v_add_f32 v113, v113, v9
    v_add_f32 v114, v114, v10
    v_add_f32 v115, v115, v11
    v_add_f32 v116, v116, v12
    v_add_f32 v117, v117, v13
    v_add_f32 v118, v118, v14
    v_add_f32 v119, v119, v15
    v_mov_b32 v8, v112
    v_mov_b32 v9, v113
    v_mov_b32 v10, v114
    v_mov_b32 v11, v115
    v_mov_b32 v12, v116
    v_mov_b32 v13, v117
    v_mov_b32 v14, v118
    v_mov_b32 v15, v119
    s_nop 1
    v_permlane32_swap_b32 v8, v112
    v_permlane32_swap_b32 v9, v113
    v_permlane32_swap_b32 v10, v114
    v_permlane32_swap_b32 v11, v115
    v_permlane32_swap_b32 v12, v116
    v_permlane32_swap_b32 v13, v117
    v_permlane32_swap_b32 v14, v118
    v_permlane32_swap_b32 v15, v119
    v_add_f32 v112, v112, v8
    v_add_f32 v113, v113, v9
    v_add_f32 v114, v114, v10
    v_add_f32 v115, v115, v11
    v_add_f32 v116, v116, v12
    v_add_f32 v117, v117, v13
    v_add_f32 v118, v118, v14
    v_add_f32 v119, v119, v15
    v_rcp_f32 v112, v112
    v_accvgpr_read_b32 v128, a0
    v_accvgpr_read_b32 v129, a1
    v_accvgpr_read_b32 v130, a2
    v_accvgpr_read_b32 v131, a3
    v_accvgpr_read_b32 v132, a4
    v_accvgpr_read_b32 v133, a5
    v_accvgpr_read_b32 v134, a6
    v_accvgpr_read_b32 v135, a7
    v_add_u32 v7, 0, v6
    v_pk_mul_f32 v[128:129], v[128:129], v[112:113] op_sel_hi:[1,0]
    v_pk_mul_f32 v[130:131], v[130:131], v[112:113] op_sel_hi:[1,0]
    v_pk_mul_f32 v[132:133], v[132:133], v[112:113] op_sel_hi:[1,0]
    v_pk_mul_f32 v[134:135], v[134:135], v[112:113] op_sel_hi:[1,0]
    v_cvt_pk_bf16_f32 v128, v128, v129
    v_cvt_pk_bf16_f32 v129, v130, v131
    v_cvt_pk_bf16_f32 v130, v132, v133
    v_cvt_pk_bf16_f32 v131, v134, v135
    v_accvgpr_read_b32 v136, a8
    v_accvgpr_read_b32 v137, a9
    v_permlane16_swap_b32 v128, v130
    v_permlane16_swap_b32 v129, v131
    buffer_store_dwordx4 v[128:131], v7, s[20:23], 0 offen
    v_accvgpr_read_b32 v138, a10
    v_accvgpr_read_b32 v139, a11
    v_accvgpr_read_b32 v140, a12
    v_accvgpr_read_b32 v141, a13
    v_accvgpr_read_b32 v142, a14
    v_accvgpr_read_b32 v143, a15
    v_pk_mul_f32 v[136:137], v[136:137], v[112:113] op_sel_hi:[1,0]
    v_pk_mul_f32 v[138:139], v[138:139], v[112:113] op_sel_hi:[1,0]
    v_pk_mul_f32 v[140:141], v[140:141], v[112:113] op_sel_hi:[1,0]
    v_pk_mul_f32 v[142:143], v[142:143], v[112:113] op_sel_hi:[1,0]
    v_cvt_pk_bf16_f32 v136, v136, v137
    v_cvt_pk_bf16_f32 v137, v138, v139
    v_cvt_pk_bf16_f32 v138, v140, v141
    v_cvt_pk_bf16_f32 v139, v142, v143
    v_accvgpr_read_b32 v132, a20
    v_accvgpr_read_b32 v133, a21
    v_permlane16_swap_b32 v136, v138
    v_permlane16_swap_b32 v137, v139
    buffer_store_dwordx4 v[136:139], v7, s[20:23], 0 offen offset:64
    v_accvgpr_read_b32 v134, a22
    v_accvgpr_read_b32 v135, a23
    v_accvgpr_read_b32 v128, a16
    v_accvgpr_read_b32 v129, a17
    v_accvgpr_read_b32 v130, a18
    v_accvgpr_read_b32 v131, a19
    v_pk_mul_f32 v[128:129], v[128:129], v[112:113] op_sel_hi:[1,0]
    v_pk_mul_f32 v[130:131], v[130:131], v[112:113] op_sel_hi:[1,0]
    v_pk_mul_f32 v[132:133], v[132:133], v[112:113] op_sel_hi:[1,0]
    v_pk_mul_f32 v[134:135], v[134:135], v[112:113] op_sel_hi:[1,0]
    v_cvt_pk_bf16_f32 v128, v128, v129
    v_cvt_pk_bf16_f32 v129, v130, v131
    v_cvt_pk_bf16_f32 v130, v132, v133
    v_cvt_pk_bf16_f32 v131, v134, v135
    v_accvgpr_read_b32 v140, a28
    v_accvgpr_read_b32 v141, a29
    v_permlane16_swap_b32 v128, v130
    v_permlane16_swap_b32 v129, v131
    buffer_store_dwordx4 v[128:131], v7, s[20:23], 0 offen offset:128
    v_accvgpr_read_b32 v142, a30
    v_accvgpr_read_b32 v143, a31
    v_accvgpr_read_b32 v136, a24
    v_accvgpr_read_b32 v137, a25
    v_accvgpr_read_b32 v138, a26
    v_accvgpr_read_b32 v139, a27
    v_pk_mul_f32 v[136:137], v[136:137], v[112:113] op_sel_hi:[1,0]
    v_pk_mul_f32 v[138:139], v[138:139], v[112:113] op_sel_hi:[1,0]
    v_pk_mul_f32 v[140:141], v[140:141], v[112:113] op_sel_hi:[1,0]
    v_pk_mul_f32 v[142:143], v[142:143], v[112:113] op_sel_hi:[1,0]
    v_cvt_pk_bf16_f32 v136, v136, v137
    v_cvt_pk_bf16_f32 v137, v138, v139
    v_cvt_pk_bf16_f32 v138, v140, v141
    v_cvt_pk_bf16_f32 v139, v142, v143
    s_nop 1
    v_permlane16_swap_b32 v136, v138
    v_permlane16_swap_b32 v137, v139
    buffer_store_dwordx4 v[136:139], v7, s[20:23], 0 offen offset:192
    v_rcp_f32 v113, v113
    v_accvgpr_read_b32 v144, a32
    v_accvgpr_read_b32 v145, a33
    v_accvgpr_read_b32 v146, a34
    v_accvgpr_read_b32 v147, a35
    v_accvgpr_read_b32 v148, a36
    v_accvgpr_read_b32 v149, a37
    v_accvgpr_read_b32 v150, a38
    v_accvgpr_read_b32 v151, a39
    v_add_u32 v7, 4096, v6
    v_pk_mul_f32 v[144:145], v[144:145], v[112:113] op_sel:[0,1] op_sel_hi:[1,1]
    v_pk_mul_f32 v[146:147], v[146:147], v[112:113] op_sel:[0,1] op_sel_hi:[1,1]
    v_pk_mul_f32 v[148:149], v[148:149], v[112:113] op_sel:[0,1] op_sel_hi:[1,1]
    v_pk_mul_f32 v[150:151], v[150:151], v[112:113] op_sel:[0,1] op_sel_hi:[1,1]
    v_cvt_pk_bf16_f32 v144, v144, v145
    v_cvt_pk_bf16_f32 v145, v146, v147
    v_cvt_pk_bf16_f32 v146, v148, v149
    v_cvt_pk_bf16_f32 v147, v150, v151
    v_accvgpr_read_b32 v152, a40
    v_accvgpr_read_b32 v153, a41
    v_permlane16_swap_b32 v144, v146
    v_permlane16_swap_b32 v145, v147
    buffer_store_dwordx4 v[144:147], v7, s[20:23], 0 offen
    v_accvgpr_read_b32 v154, a42
    v_accvgpr_read_b32 v155, a43
    v_accvgpr_read_b32 v156, a44
    v_accvgpr_read_b32 v157, a45
    v_accvgpr_read_b32 v158, a46
    v_accvgpr_read_b32 v159, a47
    v_pk_mul_f32 v[152:153], v[152:153], v[112:113] op_sel:[0,1] op_sel_hi:[1,1]
    v_pk_mul_f32 v[154:155], v[154:155], v[112:113] op_sel:[0,1] op_sel_hi:[1,1]
    v_pk_mul_f32 v[156:157], v[156:157], v[112:113] op_sel:[0,1] op_sel_hi:[1,1]
    v_pk_mul_f32 v[158:159], v[158:159], v[112:113] op_sel:[0,1] op_sel_hi:[1,1]
    v_cvt_pk_bf16_f32 v152, v152, v153
    v_cvt_pk_bf16_f32 v153, v154, v155
    v_cvt_pk_bf16_f32 v154, v156, v157
    v_cvt_pk_bf16_f32 v155, v158, v159
    v_accvgpr_read_b32 v148, a52
    v_accvgpr_read_b32 v149, a53
    v_permlane16_swap_b32 v152, v154
    v_permlane16_swap_b32 v153, v155
    buffer_store_dwordx4 v[152:155], v7, s[20:23], 0 offen offset:64
    v_accvgpr_read_b32 v150, a54
    v_accvgpr_read_b32 v151, a55
    v_accvgpr_read_b32 v144, a48
    v_accvgpr_read_b32 v145, a49
    v_accvgpr_read_b32 v146, a50
    v_accvgpr_read_b32 v147, a51
    v_pk_mul_f32 v[144:145], v[144:145], v[112:113] op_sel:[0,1] op_sel_hi:[1,1]
    v_pk_mul_f32 v[146:147], v[146:147], v[112:113] op_sel:[0,1] op_sel_hi:[1,1]
    v_pk_mul_f32 v[148:149], v[148:149], v[112:113] op_sel:[0,1] op_sel_hi:[1,1]
    v_pk_mul_f32 v[150:151], v[150:151], v[112:113] op_sel:[0,1] op_sel_hi:[1,1]
    v_cvt_pk_bf16_f32 v144, v144, v145
    v_cvt_pk_bf16_f32 v145, v146, v147
    v_cvt_pk_bf16_f32 v146, v148, v149
    v_cvt_pk_bf16_f32 v147, v150, v151
    v_accvgpr_read_b32 v156, a60
    v_accvgpr_read_b32 v157, a61
    v_permlane16_swap_b32 v144, v146
    v_permlane16_swap_b32 v145, v147
    buffer_store_dwordx4 v[144:147], v7, s[20:23], 0 offen offset:128
    v_accvgpr_read_b32 v158, a62
    v_accvgpr_read_b32 v159, a63
    v_accvgpr_read_b32 v152, a56
    v_accvgpr_read_b32 v153, a57
    v_accvgpr_read_b32 v154, a58
    v_accvgpr_read_b32 v155, a59
    v_pk_mul_f32 v[152:153], v[152:153], v[112:113] op_sel:[0,1] op_sel_hi:[1,1]
    v_pk_mul_f32 v[154:155], v[154:155], v[112:113] op_sel:[0,1] op_sel_hi:[1,1]
    v_pk_mul_f32 v[156:157], v[156:157], v[112:113] op_sel:[0,1] op_sel_hi:[1,1]
    v_pk_mul_f32 v[158:159], v[158:159], v[112:113] op_sel:[0,1] op_sel_hi:[1,1]
    v_cvt_pk_bf16_f32 v152, v152, v153
    v_cvt_pk_bf16_f32 v153, v154, v155
    v_cvt_pk_bf16_f32 v154, v156, v157
    v_cvt_pk_bf16_f32 v155, v158, v159
    s_nop 1
    v_permlane16_swap_b32 v152, v154
    v_permlane16_swap_b32 v153, v155
    buffer_store_dwordx4 v[152:155], v7, s[20:23], 0 offen offset:192
    v_rcp_f32 v114, v114
    v_accvgpr_read_b32 v160, a64
    v_accvgpr_read_b32 v161, a65
    v_accvgpr_read_b32 v162, a66
    v_accvgpr_read_b32 v163, a67
    v_accvgpr_read_b32 v164, a68
    v_accvgpr_read_b32 v165, a69
    v_accvgpr_read_b32 v166, a70
    v_accvgpr_read_b32 v167, a71
    v_add_u32 v7, 8192, v6
    v_pk_mul_f32 v[160:161], v[160:161], v[114:115] op_sel_hi:[1,0]
    v_pk_mul_f32 v[162:163], v[162:163], v[114:115] op_sel_hi:[1,0]
    v_pk_mul_f32 v[164:165], v[164:165], v[114:115] op_sel_hi:[1,0]
    v_pk_mul_f32 v[166:167], v[166:167], v[114:115] op_sel_hi:[1,0]
    v_cvt_pk_bf16_f32 v160, v160, v161
    v_cvt_pk_bf16_f32 v161, v162, v163
    v_cvt_pk_bf16_f32 v162, v164, v165
    v_cvt_pk_bf16_f32 v163, v166, v167
    v_accvgpr_read_b32 v168, a72
    v_accvgpr_read_b32 v169, a73
    v_permlane16_swap_b32 v160, v162
    v_permlane16_swap_b32 v161, v163
    buffer_store_dwordx4 v[160:163], v7, s[20:23], 0 offen
    v_accvgpr_read_b32 v170, a74
    v_accvgpr_read_b32 v171, a75
    v_accvgpr_read_b32 v172, a76
    v_accvgpr_read_b32 v173, a77
    v_accvgpr_read_b32 v174, a78
    v_accvgpr_read_b32 v175, a79
    v_pk_mul_f32 v[168:169], v[168:169], v[114:115] op_sel_hi:[1,0]
    v_pk_mul_f32 v[170:171], v[170:171], v[114:115] op_sel_hi:[1,0]
    v_pk_mul_f32 v[172:173], v[172:173], v[114:115] op_sel_hi:[1,0]
    v_pk_mul_f32 v[174:175], v[174:175], v[114:115] op_sel_hi:[1,0]
    v_cvt_pk_bf16_f32 v168, v168, v169
    v_cvt_pk_bf16_f32 v169, v170, v171
    v_cvt_pk_bf16_f32 v170, v172, v173
    v_cvt_pk_bf16_f32 v171, v174, v175
    v_accvgpr_read_b32 v164, a84
    v_accvgpr_read_b32 v165, a85
    v_permlane16_swap_b32 v168, v170
    v_permlane16_swap_b32 v169, v171
    buffer_store_dwordx4 v[168:171], v7, s[20:23], 0 offen offset:64
    v_accvgpr_read_b32 v166, a86
    v_accvgpr_read_b32 v167, a87
    v_accvgpr_read_b32 v160, a80
    v_accvgpr_read_b32 v161, a81
    v_accvgpr_read_b32 v162, a82
    v_accvgpr_read_b32 v163, a83
    v_pk_mul_f32 v[160:161], v[160:161], v[114:115] op_sel_hi:[1,0]
    v_pk_mul_f32 v[162:163], v[162:163], v[114:115] op_sel_hi:[1,0]
    v_pk_mul_f32 v[164:165], v[164:165], v[114:115] op_sel_hi:[1,0]
    v_pk_mul_f32 v[166:167], v[166:167], v[114:115] op_sel_hi:[1,0]
    v_cvt_pk_bf16_f32 v160, v160, v161
    v_cvt_pk_bf16_f32 v161, v162, v163
    v_cvt_pk_bf16_f32 v162, v164, v165
    v_cvt_pk_bf16_f32 v163, v166, v167
    v_accvgpr_read_b32 v172, a92
    v_accvgpr_read_b32 v173, a93
    v_permlane16_swap_b32 v160, v162
    v_permlane16_swap_b32 v161, v163
    buffer_store_dwordx4 v[160:163], v7, s[20:23], 0 offen offset:128
    v_accvgpr_read_b32 v174, a94
    v_accvgpr_read_b32 v175, a95
    v_accvgpr_read_b32 v168, a88
    v_accvgpr_read_b32 v169, a89
    v_accvgpr_read_b32 v170, a90
    v_accvgpr_read_b32 v171, a91
    v_pk_mul_f32 v[168:169], v[168:169], v[114:115] op_sel_hi:[1,0]
    v_pk_mul_f32 v[170:171], v[170:171], v[114:115] op_sel_hi:[1,0]
    v_pk_mul_f32 v[172:173], v[172:173], v[114:115] op_sel_hi:[1,0]
    v_pk_mul_f32 v[174:175], v[174:175], v[114:115] op_sel_hi:[1,0]
    v_cvt_pk_bf16_f32 v168, v168, v169
    v_cvt_pk_bf16_f32 v169, v170, v171
    v_cvt_pk_bf16_f32 v170, v172, v173
    v_cvt_pk_bf16_f32 v171, v174, v175
    s_nop 1
    v_permlane16_swap_b32 v168, v170
    v_permlane16_swap_b32 v169, v171
    buffer_store_dwordx4 v[168:171], v7, s[20:23], 0 offen offset:192
    v_rcp_f32 v115, v115
    v_accvgpr_read_b32 v176, a96
    v_accvgpr_read_b32 v177, a97
    v_accvgpr_read_b32 v178, a98
    v_accvgpr_read_b32 v179, a99
    v_accvgpr_read_b32 v180, a100
    v_accvgpr_read_b32 v181, a101
    v_accvgpr_read_b32 v182, a102
    v_accvgpr_read_b32 v183, a103
    v_add_u32 v7, 12288, v6
    v_pk_mul_f32 v[176:177], v[176:177], v[114:115] op_sel:[0,1] op_sel_hi:[1,1]
    v_pk_mul_f32 v[178:179], v[178:179], v[114:115] op_sel:[0,1] op_sel_hi:[1,1]
    v_pk_mul_f32 v[180:181], v[180:181], v[114:115] op_sel:[0,1] op_sel_hi:[1,1]
    v_pk_mul_f32 v[182:183], v[182:183], v[114:115] op_sel:[0,1] op_sel_hi:[1,1]
    v_cvt_pk_bf16_f32 v176, v176, v177
    v_cvt_pk_bf16_f32 v177, v178, v179
    v_cvt_pk_bf16_f32 v178, v180, v181
    v_cvt_pk_bf16_f32 v179, v182, v183
    v_accvgpr_read_b32 v184, a104
    v_accvgpr_read_b32 v185, a105
    v_permlane16_swap_b32 v176, v178
    v_permlane16_swap_b32 v177, v179
    buffer_store_dwordx4 v[176:179], v7, s[20:23], 0 offen
    v_accvgpr_read_b32 v186, a106
    v_accvgpr_read_b32 v187, a107
    v_accvgpr_read_b32 v188, a108
    v_accvgpr_read_b32 v189, a109
    v_accvgpr_read_b32 v190, a110
    v_accvgpr_read_b32 v191, a111
    v_pk_mul_f32 v[184:185], v[184:185], v[114:115] op_sel:[0,1] op_sel_hi:[1,1]
    v_pk_mul_f32 v[186:187], v[186:187], v[114:115] op_sel:[0,1] op_sel_hi:[1,1]
    v_pk_mul_f32 v[188:189], v[188:189], v[114:115] op_sel:[0,1] op_sel_hi:[1,1]
    v_pk_mul_f32 v[190:191], v[190:191], v[114:115] op_sel:[0,1] op_sel_hi:[1,1]
    v_cvt_pk_bf16_f32 v184, v184, v185
    v_cvt_pk_bf16_f32 v185, v186, v187
    v_cvt_pk_bf16_f32 v186, v188, v189
    v_cvt_pk_bf16_f32 v187, v190, v191
    v_accvgpr_read_b32 v180, a116
    v_accvgpr_read_b32 v181, a117
    v_permlane16_swap_b32 v184, v186
    v_permlane16_swap_b32 v185, v187
    buffer_store_dwordx4 v[184:187], v7, s[20:23], 0 offen offset:64
    v_accvgpr_read_b32 v182, a118
    v_accvgpr_read_b32 v183, a119
    v_accvgpr_read_b32 v176, a112
    v_accvgpr_read_b32 v177, a113
    v_accvgpr_read_b32 v178, a114
    v_accvgpr_read_b32 v179, a115
    v_pk_mul_f32 v[176:177], v[176:177], v[114:115] op_sel:[0,1] op_sel_hi:[1,1]
    v_pk_mul_f32 v[178:179], v[178:179], v[114:115] op_sel:[0,1] op_sel_hi:[1,1]
    v_pk_mul_f32 v[180:181], v[180:181], v[114:115] op_sel:[0,1] op_sel_hi:[1,1]
    v_pk_mul_f32 v[182:183], v[182:183], v[114:115] op_sel:[0,1] op_sel_hi:[1,1]
    v_cvt_pk_bf16_f32 v176, v176, v177
    v_cvt_pk_bf16_f32 v177, v178, v179
    v_cvt_pk_bf16_f32 v178, v180, v181
    v_cvt_pk_bf16_f32 v179, v182, v183
    v_accvgpr_read_b32 v188, a124
    v_accvgpr_read_b32 v189, a125
    v_permlane16_swap_b32 v176, v178
    v_permlane16_swap_b32 v177, v179
    buffer_store_dwordx4 v[176:179], v7, s[20:23], 0 offen offset:128
    v_accvgpr_read_b32 v190, a126
    v_accvgpr_read_b32 v191, a127
    v_accvgpr_read_b32 v184, a120
    v_accvgpr_read_b32 v185, a121
    v_accvgpr_read_b32 v186, a122
    v_accvgpr_read_b32 v187, a123
    v_pk_mul_f32 v[184:185], v[184:185], v[114:115] op_sel:[0,1] op_sel_hi:[1,1]
    v_pk_mul_f32 v[186:187], v[186:187], v[114:115] op_sel:[0,1] op_sel_hi:[1,1]
    v_pk_mul_f32 v[188:189], v[188:189], v[114:115] op_sel:[0,1] op_sel_hi:[1,1]
    v_pk_mul_f32 v[190:191], v[190:191], v[114:115] op_sel:[0,1] op_sel_hi:[1,1]
    v_cvt_pk_bf16_f32 v184, v184, v185
    v_cvt_pk_bf16_f32 v185, v186, v187
    v_cvt_pk_bf16_f32 v186, v188, v189
    v_cvt_pk_bf16_f32 v187, v190, v191
    s_nop 1
    v_permlane16_swap_b32 v184, v186
    v_permlane16_swap_b32 v185, v187
    buffer_store_dwordx4 v[184:187], v7, s[20:23], 0 offen offset:192
    v_rcp_f32 v116, v116
    v_accvgpr_read_b32 v192, a128
    v_accvgpr_read_b32 v193, a129
    v_accvgpr_read_b32 v194, a130
    v_accvgpr_read_b32 v195, a131
    v_accvgpr_read_b32 v196, a132
    v_accvgpr_read_b32 v197, a133
    v_accvgpr_read_b32 v198, a134
    v_accvgpr_read_b32 v199, a135
    v_add_u32 v7, 16384, v6
    v_pk_mul_f32 v[192:193], v[192:193], v[116:117] op_sel_hi:[1,0]
    v_pk_mul_f32 v[194:195], v[194:195], v[116:117] op_sel_hi:[1,0]
    v_pk_mul_f32 v[196:197], v[196:197], v[116:117] op_sel_hi:[1,0]
    v_pk_mul_f32 v[198:199], v[198:199], v[116:117] op_sel_hi:[1,0]
    v_cvt_pk_bf16_f32 v192, v192, v193
    v_cvt_pk_bf16_f32 v193, v194, v195
    v_cvt_pk_bf16_f32 v194, v196, v197
    v_cvt_pk_bf16_f32 v195, v198, v199
    v_accvgpr_read_b32 v200, a136
    v_accvgpr_read_b32 v201, a137
    v_permlane16_swap_b32 v192, v194
    v_permlane16_swap_b32 v193, v195
    buffer_store_dwordx4 v[192:195], v7, s[20:23], 0 offen
    v_accvgpr_read_b32 v202, a138
    v_accvgpr_read_b32 v203, a139
    v_accvgpr_read_b32 v204, a140
    v_accvgpr_read_b32 v205, a141
    v_accvgpr_read_b32 v206, a142
    v_accvgpr_read_b32 v207, a143
    v_pk_mul_f32 v[200:201], v[200:201], v[116:117] op_sel_hi:[1,0]
    v_pk_mul_f32 v[202:203], v[202:203], v[116:117] op_sel_hi:[1,0]
    v_pk_mul_f32 v[204:205], v[204:205], v[116:117] op_sel_hi:[1,0]
    v_pk_mul_f32 v[206:207], v[206:207], v[116:117] op_sel_hi:[1,0]
    v_cvt_pk_bf16_f32 v200, v200, v201
    v_cvt_pk_bf16_f32 v201, v202, v203
    v_cvt_pk_bf16_f32 v202, v204, v205
    v_cvt_pk_bf16_f32 v203, v206, v207
    v_accvgpr_read_b32 v196, a148
    v_accvgpr_read_b32 v197, a149
    v_permlane16_swap_b32 v200, v202
    v_permlane16_swap_b32 v201, v203
    buffer_store_dwordx4 v[200:203], v7, s[20:23], 0 offen offset:64
    v_accvgpr_read_b32 v198, a150
    v_accvgpr_read_b32 v199, a151
    v_accvgpr_read_b32 v192, a144
    v_accvgpr_read_b32 v193, a145
    v_accvgpr_read_b32 v194, a146
    v_accvgpr_read_b32 v195, a147
    v_pk_mul_f32 v[192:193], v[192:193], v[116:117] op_sel_hi:[1,0]
    v_pk_mul_f32 v[194:195], v[194:195], v[116:117] op_sel_hi:[1,0]
    v_pk_mul_f32 v[196:197], v[196:197], v[116:117] op_sel_hi:[1,0]
    v_pk_mul_f32 v[198:199], v[198:199], v[116:117] op_sel_hi:[1,0]
    v_cvt_pk_bf16_f32 v192, v192, v193
    v_cvt_pk_bf16_f32 v193, v194, v195
    v_cvt_pk_bf16_f32 v194, v196, v197
    v_cvt_pk_bf16_f32 v195, v198, v199
    v_accvgpr_read_b32 v204, a156
    v_accvgpr_read_b32 v205, a157
    v_permlane16_swap_b32 v192, v194
    v_permlane16_swap_b32 v193, v195
    buffer_store_dwordx4 v[192:195], v7, s[20:23], 0 offen offset:128
    v_accvgpr_read_b32 v206, a158
    v_accvgpr_read_b32 v207, a159
    v_accvgpr_read_b32 v200, a152
    v_accvgpr_read_b32 v201, a153
    v_accvgpr_read_b32 v202, a154
    v_accvgpr_read_b32 v203, a155
    v_pk_mul_f32 v[200:201], v[200:201], v[116:117] op_sel_hi:[1,0]
    v_pk_mul_f32 v[202:203], v[202:203], v[116:117] op_sel_hi:[1,0]
    v_pk_mul_f32 v[204:205], v[204:205], v[116:117] op_sel_hi:[1,0]
    v_pk_mul_f32 v[206:207], v[206:207], v[116:117] op_sel_hi:[1,0]
    v_cvt_pk_bf16_f32 v200, v200, v201
    v_cvt_pk_bf16_f32 v201, v202, v203
    v_cvt_pk_bf16_f32 v202, v204, v205
    v_cvt_pk_bf16_f32 v203, v206, v207
    s_nop 1
    v_permlane16_swap_b32 v200, v202
    v_permlane16_swap_b32 v201, v203
    buffer_store_dwordx4 v[200:203], v7, s[20:23], 0 offen offset:192
    v_rcp_f32 v117, v117
    v_accvgpr_read_b32 v208, a160
    v_accvgpr_read_b32 v209, a161
    v_accvgpr_read_b32 v210, a162
    v_accvgpr_read_b32 v211, a163
    v_accvgpr_read_b32 v212, a164
    v_accvgpr_read_b32 v213, a165
    v_accvgpr_read_b32 v214, a166
    v_accvgpr_read_b32 v215, a167
    v_add_u32 v7, 20480, v6
    v_pk_mul_f32 v[208:209], v[208:209], v[116:117] op_sel:[0,1] op_sel_hi:[1,1]
    v_pk_mul_f32 v[210:211], v[210:211], v[116:117] op_sel:[0,1] op_sel_hi:[1,1]
    v_pk_mul_f32 v[212:213], v[212:213], v[116:117] op_sel:[0,1] op_sel_hi:[1,1]
    v_pk_mul_f32 v[214:215], v[214:215], v[116:117] op_sel:[0,1] op_sel_hi:[1,1]
    v_cvt_pk_bf16_f32 v208, v208, v209
    v_cvt_pk_bf16_f32 v209, v210, v211
    v_cvt_pk_bf16_f32 v210, v212, v213
    v_cvt_pk_bf16_f32 v211, v214, v215
    v_accvgpr_read_b32 v216, a168
    v_accvgpr_read_b32 v217, a169
    v_permlane16_swap_b32 v208, v210
    v_permlane16_swap_b32 v209, v211
    buffer_store_dwordx4 v[208:211], v7, s[20:23], 0 offen
    v_accvgpr_read_b32 v218, a170
    v_accvgpr_read_b32 v219, a171
    v_accvgpr_read_b32 v220, a172
    v_accvgpr_read_b32 v221, a173
    v_accvgpr_read_b32 v222, a174
    v_accvgpr_read_b32 v223, a175
    v_pk_mul_f32 v[216:217], v[216:217], v[116:117] op_sel:[0,1] op_sel_hi:[1,1]
    v_pk_mul_f32 v[218:219], v[218:219], v[116:117] op_sel:[0,1] op_sel_hi:[1,1]
    v_pk_mul_f32 v[220:221], v[220:221], v[116:117] op_sel:[0,1] op_sel_hi:[1,1]
    v_pk_mul_f32 v[222:223], v[222:223], v[116:117] op_sel:[0,1] op_sel_hi:[1,1]
    v_cvt_pk_bf16_f32 v216, v216, v217
    v_cvt_pk_bf16_f32 v217, v218, v219
    v_cvt_pk_bf16_f32 v218, v220, v221
    v_cvt_pk_bf16_f32 v219, v222, v223
    v_accvgpr_read_b32 v212, a180
    v_accvgpr_read_b32 v213, a181
    v_permlane16_swap_b32 v216, v218
    v_permlane16_swap_b32 v217, v219
    buffer_store_dwordx4 v[216:219], v7, s[20:23], 0 offen offset:64
    v_accvgpr_read_b32 v214, a182
    v_accvgpr_read_b32 v215, a183
    v_accvgpr_read_b32 v208, a176
    v_accvgpr_read_b32 v209, a177
    v_accvgpr_read_b32 v210, a178
    v_accvgpr_read_b32 v211, a179
    v_pk_mul_f32 v[208:209], v[208:209], v[116:117] op_sel:[0,1] op_sel_hi:[1,1]
    v_pk_mul_f32 v[210:211], v[210:211], v[116:117] op_sel:[0,1] op_sel_hi:[1,1]
    v_pk_mul_f32 v[212:213], v[212:213], v[116:117] op_sel:[0,1] op_sel_hi:[1,1]
    v_pk_mul_f32 v[214:215], v[214:215], v[116:117] op_sel:[0,1] op_sel_hi:[1,1]
    v_cvt_pk_bf16_f32 v208, v208, v209
    v_cvt_pk_bf16_f32 v209, v210, v211
    v_cvt_pk_bf16_f32 v210, v212, v213
    v_cvt_pk_bf16_f32 v211, v214, v215
    v_accvgpr_read_b32 v220, a188
    v_accvgpr_read_b32 v221, a189
    v_permlane16_swap_b32 v208, v210
    v_permlane16_swap_b32 v209, v211
    buffer_store_dwordx4 v[208:211], v7, s[20:23], 0 offen offset:128
    v_accvgpr_read_b32 v222, a190
    v_accvgpr_read_b32 v223, a191
    v_accvgpr_read_b32 v216, a184
    v_accvgpr_read_b32 v217, a185
    v_accvgpr_read_b32 v218, a186
    v_accvgpr_read_b32 v219, a187
    v_pk_mul_f32 v[216:217], v[216:217], v[116:117] op_sel:[0,1] op_sel_hi:[1,1]
    v_pk_mul_f32 v[218:219], v[218:219], v[116:117] op_sel:[0,1] op_sel_hi:[1,1]
    v_pk_mul_f32 v[220:221], v[220:221], v[116:117] op_sel:[0,1] op_sel_hi:[1,1]
    v_pk_mul_f32 v[222:223], v[222:223], v[116:117] op_sel:[0,1] op_sel_hi:[1,1]
    v_cvt_pk_bf16_f32 v216, v216, v217
    v_cvt_pk_bf16_f32 v217, v218, v219
    v_cvt_pk_bf16_f32 v218, v220, v221
    v_cvt_pk_bf16_f32 v219, v222, v223
    s_nop 1
    v_permlane16_swap_b32 v216, v218
    v_permlane16_swap_b32 v217, v219
    buffer_store_dwordx4 v[216:219], v7, s[20:23], 0 offen offset:192
    v_rcp_f32 v118, v118
    v_add_u32 v7, 24576, v6
    v_pk_mul_f32 v[48:49], v[48:49], v[118:119] op_sel_hi:[1,0]
    v_pk_mul_f32 v[50:51], v[50:51], v[118:119] op_sel_hi:[1,0]
    v_pk_mul_f32 v[52:53], v[52:53], v[118:119] op_sel_hi:[1,0]
    v_pk_mul_f32 v[54:55], v[54:55], v[118:119] op_sel_hi:[1,0]
    v_cvt_pk_bf16_f32 v48, v48, v49
    v_cvt_pk_bf16_f32 v49, v50, v51
    v_cvt_pk_bf16_f32 v50, v52, v53
    v_cvt_pk_bf16_f32 v51, v54, v55
    v_pk_mul_f32 v[56:57], v[56:57], v[118:119] op_sel_hi:[1,0]
    v_pk_mul_f32 v[58:59], v[58:59], v[118:119] op_sel_hi:[1,0]
    v_permlane16_swap_b32 v48, v50
    v_permlane16_swap_b32 v49, v51
    buffer_store_dwordx4 v[48:51], v7, s[20:23], 0 offen
    v_pk_mul_f32 v[60:61], v[60:61], v[118:119] op_sel_hi:[1,0]
    v_pk_mul_f32 v[62:63], v[62:63], v[118:119] op_sel_hi:[1,0]
    v_cvt_pk_bf16_f32 v56, v56, v57
    v_cvt_pk_bf16_f32 v57, v58, v59
    v_cvt_pk_bf16_f32 v58, v60, v61
    v_cvt_pk_bf16_f32 v59, v62, v63
    v_pk_mul_f32 v[64:65], v[64:65], v[118:119] op_sel_hi:[1,0]
    v_pk_mul_f32 v[66:67], v[66:67], v[118:119] op_sel_hi:[1,0]
    v_permlane16_swap_b32 v56, v58
    v_permlane16_swap_b32 v57, v59
    buffer_store_dwordx4 v[56:59], v7, s[20:23], 0 offen offset:64
    v_pk_mul_f32 v[68:69], v[68:69], v[118:119] op_sel_hi:[1,0]
    v_pk_mul_f32 v[70:71], v[70:71], v[118:119] op_sel_hi:[1,0]
    v_cvt_pk_bf16_f32 v64, v64, v65
    v_cvt_pk_bf16_f32 v65, v66, v67
    v_cvt_pk_bf16_f32 v66, v68, v69
    v_cvt_pk_bf16_f32 v67, v70, v71
    v_pk_mul_f32 v[72:73], v[72:73], v[118:119] op_sel_hi:[1,0]
    v_pk_mul_f32 v[74:75], v[74:75], v[118:119] op_sel_hi:[1,0]
    v_permlane16_swap_b32 v64, v66
    v_permlane16_swap_b32 v65, v67
    buffer_store_dwordx4 v[64:67], v7, s[20:23], 0 offen offset:128
    v_pk_mul_f32 v[76:77], v[76:77], v[118:119] op_sel_hi:[1,0]
    v_pk_mul_f32 v[78:79], v[78:79], v[118:119] op_sel_hi:[1,0]
    v_cvt_pk_bf16_f32 v72, v72, v73
    v_cvt_pk_bf16_f32 v73, v74, v75
    v_cvt_pk_bf16_f32 v74, v76, v77
    v_cvt_pk_bf16_f32 v75, v78, v79
    s_nop 1
    v_permlane16_swap_b32 v72, v74
    v_permlane16_swap_b32 v73, v75
    buffer_store_dwordx4 v[72:75], v7, s[20:23], 0 offen offset:192
    v_rcp_f32 v119, v119
    v_add_u32 v7, 28672, v6
    v_pk_mul_f32 v[80:81], v[80:81], v[118:119] op_sel:[0,1] op_sel_hi:[1,1]
    v_pk_mul_f32 v[82:83], v[82:83], v[118:119] op_sel:[0,1] op_sel_hi:[1,1]
    v_pk_mul_f32 v[84:85], v[84:85], v[118:119] op_sel:[0,1] op_sel_hi:[1,1]
    v_pk_mul_f32 v[86:87], v[86:87], v[118:119] op_sel:[0,1] op_sel_hi:[1,1]
    v_cvt_pk_bf16_f32 v80, v80, v81
    v_cvt_pk_bf16_f32 v81, v82, v83
    v_cvt_pk_bf16_f32 v82, v84, v85
    v_cvt_pk_bf16_f32 v83, v86, v87
    v_pk_mul_f32 v[88:89], v[88:89], v[118:119] op_sel:[0,1] op_sel_hi:[1,1]
    v_pk_mul_f32 v[90:91], v[90:91], v[118:119] op_sel:[0,1] op_sel_hi:[1,1]
    v_permlane16_swap_b32 v80, v82
    v_permlane16_swap_b32 v81, v83
    buffer_store_dwordx4 v[80:83], v7, s[20:23], 0 offen
    v_pk_mul_f32 v[92:93], v[92:93], v[118:119] op_sel:[0,1] op_sel_hi:[1,1]
    v_pk_mul_f32 v[94:95], v[94:95], v[118:119] op_sel:[0,1] op_sel_hi:[1,1]
    v_cvt_pk_bf16_f32 v88, v88, v89
    v_cvt_pk_bf16_f32 v89, v90, v91
    v_cvt_pk_bf16_f32 v90, v92, v93
    v_cvt_pk_bf16_f32 v91, v94, v95
    v_pk_mul_f32 v[96:97], v[96:97], v[118:119] op_sel:[0,1] op_sel_hi:[1,1]
    v_pk_mul_f32 v[98:99], v[98:99], v[118:119] op_sel:[0,1] op_sel_hi:[1,1]
    v_permlane16_swap_b32 v88, v90
    v_permlane16_swap_b32 v89, v91
    buffer_store_dwordx4 v[88:91], v7, s[20:23], 0 offen offset:64
    v_pk_mul_f32 v[100:101], v[100:101], v[118:119] op_sel:[0,1] op_sel_hi:[1,1]
    v_pk_mul_f32 v[102:103], v[102:103], v[118:119] op_sel:[0,1] op_sel_hi:[1,1]
    v_cvt_pk_bf16_f32 v96, v96, v97
    v_cvt_pk_bf16_f32 v97, v98, v99
    v_cvt_pk_bf16_f32 v98, v100, v101
    v_cvt_pk_bf16_f32 v99, v102, v103
    v_pk_mul_f32 v[104:105], v[104:105], v[118:119] op_sel:[0,1] op_sel_hi:[1,1]
    v_pk_mul_f32 v[106:107], v[106:107], v[118:119] op_sel:[0,1] op_sel_hi:[1,1]
    v_permlane16_swap_b32 v96, v98
    v_permlane16_swap_b32 v97, v99
    buffer_store_dwordx4 v[96:99], v7, s[20:23], 0 offen offset:128
    v_pk_mul_f32 v[108:109], v[108:109], v[118:119] op_sel:[0,1] op_sel_hi:[1,1]
    v_pk_mul_f32 v[110:111], v[110:111], v[118:119] op_sel:[0,1] op_sel_hi:[1,1]
    v_cvt_pk_bf16_f32 v104, v104, v105
    v_cvt_pk_bf16_f32 v105, v106, v107
    v_cvt_pk_bf16_f32 v106, v108, v109
    v_cvt_pk_bf16_f32 v107, v110, v111
    s_nop 1
    v_permlane16_swap_b32 v104, v106
    v_permlane16_swap_b32 v105, v107
    buffer_store_dwordx4 v[104:107], v7, s[20:23], 0 offen offset:192
    s_endpgm
.section .rodata,"a"
.p2align 6
.amdhsa_kernel standalone__mha_softmax__near_ridge_kernel
  .amdhsa_next_free_vgpr 512
  .amdhsa_next_free_sgpr 80
  .amdhsa_accum_offset 256
  .amdhsa_group_segment_fixed_size 0
  .amdhsa_kernarg_size 48
  .amdhsa_user_sgpr_count 2
  .amdhsa_user_sgpr_kernarg_segment_ptr 1
  .amdhsa_system_sgpr_workgroup_id_x 1
.end_amdhsa_kernel
```
